```python
import torch

def _softmax(x, axis=-1):
    return torch.softmax(x, dim=axis)
def _gelu(x):
    return torch.nn.functional.gelu(x, approximate="tanh")
def _silu(x):
    return torch.nn.functional.silu(x)
def _sigmoid(x):
    return torch.sigmoid(x)
def _layernorm(x, axis=-1, eps=1e-5):
    m = x.mean(dim=axis, keepdim=True)
    v = x.var(dim=axis, keepdim=True, unbiased=False)
    return (x - m) / torch.sqrt(v + eps)
def _scatter_add(tgt, idx, src, axis=0):
    return tgt.clone().index_add_(axis, idx, src)
def _segment_sum(src, seg, n):
    out = torch.zeros((n,) + src.shape[1:], dtype=src.dtype)
    return out.index_add_(0, seg, src)
def _pad(x, pw):
    flat = tuple(v for pair in reversed(pw) for v in pair)
    return torch.nn.functional.pad(x, flat)

kernel_name = 'sequential_preLN__linear_kernel_hedgehog__swiglu_ffn__prompt'

def setup_inputs():

    _w = (lambda a: (lambda t: t.to(torch.bfloat16) if t.is_floating_point() else t)(torch.as_tensor(a)))
    def _A_setup():
        B, S, D, H = 1, 2048, 512, 32
        Dh = D // H
        return {
            "x": _w((lambda *s: torch.randn(*s, dtype=torch.bfloat16) * 0.05)(B, S, D)),
            "wqkv": _w((lambda *s: torch.randn(*s, dtype=torch.bfloat16) * 0.2)(D, 3 * D)),
            "w_phi": _w((lambda *s: torch.randn(*s, dtype=torch.bfloat16) * 0.2)(H, Dh, Dh) * (Dh ** -0.5)),
            "wo": _w((lambda *s: torch.randn(*s, dtype=torch.bfloat16) * 0.05)(D, D)),
        }
    _A_in = _A_setup()

    def _B_setup():
        B, S, D, F = 1, 2048, 512, 1792
        return {
            "x": _w((lambda *s: torch.randn(*s, dtype=torch.bfloat16) * 0.05)(B, S, D)),
            "w_gate": _w((lambda *s: torch.randn(*s, dtype=torch.bfloat16) * 0.05)(D, F)),
            "w_up": _w((lambda *s: torch.randn(*s, dtype=torch.bfloat16) * 0.05)(D, F)),
            "w_down": _w((lambda *s: torch.randn(*s, dtype=torch.bfloat16) * 0.05)(F, D)),
        }
    _B_in = _B_setup()

    return {
        "A_x": _A_in["x"],
        "A_wqkv": _A_in["wqkv"],
        "A_w_phi": _A_in["w_phi"],
        "A_wo": _A_in["wo"],
        "B_x": _B_in["x"],
        "B_w_gate": _B_in["w_gate"],
        "B_w_up": _B_in["w_up"],
        "B_w_down": _B_in["w_down"],
    }

def reference(A_x, A_wqkv, A_w_phi, A_wo, B_x, B_w_gate, B_w_up, B_w_down):
    def _A_ref(x, wqkv, w_phi, wo):
        B, S, D = x.shape
        H = 32; Dh = D // H
        qkv = (lambda x, *d: x.permute(*d))((x @ wqkv).reshape(B, S, 3, H, Dh), 2, 0, 3, 1, 4)
        q, k, v = qkv[0], qkv[1], qkv[2]
        pq = torch.einsum("bhsd,hdf->bhsf", q, w_phi)
        pk = torch.einsum("bhsd,hdf->bhsf", k, w_phi)
        phi_q = torch.concatenate([_softmax(pq, axis=-1), _softmax(-pq, axis=-1)], axis=-1)
        phi_k = torch.concatenate([_softmax(pk, axis=-1), _softmax(-pk, axis=-1)], axis=-1)
        kv = torch.einsum("bhsf,bhsd->bhfd", phi_k, v)
        z  = torch.einsum("bhsf->bhf", phi_k)
        num = torch.einsum("bhqf,bhfd->bhqd", phi_q, kv)
        den = torch.einsum("bhqf,bhf->bhq", phi_q, z)[..., None] + 1e-6
        o = num / den
        return (lambda x, *d: x.permute(*d))(o, 0, 2, 1, 3).reshape(B, S, D) @ wo

    def _B_ref(x, w_gate, w_up, w_down):
        g = _silu(x @ w_gate)
        u = x @ w_up
        return (g * u) @ w_down

    x = A_x
    h = x + _A_ref(_layernorm(x, axis=-1), A_wqkv, A_w_phi, A_wo)
    h2 = h + _B_ref(_layernorm(h, axis=-1), B_w_gate, B_w_up, B_w_down)
    return h2
```

```asm
; @launch kernel=k1_qkv_kernel grid=(256,1,1) block=(512,1,1) lds=106496
; @launch kernel=kaux_reduce_kernel grid=(182,1,1) block=(256,1,1) lds=9216
; @launch kernel=k2_attn_out_kernel grid=(256,1,1) block=(512,1,1) lds=131072
; @launch kernel=k3_ffn_up_kernel grid=(256,1,1) block=(512,1,1) lds=152576
; @launch kernel=k4_ffn_down_kernel grid=(256,1,1) block=(512,1,1) lds=131072
.amdgcn_target "amdgcn-amd-amdhsa--gfx950"
.text
.globl k1_qkv_kernel
.p2align 8
.type k1_qkv_kernel,@function
k1_qkv_kernel:

    s_cmp_ge_u32 s2, 256
    s_cbranch_scc1 L_k1_done
    s_load_dwordx2 s[20:21], s[0:1], 80
    s_load_dwordx2 s[22:23], s[0:1], 8
    s_load_dwordx2 s[24:25], s[0:1], 0
    s_load_dwordx2 s[42:43], s[0:1], 16
    v_lshrrev_b32 v16, 6, v0
    v_and_b32 v1, 63, v0
    v_readfirstlane_b32 s26, v16
    s_and_b32 s27, s2, 3
    s_lshl_b32 s27, s27, 2
    s_bfe_u32 s28, s2, 0x20003
    s_add_u32 s27, s27, s28
    s_bfe_u32 s28, s2, 0x10002
    s_lshl_b32 s28, s28, 3
    s_lshr_b32 s29, s2, 5
    s_add_u32 s28, s28, s29
    s_and_b32 s39, s26, 3
    v_lshrrev_b32 v17, 4, v1
    v_and_b32 v18, 15, v1
    v_lshlrev_b32 v19, 2, v17
    v_xor_b32 v18, v18, v19
    v_cmp_gt_u32 s[32:33], 12, v18
    s_movk_i32 s30, 3072
    v_mul_lo_u32 v3, v17, s30
    v_lshrrev_b32 v19, 2, v18
    v_lshl_add_u32 v3, v19, 10, v3
    v_and_b32 v19, 3, v18
    v_lshl_add_u32 v3, v19, 4, v3
    s_lshl_b32 s30, s28, 6
    v_add_u32 v3, s30, v3
    v_lshrrev_b32 v17, 3, v1
    v_and_b32 v18, 7, v1
    v_lshrrev_b32 v19, 1, v17
    v_xor_b32 v18, v18, v19
    s_lshl_b32 s30, s27, 7
    s_lshl_b32 s36, s26, 4
    s_add_u32 s30, s30, s36
    v_add_u32 v17, s30, v17
    v_lshlrev_b32 v2, 10, v17
    v_xor_b32 v19, 4, v18
    v_lshl_add_u32 v10, v19, 4, v2
    v_add_u32 v10, 8192, v10
    v_lshl_add_u32 v2, v18, 4, v2
    s_lshl_b32 s38, s26, 11
    s_mul_i32 s34, s26, 24576
    s_lshl_b32 s35, s26, 11
    s_add_u32 s35, s35, 16384
    s_waitcnt lgkmcnt(0)
    s_mov_b32 s4, s24
    s_mov_b32 s5, s25
    s_mov_b32 s6, 2097152
    s_mov_b32 s7, 0x00020000
    s_mov_b32 s8, s22
    s_mov_b32 s9, s23
    s_mov_b32 s10, 1572864
    s_mov_b32 s11, 0x00020000
    s_add_u32 s37, s38, 0
    s_mov_b32 m0, s37
    s_movk_i32 s36, 0
    buffer_load_dwordx4 v2, s[4:7], s36 offen lds
    s_add_u32 s37, s38, 1024
    s_mov_b32 m0, s37
    s_movk_i32 s36, 0
    buffer_load_dwordx4 v10, s[4:7], s36 offen lds
    s_add_u32 s36, s34, 0
    s_add_u32 s37, s35, 0
    s_mov_b32 m0, s37
    s_mov_b64 exec, s[32:33]
    buffer_load_dwordx4 v3, s[8:11], s36 offen lds
    s_mov_b64 exec, -1
    s_add_u32 s36, s34, 12288
    s_add_u32 s37, s35, 1024
    s_mov_b32 m0, s37
    s_mov_b64 exec, s[32:33]
    buffer_load_dwordx4 v3, s[8:11], s36 offen lds
    s_mov_b64 exec, -1
    s_mov_b32 s44, s42
    s_mov_b32 s45, s43
    s_mov_b32 s46, 16384
    s_mov_b32 s47, 0x00020000
    v_lshlrev_b32 v16, 4, v1
    s_lshl_b32 s30, s28, 10
    v_add_u32 v16, s30, v16
    s_mov_b32 m0, 98304
    s_nop 0
    buffer_load_dwordx4 v16, s[44:47], 0 offen lds
    s_mov_b32 s12, s20
    s_mov_b32 s13, s21
    s_mov_b32 s14, 4194304
    s_mov_b32 s15, 0x00020000
    s_add_u32 s16, s20, 4194304
    s_addc_u32 s17, s21, 0
    s_mov_b32 s18, 1114112
    s_mov_b32 s19, 0x00020000
    v_and_b32 v16, 31, v1
    v_lshrrev_b32 v17, 5, v1
    v_bfe_u32 v18, v1, 2, 2
    v_and_b32 v19, 3, v1
    v_bfe_u32 v20, v1, 4, 1
    v_lshrrev_b32 v23, 3, v16
    s_lshl_b32 s30, s39, 2
    v_add_u32 v23, s30, v23
    v_lshlrev_b32 v24, 10, v23
    v_and_b32 v23, 7, v16
    v_lshl_add_u32 v24, v23, 7, v24
    v_bfe_u32 v23, v16, 1, 3
    v_lshl_add_u32 v25, v17, 0, 0
    v_xor_b32 v25, v25, v23
    v_lshl_add_u32 v31, v25, 4, v24
    v_lshl_add_u32 v25, v17, 0, 2
    v_xor_b32 v25, v25, v23
    v_lshl_add_u32 v32, v25, 4, v24
    v_lshl_add_u32 v25, v17, 0, 4
    v_xor_b32 v25, v25, v23
    v_lshl_add_u32 v33, v25, 4, v24
    v_lshl_add_u32 v25, v17, 0, 6
    v_xor_b32 v25, v25, v23
    v_lshl_add_u32 v34, v25, 4, v24
    v_lshl_add_u32 v21, v17, 3, v18
    v_lshlrev_b32 v21, 8, v21
    v_and_b32 v23, 1, v19
    v_lshl_add_u32 v21, v23, 3, v21
    v_add_u32 v21, 16384, v21
    v_lshrrev_b32 v23, 1, v19
    v_lshl_add_u32 v24, v20, 1, v23
    v_xor_b32 v25, 0, v18
    v_lshl_add_u32 v28, v25, 6, v21
    v_lshl_add_u32 v28, v24, 4, v28
    v_xor_b32 v25, 1, v18
    v_lshl_add_u32 v29, v25, 6, v21
    v_lshl_add_u32 v29, v24, 4, v29
    v_xor_b32 v25, 2, v18
    v_lshl_add_u32 v30, v25, 6, v21
    v_lshl_add_u32 v30, v24, 4, v30
    v_add_u32 v36, 32768, v28
    v_add_u32 v37, 32768, v29
    v_add_u32 v38, 32768, v30
    v_add_u32 v39, 32768, v31
    v_add_u32 v40, 32768, v32
    v_add_u32 v41, 32768, v33
    v_add_u32 v42, 32768, v34
    v_add_u32 v44, 65536, v28
    v_add_u32 v45, 65536, v29
    v_add_u32 v46, 65536, v30
    v_add_u32 v47, 65536, v31
    v_add_u32 v48, 65536, v32
    v_add_u32 v49, 65536, v33
    v_add_u32 v50, 65536, v34
    s_add_u32 s37, s38, 32768
    s_mov_b32 m0, s37
    s_movk_i32 s36, 128
    buffer_load_dwordx4 v2, s[4:7], s36 offen lds
    s_add_u32 s37, s38, 33792
    s_mov_b32 m0, s37
    s_movk_i32 s36, 128
    buffer_load_dwordx4 v10, s[4:7], s36 offen lds
    s_add_u32 s36, s34, 196608
    s_add_u32 s37, s35, 32768
    s_mov_b32 m0, s37
    s_mov_b64 exec, s[32:33]
    buffer_load_dwordx4 v3, s[8:11], s36 offen lds
    s_mov_b64 exec, -1
    s_add_u32 s36, s34, 208896
    s_add_u32 s37, s35, 33792
    s_mov_b32 m0, s37
    s_mov_b64 exec, s[32:33]
    buffer_load_dwordx4 v3, s[8:11], s36 offen lds
    s_mov_b64 exec, -1
    v_mov_b32 v128, 0
    v_mov_b32 v129, 0
    v_mov_b32 v130, 0
    v_mov_b32 v131, 0
    v_mov_b32 v132, 0
    v_mov_b32 v133, 0
    v_mov_b32 v134, 0
    v_mov_b32 v135, 0
    v_mov_b32 v136, 0
    v_mov_b32 v137, 0
    v_mov_b32 v138, 0
    v_mov_b32 v139, 0
    v_mov_b32 v140, 0
    v_mov_b32 v141, 0
    v_mov_b32 v142, 0
    v_mov_b32 v143, 0
    v_mov_b32 v144, 0
    v_mov_b32 v145, 0
    v_mov_b32 v146, 0
    v_mov_b32 v147, 0
    v_mov_b32 v148, 0
    v_mov_b32 v149, 0
    v_mov_b32 v150, 0
    v_mov_b32 v151, 0
    v_mov_b32 v152, 0
    v_mov_b32 v153, 0
    v_mov_b32 v154, 0
    v_mov_b32 v155, 0
    v_mov_b32 v156, 0
    v_mov_b32 v157, 0
    v_mov_b32 v158, 0
    v_mov_b32 v159, 0
    v_mov_b32 v12, 0
    v_mov_b32 v13, 0
    v_mov_b32 v14, 0
    v_mov_b32 v15, 0
    v_mov_b32 v116, 0
    v_mov_b32 v117, 0
    v_mov_b32 v118, 0
    v_mov_b32 v119, 0
    v_mov_b32 v120, 0
    v_mov_b32 v121, 0
    s_cmp_ge_u32 s26, 4
    s_cbranch_scc1 L_k1_tg1
    s_waitcnt vmcnt(5)
    s_barrier
    ds_read_b128 v[96:99], v31
    ds_read_b64_tr_b16 v[64:65], v28 offset:0
    ds_read_b64_tr_b16 v[66:67], v28 offset:1024
    ds_read_b128 v[100:103], v32
    ds_read_b64_tr_b16 v[68:69], v28 offset:4096
    ds_read_b64_tr_b16 v[70:71], v28 offset:5120
    ds_read_b128 v[104:107], v33
    ds_read_b64_tr_b16 v[72:73], v28 offset:8192
    ds_read_b64_tr_b16 v[74:75], v28 offset:9216
    ds_read_b128 v[108:111], v34
    ds_read_b64_tr_b16 v[76:77], v28 offset:12288
    ds_read_b64_tr_b16 v[78:79], v28 offset:13312
    s_waitcnt lgkmcnt(9)
    v_mfma_f32_32x32x16_bf16 v[128:143], v[64:67], v[96:99], v[128:143]
    v_lshlrev_b32 v16, 16, v96
    v_and_b32 v17, 0xffff0000, v96
    v_add_f32 v12, v12, v16
    v_add_f32 v13, v13, v17
    v_fma_f32 v14, v16, v16, v14
    v_fma_f32 v15, v17, v17, v15
    v_lshlrev_b32 v16, 16, v97
    v_and_b32 v17, 0xffff0000, v97
    v_add_f32 v12, v12, v16
    v_add_f32 v13, v13, v17
    v_fma_f32 v14, v16, v16, v14
    v_fma_f32 v15, v17, v17, v15
    s_cmp_lg_u32 s39, 0
    s_cbranch_scc1 L_k1_ws_1
    v_lshlrev_b32 v18, 16, v64
    v_and_b32 v19, 0xffff0000, v64
    v_add_f32 v116, v116, v18
    v_add_f32 v117, v117, v19
    v_lshlrev_b32 v18, 16, v65
    v_and_b32 v19, 0xffff0000, v65
    v_add_f32 v116, v116, v18
    v_add_f32 v117, v117, v19
    v_lshlrev_b32 v18, 16, v66
    v_and_b32 v19, 0xffff0000, v66
    v_add_f32 v116, v116, v18
    v_add_f32 v117, v117, v19
    v_lshlrev_b32 v18, 16, v67
    v_and_b32 v19, 0xffff0000, v67
    v_add_f32 v116, v116, v18
    v_add_f32 v117, v117, v19
L_k1_ws_1:
    s_add_u32 s37, s38, 65536
    s_mov_b32 m0, s37
    s_movk_i32 s36, 256
    buffer_load_dwordx4 v2, s[4:7], s36 offen lds
    s_add_u32 s37, s38, 66560
    s_mov_b32 m0, s37
    s_movk_i32 s36, 256
    buffer_load_dwordx4 v10, s[4:7], s36 offen lds
    s_add_u32 s36, s34, 393216
    s_add_u32 s37, s35, 65536
    s_mov_b32 m0, s37
    s_mov_b64 exec, s[32:33]
    buffer_load_dwordx4 v3, s[8:11], s36 offen lds
    s_mov_b64 exec, -1
    s_add_u32 s36, s34, 405504
    s_add_u32 s37, s35, 66560
    s_mov_b32 m0, s37
    s_mov_b64 exec, s[32:33]
    buffer_load_dwordx4 v3, s[8:11], s36 offen lds
    s_mov_b64 exec, -1
    s_waitcnt vmcnt(4)
    s_waitcnt lgkmcnt(0)
    s_barrier
    ds_read_b128 v[112:115], v39
    ds_read_b64_tr_b16 v[80:81], v36 offset:0
    ds_read_b64_tr_b16 v[82:83], v36 offset:1024
    v_mfma_f32_32x32x16_bf16 v[128:143], v[68:71], v[100:103], v[128:143]
    v_lshlrev_b32 v16, 16, v100
    v_and_b32 v17, 0xffff0000, v100
    v_add_f32 v12, v12, v16
    v_add_f32 v13, v13, v17
    v_fma_f32 v14, v16, v16, v14
    v_fma_f32 v15, v17, v17, v15
    v_lshlrev_b32 v16, 16, v101
    v_and_b32 v17, 0xffff0000, v101
    v_add_f32 v12, v12, v16
    v_add_f32 v13, v13, v17
    v_fma_f32 v14, v16, v16, v14
    v_fma_f32 v15, v17, v17, v15
    s_cmp_lg_u32 s39, 1
    s_cbranch_scc1 L_k1_ws_2
    v_lshlrev_b32 v18, 16, v68
    v_and_b32 v19, 0xffff0000, v68
    v_add_f32 v116, v116, v18
    v_add_f32 v117, v117, v19
    v_lshlrev_b32 v18, 16, v69
    v_and_b32 v19, 0xffff0000, v69
    v_add_f32 v116, v116, v18
    v_add_f32 v117, v117, v19
    v_lshlrev_b32 v18, 16, v70
    v_and_b32 v19, 0xffff0000, v70
    v_add_f32 v116, v116, v18
    v_add_f32 v117, v117, v19
    v_lshlrev_b32 v18, 16, v71
    v_and_b32 v19, 0xffff0000, v71
    v_add_f32 v116, v116, v18
    v_add_f32 v117, v117, v19
L_k1_ws_2:
    s_add_u32 s37, s38, 0
    s_mov_b32 m0, s37
    s_movk_i32 s36, 384
    buffer_load_dwordx4 v2, s[4:7], s36 offen lds
    ds_read_b128 v[96:99], v40
    ds_read_b64_tr_b16 v[64:65], v36 offset:4096
    ds_read_b64_tr_b16 v[66:67], v36 offset:5120
    v_mfma_f32_32x32x16_bf16 v[128:143], v[72:75], v[104:107], v[128:143]
    v_lshlrev_b32 v16, 16, v104
    v_and_b32 v17, 0xffff0000, v104
    v_add_f32 v12, v12, v16
    v_add_f32 v13, v13, v17
    v_fma_f32 v14, v16, v16, v14
    v_fma_f32 v15, v17, v17, v15
    v_lshlrev_b32 v16, 16, v105
    v_and_b32 v17, 0xffff0000, v105
    v_add_f32 v12, v12, v16
    v_add_f32 v13, v13, v17
    v_fma_f32 v14, v16, v16, v14
    v_fma_f32 v15, v17, v17, v15
    s_cmp_lg_u32 s39, 2
    s_cbranch_scc1 L_k1_ws_3
    v_lshlrev_b32 v18, 16, v72
    v_and_b32 v19, 0xffff0000, v72
    v_add_f32 v116, v116, v18
    v_add_f32 v117, v117, v19
    v_lshlrev_b32 v18, 16, v73
    v_and_b32 v19, 0xffff0000, v73
    v_add_f32 v116, v116, v18
    v_add_f32 v117, v117, v19
    v_lshlrev_b32 v18, 16, v74
    v_and_b32 v19, 0xffff0000, v74
    v_add_f32 v116, v116, v18
    v_add_f32 v117, v117, v19
    v_lshlrev_b32 v18, 16, v75
    v_and_b32 v19, 0xffff0000, v75
    v_add_f32 v116, v116, v18
    v_add_f32 v117, v117, v19
L_k1_ws_3:
    s_add_u32 s37, s38, 1024
    s_mov_b32 m0, s37
    s_movk_i32 s36, 384
    buffer_load_dwordx4 v10, s[4:7], s36 offen lds
    ds_read_b128 v[100:103], v41
    ds_read_b64_tr_b16 v[68:69], v36 offset:8192
    ds_read_b64_tr_b16 v[70:71], v36 offset:9216
    v_mfma_f32_32x32x16_bf16 v[128:143], v[76:79], v[108:111], v[128:143]
    v_lshlrev_b32 v16, 16, v108
    v_and_b32 v17, 0xffff0000, v108
    v_add_f32 v12, v12, v16
    v_add_f32 v13, v13, v17
    v_fma_f32 v14, v16, v16, v14
    v_fma_f32 v15, v17, v17, v15
    v_lshlrev_b32 v16, 16, v109
    v_and_b32 v17, 0xffff0000, v109
    v_add_f32 v12, v12, v16
    v_add_f32 v13, v13, v17
    v_fma_f32 v14, v16, v16, v14
    v_fma_f32 v15, v17, v17, v15
    s_cmp_lg_u32 s39, 3
    s_cbranch_scc1 L_k1_ws_4
    v_lshlrev_b32 v18, 16, v76
    v_and_b32 v19, 0xffff0000, v76
    v_add_f32 v116, v116, v18
    v_add_f32 v117, v117, v19
    v_lshlrev_b32 v18, 16, v77
    v_and_b32 v19, 0xffff0000, v77
    v_add_f32 v116, v116, v18
    v_add_f32 v117, v117, v19
    v_lshlrev_b32 v18, 16, v78
    v_and_b32 v19, 0xffff0000, v78
    v_add_f32 v116, v116, v18
    v_add_f32 v117, v117, v19
    v_lshlrev_b32 v18, 16, v79
    v_and_b32 v19, 0xffff0000, v79
    v_add_f32 v116, v116, v18
    v_add_f32 v117, v117, v19
L_k1_ws_4:
    s_add_u32 s36, s34, 589824
    s_add_u32 s37, s35, 0
    s_mov_b32 m0, s37
    s_mov_b64 exec, s[32:33]
    buffer_load_dwordx4 v3, s[8:11], s36 offen lds
    s_mov_b64 exec, -1
    ds_read_b128 v[104:107], v42
    ds_read_b64_tr_b16 v[72:73], v36 offset:12288
    ds_read_b64_tr_b16 v[74:75], v36 offset:13312
    s_waitcnt lgkmcnt(9)
    v_mfma_f32_32x32x16_bf16 v[128:143], v[80:83], v[112:115], v[128:143]
    v_lshlrev_b32 v16, 16, v112
    v_and_b32 v17, 0xffff0000, v112
    v_add_f32 v12, v12, v16
    v_add_f32 v13, v13, v17
    v_fma_f32 v14, v16, v16, v14
    v_fma_f32 v15, v17, v17, v15
    v_lshlrev_b32 v16, 16, v113
    v_and_b32 v17, 0xffff0000, v113
    v_add_f32 v12, v12, v16
    v_add_f32 v13, v13, v17
    v_fma_f32 v14, v16, v16, v14
    v_fma_f32 v15, v17, v17, v15
    s_cmp_lg_u32 s39, 0
    s_cbranch_scc1 L_k1_ws_5
    v_lshlrev_b32 v18, 16, v80
    v_and_b32 v19, 0xffff0000, v80
    v_add_f32 v116, v116, v18
    v_add_f32 v117, v117, v19
    v_lshlrev_b32 v18, 16, v81
    v_and_b32 v19, 0xffff0000, v81
    v_add_f32 v116, v116, v18
    v_add_f32 v117, v117, v19
    v_lshlrev_b32 v18, 16, v82
    v_and_b32 v19, 0xffff0000, v82
    v_add_f32 v116, v116, v18
    v_add_f32 v117, v117, v19
    v_lshlrev_b32 v18, 16, v83
    v_and_b32 v19, 0xffff0000, v83
    v_add_f32 v116, v116, v18
    v_add_f32 v117, v117, v19
L_k1_ws_5:
    s_add_u32 s36, s34, 602112
    s_add_u32 s37, s35, 1024
    s_mov_b32 m0, s37
    s_mov_b64 exec, s[32:33]
    buffer_load_dwordx4 v3, s[8:11], s36 offen lds
    s_mov_b64 exec, -1
    s_waitcnt vmcnt(4)
    s_waitcnt lgkmcnt(0)
    s_barrier
    ds_read_b128 v[108:111], v47
    ds_read_b64_tr_b16 v[76:77], v44 offset:0
    ds_read_b64_tr_b16 v[78:79], v44 offset:1024
    v_mfma_f32_32x32x16_bf16 v[128:143], v[64:67], v[96:99], v[128:143]
    v_lshlrev_b32 v16, 16, v96
    v_and_b32 v17, 0xffff0000, v96
    v_add_f32 v12, v12, v16
    v_add_f32 v13, v13, v17
    v_fma_f32 v14, v16, v16, v14
    v_fma_f32 v15, v17, v17, v15
    v_lshlrev_b32 v16, 16, v97
    v_and_b32 v17, 0xffff0000, v97
    v_add_f32 v12, v12, v16
    v_add_f32 v13, v13, v17
    v_fma_f32 v14, v16, v16, v14
    v_fma_f32 v15, v17, v17, v15
    s_cmp_lg_u32 s39, 1
    s_cbranch_scc1 L_k1_ws_6
    v_lshlrev_b32 v18, 16, v64
    v_and_b32 v19, 0xffff0000, v64
    v_add_f32 v116, v116, v18
    v_add_f32 v117, v117, v19
    v_lshlrev_b32 v18, 16, v65
    v_and_b32 v19, 0xffff0000, v65
    v_add_f32 v116, v116, v18
    v_add_f32 v117, v117, v19
    v_lshlrev_b32 v18, 16, v66
    v_and_b32 v19, 0xffff0000, v66
    v_add_f32 v116, v116, v18
    v_add_f32 v117, v117, v19
    v_lshlrev_b32 v18, 16, v67
    v_and_b32 v19, 0xffff0000, v67
    v_add_f32 v116, v116, v18
    v_add_f32 v117, v117, v19
L_k1_ws_6:
    s_add_u32 s37, s38, 32768
    s_mov_b32 m0, s37
    s_movk_i32 s36, 512
    buffer_load_dwordx4 v2, s[4:7], s36 offen lds
    ds_read_b128 v[112:115], v48
    ds_read_b64_tr_b16 v[80:81], v44 offset:4096
    ds_read_b64_tr_b16 v[82:83], v44 offset:5120
    v_mfma_f32_32x32x16_bf16 v[128:143], v[68:71], v[100:103], v[128:143]
    v_lshlrev_b32 v16, 16, v100
    v_and_b32 v17, 0xffff0000, v100
    v_add_f32 v12, v12, v16
    v_add_f32 v13, v13, v17
    v_fma_f32 v14, v16, v16, v14
    v_fma_f32 v15, v17, v17, v15
    v_lshlrev_b32 v16, 16, v101
    v_and_b32 v17, 0xffff0000, v101
    v_add_f32 v12, v12, v16
    v_add_f32 v13, v13, v17
    v_fma_f32 v14, v16, v16, v14
    v_fma_f32 v15, v17, v17, v15
    s_cmp_lg_u32 s39, 2
    s_cbranch_scc1 L_k1_ws_7
    v_lshlrev_b32 v18, 16, v68
    v_and_b32 v19, 0xffff0000, v68
    v_add_f32 v116, v116, v18
    v_add_f32 v117, v117, v19
    v_lshlrev_b32 v18, 16, v69
    v_and_b32 v19, 0xffff0000, v69
    v_add_f32 v116, v116, v18
    v_add_f32 v117, v117, v19
    v_lshlrev_b32 v18, 16, v70
    v_and_b32 v19, 0xffff0000, v70
    v_add_f32 v116, v116, v18
    v_add_f32 v117, v117, v19
    v_lshlrev_b32 v18, 16, v71
    v_and_b32 v19, 0xffff0000, v71
    v_add_f32 v116, v116, v18
    v_add_f32 v117, v117, v19
L_k1_ws_7:
    s_add_u32 s37, s38, 33792
    s_mov_b32 m0, s37
    s_movk_i32 s36, 512
    buffer_load_dwordx4 v10, s[4:7], s36 offen lds
    ds_read_b128 v[96:99], v49
    ds_read_b64_tr_b16 v[64:65], v44 offset:8192
    ds_read_b64_tr_b16 v[66:67], v44 offset:9216
    v_mfma_f32_32x32x16_bf16 v[128:143], v[72:75], v[104:107], v[128:143]
    v_lshlrev_b32 v16, 16, v104
    v_and_b32 v17, 0xffff0000, v104
    v_add_f32 v12, v12, v16
    v_add_f32 v13, v13, v17
    v_fma_f32 v14, v16, v16, v14
    v_fma_f32 v15, v17, v17, v15
    v_lshlrev_b32 v16, 16, v105
    v_and_b32 v17, 0xffff0000, v105
    v_add_f32 v12, v12, v16
    v_add_f32 v13, v13, v17
    v_fma_f32 v14, v16, v16, v14
    v_fma_f32 v15, v17, v17, v15
    s_cmp_lg_u32 s39, 3
    s_cbranch_scc1 L_k1_ws_8
    v_lshlrev_b32 v18, 16, v72
    v_and_b32 v19, 0xffff0000, v72
    v_add_f32 v116, v116, v18
    v_add_f32 v117, v117, v19
    v_lshlrev_b32 v18, 16, v73
    v_and_b32 v19, 0xffff0000, v73
    v_add_f32 v116, v116, v18
    v_add_f32 v117, v117, v19
    v_lshlrev_b32 v18, 16, v74
    v_and_b32 v19, 0xffff0000, v74
    v_add_f32 v116, v116, v18
    v_add_f32 v117, v117, v19
    v_lshlrev_b32 v18, 16, v75
    v_and_b32 v19, 0xffff0000, v75
    v_add_f32 v116, v116, v18
    v_add_f32 v117, v117, v19
L_k1_ws_8:
    s_add_u32 s36, s34, 786432
    s_add_u32 s37, s35, 32768
    s_mov_b32 m0, s37
    s_mov_b64 exec, s[32:33]
    buffer_load_dwordx4 v3, s[8:11], s36 offen lds
    s_mov_b64 exec, -1
    ds_read_b128 v[100:103], v50
    ds_read_b64_tr_b16 v[68:69], v44 offset:12288
    ds_read_b64_tr_b16 v[70:71], v44 offset:13312
    s_waitcnt lgkmcnt(9)
    v_mfma_f32_32x32x16_bf16 v[128:143], v[76:79], v[108:111], v[128:143]
    v_lshlrev_b32 v16, 16, v108
    v_and_b32 v17, 0xffff0000, v108
    v_add_f32 v12, v12, v16
    v_add_f32 v13, v13, v17
    v_fma_f32 v14, v16, v16, v14
    v_fma_f32 v15, v17, v17, v15
    v_lshlrev_b32 v16, 16, v109
    v_and_b32 v17, 0xffff0000, v109
    v_add_f32 v12, v12, v16
    v_add_f32 v13, v13, v17
    v_fma_f32 v14, v16, v16, v14
    v_fma_f32 v15, v17, v17, v15
    s_cmp_lg_u32 s39, 0
    s_cbranch_scc1 L_k1_ws_9
    v_lshlrev_b32 v18, 16, v76
    v_and_b32 v19, 0xffff0000, v76
    v_add_f32 v116, v116, v18
    v_add_f32 v117, v117, v19
    v_lshlrev_b32 v18, 16, v77
    v_and_b32 v19, 0xffff0000, v77
    v_add_f32 v116, v116, v18
    v_add_f32 v117, v117, v19
    v_lshlrev_b32 v18, 16, v78
    v_and_b32 v19, 0xffff0000, v78
    v_add_f32 v116, v116, v18
    v_add_f32 v117, v117, v19
    v_lshlrev_b32 v18, 16, v79
    v_and_b32 v19, 0xffff0000, v79
    v_add_f32 v116, v116, v18
    v_add_f32 v117, v117, v19
L_k1_ws_9:
    s_add_u32 s36, s34, 798720
    s_add_u32 s37, s35, 33792
    s_mov_b32 m0, s37
    s_mov_b64 exec, s[32:33]
    buffer_load_dwordx4 v3, s[8:11], s36 offen lds
    s_mov_b64 exec, -1
    s_waitcnt vmcnt(4)
    s_waitcnt lgkmcnt(0)
    s_barrier
    ds_read_b128 v[104:107], v31
    ds_read_b64_tr_b16 v[72:73], v28 offset:0
    ds_read_b64_tr_b16 v[74:75], v28 offset:1024
    v_mfma_f32_32x32x16_bf16 v[128:143], v[80:83], v[112:115], v[128:143]
    v_lshlrev_b32 v16, 16, v112
    v_and_b32 v17, 0xffff0000, v112
    v_add_f32 v12, v12, v16
    v_add_f32 v13, v13, v17
    v_fma_f32 v14, v16, v16, v14
    v_fma_f32 v15, v17, v17, v15
    v_lshlrev_b32 v16, 16, v113
    v_and_b32 v17, 0xffff0000, v113
    v_add_f32 v12, v12, v16
    v_add_f32 v13, v13, v17
    v_fma_f32 v14, v16, v16, v14
    v_fma_f32 v15, v17, v17, v15
    s_cmp_lg_u32 s39, 1
    s_cbranch_scc1 L_k1_ws_10
    v_lshlrev_b32 v18, 16, v80
    v_and_b32 v19, 0xffff0000, v80
    v_add_f32 v116, v116, v18
    v_add_f32 v117, v117, v19
    v_lshlrev_b32 v18, 16, v81
    v_and_b32 v19, 0xffff0000, v81
    v_add_f32 v116, v116, v18
    v_add_f32 v117, v117, v19
    v_lshlrev_b32 v18, 16, v82
    v_and_b32 v19, 0xffff0000, v82
    v_add_f32 v116, v116, v18
    v_add_f32 v117, v117, v19
    v_lshlrev_b32 v18, 16, v83
    v_and_b32 v19, 0xffff0000, v83
    v_add_f32 v116, v116, v18
    v_add_f32 v117, v117, v19
L_k1_ws_10:
    s_add_u32 s37, s38, 65536
    s_mov_b32 m0, s37
    s_movk_i32 s36, 640
    buffer_load_dwordx4 v2, s[4:7], s36 offen lds
    ds_read_b128 v[108:111], v32
    ds_read_b64_tr_b16 v[76:77], v28 offset:4096
    ds_read_b64_tr_b16 v[78:79], v28 offset:5120
    v_mfma_f32_32x32x16_bf16 v[128:143], v[64:67], v[96:99], v[128:143]
    v_lshlrev_b32 v16, 16, v96
    v_and_b32 v17, 0xffff0000, v96
    v_add_f32 v12, v12, v16
    v_add_f32 v13, v13, v17
    v_fma_f32 v14, v16, v16, v14
    v_fma_f32 v15, v17, v17, v15
    v_lshlrev_b32 v16, 16, v97
    v_and_b32 v17, 0xffff0000, v97
    v_add_f32 v12, v12, v16
    v_add_f32 v13, v13, v17
    v_fma_f32 v14, v16, v16, v14
    v_fma_f32 v15, v17, v17, v15
    s_cmp_lg_u32 s39, 2
    s_cbranch_scc1 L_k1_ws_11
    v_lshlrev_b32 v18, 16, v64
    v_and_b32 v19, 0xffff0000, v64
    v_add_f32 v116, v116, v18
    v_add_f32 v117, v117, v19
    v_lshlrev_b32 v18, 16, v65
    v_and_b32 v19, 0xffff0000, v65
    v_add_f32 v116, v116, v18
    v_add_f32 v117, v117, v19
    v_lshlrev_b32 v18, 16, v66
    v_and_b32 v19, 0xffff0000, v66
    v_add_f32 v116, v116, v18
    v_add_f32 v117, v117, v19
    v_lshlrev_b32 v18, 16, v67
    v_and_b32 v19, 0xffff0000, v67
    v_add_f32 v116, v116, v18
    v_add_f32 v117, v117, v19
L_k1_ws_11:
    s_add_u32 s37, s38, 66560
    s_mov_b32 m0, s37
    s_movk_i32 s36, 640
    buffer_load_dwordx4 v10, s[4:7], s36 offen lds
    ds_read_b128 v[112:115], v33
    ds_read_b64_tr_b16 v[80:81], v28 offset:8192
    ds_read_b64_tr_b16 v[82:83], v28 offset:9216
    v_mfma_f32_32x32x16_bf16 v[128:143], v[68:71], v[100:103], v[128:143]
    v_lshlrev_b32 v16, 16, v100
    v_and_b32 v17, 0xffff0000, v100
    v_add_f32 v12, v12, v16
    v_add_f32 v13, v13, v17
    v_fma_f32 v14, v16, v16, v14
    v_fma_f32 v15, v17, v17, v15
    v_lshlrev_b32 v16, 16, v101
    v_and_b32 v17, 0xffff0000, v101
    v_add_f32 v12, v12, v16
    v_add_f32 v13, v13, v17
    v_fma_f32 v14, v16, v16, v14
    v_fma_f32 v15, v17, v17, v15
    s_cmp_lg_u32 s39, 3
    s_cbranch_scc1 L_k1_ws_12
    v_lshlrev_b32 v18, 16, v68
    v_and_b32 v19, 0xffff0000, v68
    v_add_f32 v116, v116, v18
    v_add_f32 v117, v117, v19
    v_lshlrev_b32 v18, 16, v69
    v_and_b32 v19, 0xffff0000, v69
    v_add_f32 v116, v116, v18
    v_add_f32 v117, v117, v19
    v_lshlrev_b32 v18, 16, v70
    v_and_b32 v19, 0xffff0000, v70
    v_add_f32 v116, v116, v18
    v_add_f32 v117, v117, v19
    v_lshlrev_b32 v18, 16, v71
    v_and_b32 v19, 0xffff0000, v71
    v_add_f32 v116, v116, v18
    v_add_f32 v117, v117, v19
L_k1_ws_12:
    s_add_u32 s36, s34, 983040
    s_add_u32 s37, s35, 65536
    s_mov_b32 m0, s37
    s_mov_b64 exec, s[32:33]
    buffer_load_dwordx4 v3, s[8:11], s36 offen lds
    s_mov_b64 exec, -1
    ds_read_b128 v[96:99], v34
    ds_read_b64_tr_b16 v[64:65], v28 offset:12288
    ds_read_b64_tr_b16 v[66:67], v28 offset:13312
    s_waitcnt lgkmcnt(9)
    v_mfma_f32_32x32x16_bf16 v[128:143], v[72:75], v[104:107], v[128:143]
    v_lshlrev_b32 v16, 16, v104
    v_and_b32 v17, 0xffff0000, v104
    v_add_f32 v12, v12, v16
    v_add_f32 v13, v13, v17
    v_fma_f32 v14, v16, v16, v14
    v_fma_f32 v15, v17, v17, v15
    v_lshlrev_b32 v16, 16, v105
    v_and_b32 v17, 0xffff0000, v105
    v_add_f32 v12, v12, v16
    v_add_f32 v13, v13, v17
    v_fma_f32 v14, v16, v16, v14
    v_fma_f32 v15, v17, v17, v15
    s_cmp_lg_u32 s39, 0
    s_cbranch_scc1 L_k1_ws_13
    v_lshlrev_b32 v18, 16, v72
    v_and_b32 v19, 0xffff0000, v72
    v_add_f32 v116, v116, v18
    v_add_f32 v117, v117, v19
    v_lshlrev_b32 v18, 16, v73
    v_and_b32 v19, 0xffff0000, v73
    v_add_f32 v116, v116, v18
    v_add_f32 v117, v117, v19
    v_lshlrev_b32 v18, 16, v74
    v_and_b32 v19, 0xffff0000, v74
    v_add_f32 v116, v116, v18
    v_add_f32 v117, v117, v19
    v_lshlrev_b32 v18, 16, v75
    v_and_b32 v19, 0xffff0000, v75
    v_add_f32 v116, v116, v18
    v_add_f32 v117, v117, v19
L_k1_ws_13:
    s_add_u32 s36, s34, 995328
    s_add_u32 s37, s35, 66560
    s_mov_b32 m0, s37
    s_mov_b64 exec, s[32:33]
    buffer_load_dwordx4 v3, s[8:11], s36 offen lds
    s_mov_b64 exec, -1
    s_waitcnt vmcnt(4)
    s_waitcnt lgkmcnt(0)
    s_barrier
    ds_read_b128 v[100:103], v39
    ds_read_b64_tr_b16 v[68:69], v36 offset:0
    ds_read_b64_tr_b16 v[70:71], v36 offset:1024
    v_mfma_f32_32x32x16_bf16 v[128:143], v[76:79], v[108:111], v[128:143]
    v_lshlrev_b32 v16, 16, v108
    v_and_b32 v17, 0xffff0000, v108
    v_add_f32 v12, v12, v16
    v_add_f32 v13, v13, v17
    v_fma_f32 v14, v16, v16, v14
    v_fma_f32 v15, v17, v17, v15
    v_lshlrev_b32 v16, 16, v109
    v_and_b32 v17, 0xffff0000, v109
    v_add_f32 v12, v12, v16
    v_add_f32 v13, v13, v17
    v_fma_f32 v14, v16, v16, v14
    v_fma_f32 v15, v17, v17, v15
    s_cmp_lg_u32 s39, 1
    s_cbranch_scc1 L_k1_ws_14
    v_lshlrev_b32 v18, 16, v76
    v_and_b32 v19, 0xffff0000, v76
    v_add_f32 v116, v116, v18
    v_add_f32 v117, v117, v19
    v_lshlrev_b32 v18, 16, v77
    v_and_b32 v19, 0xffff0000, v77
    v_add_f32 v116, v116, v18
    v_add_f32 v117, v117, v19
    v_lshlrev_b32 v18, 16, v78
    v_and_b32 v19, 0xffff0000, v78
    v_add_f32 v116, v116, v18
    v_add_f32 v117, v117, v19
    v_lshlrev_b32 v18, 16, v79
    v_and_b32 v19, 0xffff0000, v79
    v_add_f32 v116, v116, v18
    v_add_f32 v117, v117, v19
L_k1_ws_14:
    s_add_u32 s37, s38, 0
    s_mov_b32 m0, s37
    s_movk_i32 s36, 768
    buffer_load_dwordx4 v2, s[4:7], s36 offen lds
    ds_read_b128 v[104:107], v40
    ds_read_b64_tr_b16 v[72:73], v36 offset:4096
    ds_read_b64_tr_b16 v[74:75], v36 offset:5120
    v_mfma_f32_32x32x16_bf16 v[128:143], v[80:83], v[112:115], v[128:143]
    v_lshlrev_b32 v16, 16, v112
    v_and_b32 v17, 0xffff0000, v112
    v_add_f32 v12, v12, v16
    v_add_f32 v13, v13, v17
    v_fma_f32 v14, v16, v16, v14
    v_fma_f32 v15, v17, v17, v15
    v_lshlrev_b32 v16, 16, v113
    v_and_b32 v17, 0xffff0000, v113
    v_add_f32 v12, v12, v16
    v_add_f32 v13, v13, v17
    v_fma_f32 v14, v16, v16, v14
    v_fma_f32 v15, v17, v17, v15
    s_cmp_lg_u32 s39, 2
    s_cbranch_scc1 L_k1_ws_15
    v_lshlrev_b32 v18, 16, v80
    v_and_b32 v19, 0xffff0000, v80
    v_add_f32 v116, v116, v18
    v_add_f32 v117, v117, v19
    v_lshlrev_b32 v18, 16, v81
    v_and_b32 v19, 0xffff0000, v81
    v_add_f32 v116, v116, v18
    v_add_f32 v117, v117, v19
    v_lshlrev_b32 v18, 16, v82
    v_and_b32 v19, 0xffff0000, v82
    v_add_f32 v116, v116, v18
    v_add_f32 v117, v117, v19
    v_lshlrev_b32 v18, 16, v83
    v_and_b32 v19, 0xffff0000, v83
    v_add_f32 v116, v116, v18
    v_add_f32 v117, v117, v19
L_k1_ws_15:
    s_add_u32 s37, s38, 1024
    s_mov_b32 m0, s37
    s_movk_i32 s36, 768
    buffer_load_dwordx4 v10, s[4:7], s36 offen lds
    ds_read_b128 v[108:111], v41
    ds_read_b64_tr_b16 v[76:77], v36 offset:8192
    ds_read_b64_tr_b16 v[78:79], v36 offset:9216
    v_mfma_f32_32x32x16_bf16 v[128:143], v[64:67], v[96:99], v[128:143]
    v_lshlrev_b32 v16, 16, v96
    v_and_b32 v17, 0xffff0000, v96
    v_add_f32 v12, v12, v16
    v_add_f32 v13, v13, v17
    v_fma_f32 v14, v16, v16, v14
    v_fma_f32 v15, v17, v17, v15
    v_lshlrev_b32 v16, 16, v97
    v_and_b32 v17, 0xffff0000, v97
    v_add_f32 v12, v12, v16
    v_add_f32 v13, v13, v17
    v_fma_f32 v14, v16, v16, v14
    v_fma_f32 v15, v17, v17, v15
    s_cmp_lg_u32 s39, 3
    s_cbranch_scc1 L_k1_ws_16
    v_lshlrev_b32 v18, 16, v64
    v_and_b32 v19, 0xffff0000, v64
    v_add_f32 v116, v116, v18
    v_add_f32 v117, v117, v19
    v_lshlrev_b32 v18, 16, v65
    v_and_b32 v19, 0xffff0000, v65
    v_add_f32 v116, v116, v18
    v_add_f32 v117, v117, v19
    v_lshlrev_b32 v18, 16, v66
    v_and_b32 v19, 0xffff0000, v66
    v_add_f32 v116, v116, v18
    v_add_f32 v117, v117, v19
    v_lshlrev_b32 v18, 16, v67
    v_and_b32 v19, 0xffff0000, v67
    v_add_f32 v116, v116, v18
    v_add_f32 v117, v117, v19
L_k1_ws_16:
    s_add_u32 s36, s34, 1179648
    s_add_u32 s37, s35, 0
    s_mov_b32 m0, s37
    s_mov_b64 exec, s[32:33]
    buffer_load_dwordx4 v3, s[8:11], s36 offen lds
    s_mov_b64 exec, -1
    ds_read_b128 v[112:115], v42
    ds_read_b64_tr_b16 v[80:81], v36 offset:12288
    ds_read_b64_tr_b16 v[82:83], v36 offset:13312
    s_waitcnt lgkmcnt(9)
    v_mfma_f32_32x32x16_bf16 v[128:143], v[68:71], v[100:103], v[128:143]
    v_lshlrev_b32 v16, 16, v100
    v_and_b32 v17, 0xffff0000, v100
    v_add_f32 v12, v12, v16
    v_add_f32 v13, v13, v17
    v_fma_f32 v14, v16, v16, v14
    v_fma_f32 v15, v17, v17, v15
    v_lshlrev_b32 v16, 16, v101
    v_and_b32 v17, 0xffff0000, v101
    v_add_f32 v12, v12, v16
    v_add_f32 v13, v13, v17
    v_fma_f32 v14, v16, v16, v14
    v_fma_f32 v15, v17, v17, v15
    s_cmp_lg_u32 s39, 0
    s_cbranch_scc1 L_k1_ws_17
    v_lshlrev_b32 v18, 16, v68
    v_and_b32 v19, 0xffff0000, v68
    v_add_f32 v116, v116, v18
    v_add_f32 v117, v117, v19
    v_lshlrev_b32 v18, 16, v69
    v_and_b32 v19, 0xffff0000, v69
    v_add_f32 v116, v116, v18
    v_add_f32 v117, v117, v19
    v_lshlrev_b32 v18, 16, v70
    v_and_b32 v19, 0xffff0000, v70
    v_add_f32 v116, v116, v18
    v_add_f32 v117, v117, v19
    v_lshlrev_b32 v18, 16, v71
    v_and_b32 v19, 0xffff0000, v71
    v_add_f32 v116, v116, v18
    v_add_f32 v117, v117, v19
L_k1_ws_17:
    s_add_u32 s36, s34, 1191936
    s_add_u32 s37, s35, 1024
    s_mov_b32 m0, s37
    s_mov_b64 exec, s[32:33]
    buffer_load_dwordx4 v3, s[8:11], s36 offen lds
    s_mov_b64 exec, -1
    s_waitcnt vmcnt(4)
    s_waitcnt lgkmcnt(0)
    s_barrier
    ds_read_b128 v[96:99], v47
    ds_read_b64_tr_b16 v[64:65], v44 offset:0
    ds_read_b64_tr_b16 v[66:67], v44 offset:1024
    v_mfma_f32_32x32x16_bf16 v[128:143], v[72:75], v[104:107], v[128:143]
    v_lshlrev_b32 v16, 16, v104
    v_and_b32 v17, 0xffff0000, v104
    v_add_f32 v12, v12, v16
    v_add_f32 v13, v13, v17
    v_fma_f32 v14, v16, v16, v14
    v_fma_f32 v15, v17, v17, v15
    v_lshlrev_b32 v16, 16, v105
    v_and_b32 v17, 0xffff0000, v105
    v_add_f32 v12, v12, v16
    v_add_f32 v13, v13, v17
    v_fma_f32 v14, v16, v16, v14
    v_fma_f32 v15, v17, v17, v15
    s_cmp_lg_u32 s39, 1
    s_cbranch_scc1 L_k1_ws_18
    v_lshlrev_b32 v18, 16, v72
    v_and_b32 v19, 0xffff0000, v72
    v_add_f32 v116, v116, v18
    v_add_f32 v117, v117, v19
    v_lshlrev_b32 v18, 16, v73
    v_and_b32 v19, 0xffff0000, v73
    v_add_f32 v116, v116, v18
    v_add_f32 v117, v117, v19
    v_lshlrev_b32 v18, 16, v74
    v_and_b32 v19, 0xffff0000, v74
    v_add_f32 v116, v116, v18
    v_add_f32 v117, v117, v19
    v_lshlrev_b32 v18, 16, v75
    v_and_b32 v19, 0xffff0000, v75
    v_add_f32 v116, v116, v18
    v_add_f32 v117, v117, v19
L_k1_ws_18:
    s_add_u32 s37, s38, 32768
    s_mov_b32 m0, s37
    s_movk_i32 s36, 896
    buffer_load_dwordx4 v2, s[4:7], s36 offen lds
    ds_read_b128 v[100:103], v48
    ds_read_b64_tr_b16 v[68:69], v44 offset:4096
    ds_read_b64_tr_b16 v[70:71], v44 offset:5120
    v_mfma_f32_32x32x16_bf16 v[128:143], v[76:79], v[108:111], v[128:143]
    v_lshlrev_b32 v16, 16, v108
    v_and_b32 v17, 0xffff0000, v108
    v_add_f32 v12, v12, v16
    v_add_f32 v13, v13, v17
    v_fma_f32 v14, v16, v16, v14
    v_fma_f32 v15, v17, v17, v15
    v_lshlrev_b32 v16, 16, v109
    v_and_b32 v17, 0xffff0000, v109
    v_add_f32 v12, v12, v16
    v_add_f32 v13, v13, v17
    v_fma_f32 v14, v16, v16, v14
    v_fma_f32 v15, v17, v17, v15
    s_cmp_lg_u32 s39, 2
    s_cbranch_scc1 L_k1_ws_19
    v_lshlrev_b32 v18, 16, v76
    v_and_b32 v19, 0xffff0000, v76
    v_add_f32 v116, v116, v18
    v_add_f32 v117, v117, v19
    v_lshlrev_b32 v18, 16, v77
    v_and_b32 v19, 0xffff0000, v77
    v_add_f32 v116, v116, v18
    v_add_f32 v117, v117, v19
    v_lshlrev_b32 v18, 16, v78
    v_and_b32 v19, 0xffff0000, v78
    v_add_f32 v116, v116, v18
    v_add_f32 v117, v117, v19
    v_lshlrev_b32 v18, 16, v79
    v_and_b32 v19, 0xffff0000, v79
    v_add_f32 v116, v116, v18
    v_add_f32 v117, v117, v19
L_k1_ws_19:
    s_add_u32 s37, s38, 33792
    s_mov_b32 m0, s37
    s_movk_i32 s36, 896
    buffer_load_dwordx4 v10, s[4:7], s36 offen lds
    ds_read_b128 v[104:107], v49
    ds_read_b64_tr_b16 v[72:73], v44 offset:8192
    ds_read_b64_tr_b16 v[74:75], v44 offset:9216
    v_mfma_f32_32x32x16_bf16 v[128:143], v[80:83], v[112:115], v[128:143]
    v_lshlrev_b32 v16, 16, v112
    v_and_b32 v17, 0xffff0000, v112
    v_add_f32 v12, v12, v16
    v_add_f32 v13, v13, v17
    v_fma_f32 v14, v16, v16, v14
    v_fma_f32 v15, v17, v17, v15
    v_lshlrev_b32 v16, 16, v113
    v_and_b32 v17, 0xffff0000, v113
    v_add_f32 v12, v12, v16
    v_add_f32 v13, v13, v17
    v_fma_f32 v14, v16, v16, v14
    v_fma_f32 v15, v17, v17, v15
    s_cmp_lg_u32 s39, 3
    s_cbranch_scc1 L_k1_ws_20
    v_lshlrev_b32 v18, 16, v80
    v_and_b32 v19, 0xffff0000, v80
    v_add_f32 v116, v116, v18
    v_add_f32 v117, v117, v19
    v_lshlrev_b32 v18, 16, v81
    v_and_b32 v19, 0xffff0000, v81
    v_add_f32 v116, v116, v18
    v_add_f32 v117, v117, v19
    v_lshlrev_b32 v18, 16, v82
    v_and_b32 v19, 0xffff0000, v82
    v_add_f32 v116, v116, v18
    v_add_f32 v117, v117, v19
    v_lshlrev_b32 v18, 16, v83
    v_and_b32 v19, 0xffff0000, v83
    v_add_f32 v116, v116, v18
    v_add_f32 v117, v117, v19
L_k1_ws_20:
    s_add_u32 s36, s34, 1376256
    s_add_u32 s37, s35, 32768
    s_mov_b32 m0, s37
    s_mov_b64 exec, s[32:33]
    buffer_load_dwordx4 v3, s[8:11], s36 offen lds
    s_mov_b64 exec, -1
    ds_read_b128 v[108:111], v50
    ds_read_b64_tr_b16 v[76:77], v44 offset:12288
    ds_read_b64_tr_b16 v[78:79], v44 offset:13312
    s_waitcnt lgkmcnt(9)
    v_mfma_f32_32x32x16_bf16 v[128:143], v[64:67], v[96:99], v[128:143]
    v_lshlrev_b32 v16, 16, v96
    v_and_b32 v17, 0xffff0000, v96
    v_add_f32 v12, v12, v16
    v_add_f32 v13, v13, v17
    v_fma_f32 v14, v16, v16, v14
    v_fma_f32 v15, v17, v17, v15
    v_lshlrev_b32 v16, 16, v97
    v_and_b32 v17, 0xffff0000, v97
    v_add_f32 v12, v12, v16
    v_add_f32 v13, v13, v17
    v_fma_f32 v14, v16, v16, v14
    v_fma_f32 v15, v17, v17, v15
    s_cmp_lg_u32 s39, 0
    s_cbranch_scc1 L_k1_ws_21
    v_lshlrev_b32 v18, 16, v64
    v_and_b32 v19, 0xffff0000, v64
    v_add_f32 v116, v116, v18
    v_add_f32 v117, v117, v19
    v_lshlrev_b32 v18, 16, v65
    v_and_b32 v19, 0xffff0000, v65
    v_add_f32 v116, v116, v18
    v_add_f32 v117, v117, v19
    v_lshlrev_b32 v18, 16, v66
    v_and_b32 v19, 0xffff0000, v66
    v_add_f32 v116, v116, v18
    v_add_f32 v117, v117, v19
    v_lshlrev_b32 v18, 16, v67
    v_and_b32 v19, 0xffff0000, v67
    v_add_f32 v116, v116, v18
    v_add_f32 v117, v117, v19
L_k1_ws_21:
    s_add_u32 s36, s34, 1388544
    s_add_u32 s37, s35, 33792
    s_mov_b32 m0, s37
    s_mov_b64 exec, s[32:33]
    buffer_load_dwordx4 v3, s[8:11], s36 offen lds
    s_mov_b64 exec, -1
    s_waitcnt vmcnt(4)
    s_waitcnt lgkmcnt(0)
    s_barrier
    ds_read_b128 v[112:115], v31
    ds_read_b64_tr_b16 v[80:81], v28 offset:0
    ds_read_b64_tr_b16 v[82:83], v28 offset:1024
    v_mfma_f32_32x32x16_bf16 v[128:143], v[68:71], v[100:103], v[128:143]
    v_lshlrev_b32 v16, 16, v100
    v_and_b32 v17, 0xffff0000, v100
    v_add_f32 v12, v12, v16
    v_add_f32 v13, v13, v17
    v_fma_f32 v14, v16, v16, v14
    v_fma_f32 v15, v17, v17, v15
    v_lshlrev_b32 v16, 16, v101
    v_and_b32 v17, 0xffff0000, v101
    v_add_f32 v12, v12, v16
    v_add_f32 v13, v13, v17
    v_fma_f32 v14, v16, v16, v14
    v_fma_f32 v15, v17, v17, v15
    s_cmp_lg_u32 s39, 1
    s_cbranch_scc1 L_k1_ws_22
    v_lshlrev_b32 v18, 16, v68
    v_and_b32 v19, 0xffff0000, v68
    v_add_f32 v116, v116, v18
    v_add_f32 v117, v117, v19
    v_lshlrev_b32 v18, 16, v69
    v_and_b32 v19, 0xffff0000, v69
    v_add_f32 v116, v116, v18
    v_add_f32 v117, v117, v19
    v_lshlrev_b32 v18, 16, v70
    v_and_b32 v19, 0xffff0000, v70
    v_add_f32 v116, v116, v18
    v_add_f32 v117, v117, v19
    v_lshlrev_b32 v18, 16, v71
    v_and_b32 v19, 0xffff0000, v71
    v_add_f32 v116, v116, v18
    v_add_f32 v117, v117, v19
L_k1_ws_22:
    ds_read_b128 v[96:99], v32
    ds_read_b64_tr_b16 v[64:65], v28 offset:4096
    ds_read_b64_tr_b16 v[66:67], v28 offset:5120
    v_mfma_f32_32x32x16_bf16 v[128:143], v[72:75], v[104:107], v[128:143]
    v_lshlrev_b32 v16, 16, v104
    v_and_b32 v17, 0xffff0000, v104
    v_add_f32 v12, v12, v16
    v_add_f32 v13, v13, v17
    v_fma_f32 v14, v16, v16, v14
    v_fma_f32 v15, v17, v17, v15
    v_lshlrev_b32 v16, 16, v105
    v_and_b32 v17, 0xffff0000, v105
    v_add_f32 v12, v12, v16
    v_add_f32 v13, v13, v17
    v_fma_f32 v14, v16, v16, v14
    v_fma_f32 v15, v17, v17, v15
    s_cmp_lg_u32 s39, 2
    s_cbranch_scc1 L_k1_ws_23
    v_lshlrev_b32 v18, 16, v72
    v_and_b32 v19, 0xffff0000, v72
    v_add_f32 v116, v116, v18
    v_add_f32 v117, v117, v19
    v_lshlrev_b32 v18, 16, v73
    v_and_b32 v19, 0xffff0000, v73
    v_add_f32 v116, v116, v18
    v_add_f32 v117, v117, v19
    v_lshlrev_b32 v18, 16, v74
    v_and_b32 v19, 0xffff0000, v74
    v_add_f32 v116, v116, v18
    v_add_f32 v117, v117, v19
    v_lshlrev_b32 v18, 16, v75
    v_and_b32 v19, 0xffff0000, v75
    v_add_f32 v116, v116, v18
    v_add_f32 v117, v117, v19
L_k1_ws_23:
    ds_read_b128 v[100:103], v33
    ds_read_b64_tr_b16 v[68:69], v28 offset:8192
    ds_read_b64_tr_b16 v[70:71], v28 offset:9216
    v_mfma_f32_32x32x16_bf16 v[128:143], v[76:79], v[108:111], v[128:143]
    v_lshlrev_b32 v16, 16, v108
    v_and_b32 v17, 0xffff0000, v108
    v_add_f32 v12, v12, v16
    v_add_f32 v13, v13, v17
    v_fma_f32 v14, v16, v16, v14
    v_fma_f32 v15, v17, v17, v15
    v_lshlrev_b32 v16, 16, v109
    v_and_b32 v17, 0xffff0000, v109
    v_add_f32 v12, v12, v16
    v_add_f32 v13, v13, v17
    v_fma_f32 v14, v16, v16, v14
    v_fma_f32 v15, v17, v17, v15
    s_cmp_lg_u32 s39, 3
    s_cbranch_scc1 L_k1_ws_24
    v_lshlrev_b32 v18, 16, v76
    v_and_b32 v19, 0xffff0000, v76
    v_add_f32 v116, v116, v18
    v_add_f32 v117, v117, v19
    v_lshlrev_b32 v18, 16, v77
    v_and_b32 v19, 0xffff0000, v77
    v_add_f32 v116, v116, v18
    v_add_f32 v117, v117, v19
    v_lshlrev_b32 v18, 16, v78
    v_and_b32 v19, 0xffff0000, v78
    v_add_f32 v116, v116, v18
    v_add_f32 v117, v117, v19
    v_lshlrev_b32 v18, 16, v79
    v_and_b32 v19, 0xffff0000, v79
    v_add_f32 v116, v116, v18
    v_add_f32 v117, v117, v19
L_k1_ws_24:
    ds_read_b128 v[104:107], v34
    ds_read_b64_tr_b16 v[72:73], v28 offset:12288
    ds_read_b64_tr_b16 v[74:75], v28 offset:13312
    s_waitcnt lgkmcnt(9)
    v_mfma_f32_32x32x16_bf16 v[128:143], v[80:83], v[112:115], v[128:143]
    v_lshlrev_b32 v16, 16, v112
    v_and_b32 v17, 0xffff0000, v112
    v_add_f32 v12, v12, v16
    v_add_f32 v13, v13, v17
    v_fma_f32 v14, v16, v16, v14
    v_fma_f32 v15, v17, v17, v15
    v_lshlrev_b32 v16, 16, v113
    v_and_b32 v17, 0xffff0000, v113
    v_add_f32 v12, v12, v16
    v_add_f32 v13, v13, v17
    v_fma_f32 v14, v16, v16, v14
    v_fma_f32 v15, v17, v17, v15
    s_cmp_lg_u32 s39, 0
    s_cbranch_scc1 L_k1_ws_25
    v_lshlrev_b32 v18, 16, v80
    v_and_b32 v19, 0xffff0000, v80
    v_add_f32 v116, v116, v18
    v_add_f32 v117, v117, v19
    v_lshlrev_b32 v18, 16, v81
    v_and_b32 v19, 0xffff0000, v81
    v_add_f32 v116, v116, v18
    v_add_f32 v117, v117, v19
    v_lshlrev_b32 v18, 16, v82
    v_and_b32 v19, 0xffff0000, v82
    v_add_f32 v116, v116, v18
    v_add_f32 v117, v117, v19
    v_lshlrev_b32 v18, 16, v83
    v_and_b32 v19, 0xffff0000, v83
    v_add_f32 v116, v116, v18
    v_add_f32 v117, v117, v19
L_k1_ws_25:
    s_waitcnt vmcnt(0)
    s_waitcnt lgkmcnt(0)
    s_barrier
    ds_read_b128 v[108:111], v39
    ds_read_b64_tr_b16 v[76:77], v36 offset:0
    ds_read_b64_tr_b16 v[78:79], v36 offset:1024
    v_mfma_f32_32x32x16_bf16 v[128:143], v[64:67], v[96:99], v[128:143]
    v_lshlrev_b32 v16, 16, v96
    v_and_b32 v17, 0xffff0000, v96
    v_add_f32 v12, v12, v16
    v_add_f32 v13, v13, v17
    v_fma_f32 v14, v16, v16, v14
    v_fma_f32 v15, v17, v17, v15
    v_lshlrev_b32 v16, 16, v97
    v_and_b32 v17, 0xffff0000, v97
    v_add_f32 v12, v12, v16
    v_add_f32 v13, v13, v17
    v_fma_f32 v14, v16, v16, v14
    v_fma_f32 v15, v17, v17, v15
    s_cmp_lg_u32 s39, 1
    s_cbranch_scc1 L_k1_ws_26
    v_lshlrev_b32 v18, 16, v64
    v_and_b32 v19, 0xffff0000, v64
    v_add_f32 v116, v116, v18
    v_add_f32 v117, v117, v19
    v_lshlrev_b32 v18, 16, v65
    v_and_b32 v19, 0xffff0000, v65
    v_add_f32 v116, v116, v18
    v_add_f32 v117, v117, v19
    v_lshlrev_b32 v18, 16, v66
    v_and_b32 v19, 0xffff0000, v66
    v_add_f32 v116, v116, v18
    v_add_f32 v117, v117, v19
    v_lshlrev_b32 v18, 16, v67
    v_and_b32 v19, 0xffff0000, v67
    v_add_f32 v116, v116, v18
    v_add_f32 v117, v117, v19
L_k1_ws_26:
    ds_read_b128 v[112:115], v40
    ds_read_b64_tr_b16 v[80:81], v36 offset:4096
    ds_read_b64_tr_b16 v[82:83], v36 offset:5120
    v_mfma_f32_32x32x16_bf16 v[128:143], v[68:71], v[100:103], v[128:143]
    v_lshlrev_b32 v16, 16, v100
    v_and_b32 v17, 0xffff0000, v100
    v_add_f32 v12, v12, v16
    v_add_f32 v13, v13, v17
    v_fma_f32 v14, v16, v16, v14
    v_fma_f32 v15, v17, v17, v15
    v_lshlrev_b32 v16, 16, v101
    v_and_b32 v17, 0xffff0000, v101
    v_add_f32 v12, v12, v16
    v_add_f32 v13, v13, v17
    v_fma_f32 v14, v16, v16, v14
    v_fma_f32 v15, v17, v17, v15
    s_cmp_lg_u32 s39, 2
    s_cbranch_scc1 L_k1_ws_27
    v_lshlrev_b32 v18, 16, v68
    v_and_b32 v19, 0xffff0000, v68
    v_add_f32 v116, v116, v18
    v_add_f32 v117, v117, v19
    v_lshlrev_b32 v18, 16, v69
    v_and_b32 v19, 0xffff0000, v69
    v_add_f32 v116, v116, v18
    v_add_f32 v117, v117, v19
    v_lshlrev_b32 v18, 16, v70
    v_and_b32 v19, 0xffff0000, v70
    v_add_f32 v116, v116, v18
    v_add_f32 v117, v117, v19
    v_lshlrev_b32 v18, 16, v71
    v_and_b32 v19, 0xffff0000, v71
    v_add_f32 v116, v116, v18
    v_add_f32 v117, v117, v19
L_k1_ws_27:
    ds_read_b128 v[96:99], v41
    ds_read_b64_tr_b16 v[64:65], v36 offset:8192
    ds_read_b64_tr_b16 v[66:67], v36 offset:9216
    v_mfma_f32_32x32x16_bf16 v[128:143], v[72:75], v[104:107], v[128:143]
    v_lshlrev_b32 v16, 16, v104
    v_and_b32 v17, 0xffff0000, v104
    v_add_f32 v12, v12, v16
    v_add_f32 v13, v13, v17
    v_fma_f32 v14, v16, v16, v14
    v_fma_f32 v15, v17, v17, v15
    v_lshlrev_b32 v16, 16, v105
    v_and_b32 v17, 0xffff0000, v105
    v_add_f32 v12, v12, v16
    v_add_f32 v13, v13, v17
    v_fma_f32 v14, v16, v16, v14
    v_fma_f32 v15, v17, v17, v15
    s_cmp_lg_u32 s39, 3
    s_cbranch_scc1 L_k1_ws_28
    v_lshlrev_b32 v18, 16, v72
    v_and_b32 v19, 0xffff0000, v72
    v_add_f32 v116, v116, v18
    v_add_f32 v117, v117, v19
    v_lshlrev_b32 v18, 16, v73
    v_and_b32 v19, 0xffff0000, v73
    v_add_f32 v116, v116, v18
    v_add_f32 v117, v117, v19
    v_lshlrev_b32 v18, 16, v74
    v_and_b32 v19, 0xffff0000, v74
    v_add_f32 v116, v116, v18
    v_add_f32 v117, v117, v19
    v_lshlrev_b32 v18, 16, v75
    v_and_b32 v19, 0xffff0000, v75
    v_add_f32 v116, v116, v18
    v_add_f32 v117, v117, v19
L_k1_ws_28:
    ds_read_b128 v[100:103], v42
    ds_read_b64_tr_b16 v[68:69], v36 offset:12288
    ds_read_b64_tr_b16 v[70:71], v36 offset:13312
    s_waitcnt lgkmcnt(9)
    v_mfma_f32_32x32x16_bf16 v[128:143], v[76:79], v[108:111], v[128:143]
    v_lshlrev_b32 v16, 16, v108
    v_and_b32 v17, 0xffff0000, v108
    v_add_f32 v12, v12, v16
    v_add_f32 v13, v13, v17
    v_fma_f32 v14, v16, v16, v14
    v_fma_f32 v15, v17, v17, v15
    v_lshlrev_b32 v16, 16, v109
    v_and_b32 v17, 0xffff0000, v109
    v_add_f32 v12, v12, v16
    v_add_f32 v13, v13, v17
    v_fma_f32 v14, v16, v16, v14
    v_fma_f32 v15, v17, v17, v15
    s_cmp_lg_u32 s39, 0
    s_cbranch_scc1 L_k1_ws_29
    v_lshlrev_b32 v18, 16, v76
    v_and_b32 v19, 0xffff0000, v76
    v_add_f32 v116, v116, v18
    v_add_f32 v117, v117, v19
    v_lshlrev_b32 v18, 16, v77
    v_and_b32 v19, 0xffff0000, v77
    v_add_f32 v116, v116, v18
    v_add_f32 v117, v117, v19
    v_lshlrev_b32 v18, 16, v78
    v_and_b32 v19, 0xffff0000, v78
    v_add_f32 v116, v116, v18
    v_add_f32 v117, v117, v19
    v_lshlrev_b32 v18, 16, v79
    v_and_b32 v19, 0xffff0000, v79
    v_add_f32 v116, v116, v18
    v_add_f32 v117, v117, v19
L_k1_ws_29:
    s_waitcnt lgkmcnt(6)
    v_mfma_f32_32x32x16_bf16 v[128:143], v[80:83], v[112:115], v[128:143]
    v_lshlrev_b32 v16, 16, v112
    v_and_b32 v17, 0xffff0000, v112
    v_add_f32 v12, v12, v16
    v_add_f32 v13, v13, v17
    v_fma_f32 v14, v16, v16, v14
    v_fma_f32 v15, v17, v17, v15
    v_lshlrev_b32 v16, 16, v113
    v_and_b32 v17, 0xffff0000, v113
    v_add_f32 v12, v12, v16
    v_add_f32 v13, v13, v17
    v_fma_f32 v14, v16, v16, v14
    v_fma_f32 v15, v17, v17, v15
    s_cmp_lg_u32 s39, 1
    s_cbranch_scc1 L_k1_ws_30
    v_lshlrev_b32 v18, 16, v80
    v_and_b32 v19, 0xffff0000, v80
    v_add_f32 v116, v116, v18
    v_add_f32 v117, v117, v19
    v_lshlrev_b32 v18, 16, v81
    v_and_b32 v19, 0xffff0000, v81
    v_add_f32 v116, v116, v18
    v_add_f32 v117, v117, v19
    v_lshlrev_b32 v18, 16, v82
    v_and_b32 v19, 0xffff0000, v82
    v_add_f32 v116, v116, v18
    v_add_f32 v117, v117, v19
    v_lshlrev_b32 v18, 16, v83
    v_and_b32 v19, 0xffff0000, v83
    v_add_f32 v116, v116, v18
    v_add_f32 v117, v117, v19
L_k1_ws_30:
    s_waitcnt lgkmcnt(3)
    v_mfma_f32_32x32x16_bf16 v[128:143], v[64:67], v[96:99], v[128:143]
    v_lshlrev_b32 v16, 16, v96
    v_and_b32 v17, 0xffff0000, v96
    v_add_f32 v12, v12, v16
    v_add_f32 v13, v13, v17
    v_fma_f32 v14, v16, v16, v14
    v_fma_f32 v15, v17, v17, v15
    v_lshlrev_b32 v16, 16, v97
    v_and_b32 v17, 0xffff0000, v97
    v_add_f32 v12, v12, v16
    v_add_f32 v13, v13, v17
    v_fma_f32 v14, v16, v16, v14
    v_fma_f32 v15, v17, v17, v15
    s_cmp_lg_u32 s39, 2
    s_cbranch_scc1 L_k1_ws_31
    v_lshlrev_b32 v18, 16, v64
    v_and_b32 v19, 0xffff0000, v64
    v_add_f32 v116, v116, v18
    v_add_f32 v117, v117, v19
    v_lshlrev_b32 v18, 16, v65
    v_and_b32 v19, 0xffff0000, v65
    v_add_f32 v116, v116, v18
    v_add_f32 v117, v117, v19
    v_lshlrev_b32 v18, 16, v66
    v_and_b32 v19, 0xffff0000, v66
    v_add_f32 v116, v116, v18
    v_add_f32 v117, v117, v19
    v_lshlrev_b32 v18, 16, v67
    v_and_b32 v19, 0xffff0000, v67
    v_add_f32 v116, v116, v18
    v_add_f32 v117, v117, v19
L_k1_ws_31:
    s_waitcnt lgkmcnt(0)
    v_mfma_f32_32x32x16_bf16 v[128:143], v[68:71], v[100:103], v[128:143]
    v_lshlrev_b32 v16, 16, v100
    v_and_b32 v17, 0xffff0000, v100
    v_add_f32 v12, v12, v16
    v_add_f32 v13, v13, v17
    v_fma_f32 v14, v16, v16, v14
    v_fma_f32 v15, v17, v17, v15
    v_lshlrev_b32 v16, 16, v101
    v_and_b32 v17, 0xffff0000, v101
    v_add_f32 v12, v12, v16
    v_add_f32 v13, v13, v17
    v_fma_f32 v14, v16, v16, v14
    v_fma_f32 v15, v17, v17, v15
    s_cmp_lg_u32 s39, 3
    s_cbranch_scc1 L_k1_ws_32
    v_lshlrev_b32 v18, 16, v68
    v_and_b32 v19, 0xffff0000, v68
    v_add_f32 v116, v116, v18
    v_add_f32 v117, v117, v19
    v_lshlrev_b32 v18, 16, v69
    v_and_b32 v19, 0xffff0000, v69
    v_add_f32 v116, v116, v18
    v_add_f32 v117, v117, v19
    v_lshlrev_b32 v18, 16, v70
    v_and_b32 v19, 0xffff0000, v70
    v_add_f32 v116, v116, v18
    v_add_f32 v117, v117, v19
    v_lshlrev_b32 v18, 16, v71
    v_and_b32 v19, 0xffff0000, v71
    v_add_f32 v116, v116, v18
    v_add_f32 v117, v117, v19
L_k1_ws_32:
    v_add_f32 v12, v12, v13
    v_add_f32 v13, v14, v15
    s_lshl_b32 s30, s39, 10
    v_lshlrev_b32 v16, 3, v1
    v_add_u32 v16, s30, v16
    v_add_u32 v17, 99328, v16
    v_add_u32 v16, 99840, v16
    ds_write_b64 v17, v[12:13]
    v_add_f32 v116, v116, v117
    v_mov_b32 v18, v116
    s_nop 1
    v_permlane32_swap_b32 v116, v18
    v_add_f32 v116, v116, v18
    v_and_b32 v18, 31, v1
    v_lshlrev_b32 v18, 2, v18
    s_mul_i32 s30, s39, 384
    v_add_u32 v18, s30, v18
    v_add_u32 v18, 103424, v18
    ds_write_b32 v18, v116 offset:0
    s_waitcnt lgkmcnt(0)
    s_barrier
    ds_read_b64 v[14:15], v16
    v_lshrrev_b32 v18, 5, v1
    v_lshlrev_b32 v18, 4, v18
    v_add_u32 v18, 103424, v18
    ds_read_b128 v[160:163], v18 offset:0
    ds_read_b128 v[164:167], v18 offset:32
    ds_read_b128 v[168:171], v18 offset:64
    ds_read_b128 v[172:175], v18 offset:96
    ds_read_b128 v[224:227], v18 offset:384
    ds_read_b128 v[228:231], v18 offset:416
    ds_read_b128 v[232:235], v18 offset:448
    ds_read_b128 v[236:239], v18 offset:480
    s_waitcnt lgkmcnt(0)
    v_add_f32 v160, v160, v224
    v_add_f32 v161, v161, v225
    v_add_f32 v162, v162, v226
    v_add_f32 v163, v163, v227
    v_add_f32 v164, v164, v228
    v_add_f32 v165, v165, v229
    v_add_f32 v166, v166, v230
    v_add_f32 v167, v167, v231
    v_add_f32 v168, v168, v232
    v_add_f32 v169, v169, v233
    v_add_f32 v170, v170, v234
    v_add_f32 v171, v171, v235
    v_add_f32 v172, v172, v236
    v_add_f32 v173, v173, v237
    v_add_f32 v174, v174, v238
    v_add_f32 v175, v175, v239
    ds_read_b128 v[224:227], v18 offset:768
    ds_read_b128 v[228:231], v18 offset:800
    ds_read_b128 v[232:235], v18 offset:832
    ds_read_b128 v[236:239], v18 offset:864
    s_waitcnt lgkmcnt(0)
    v_add_f32 v160, v160, v224
    v_add_f32 v161, v161, v225
    v_add_f32 v162, v162, v226
    v_add_f32 v163, v163, v227
    v_add_f32 v164, v164, v228
    v_add_f32 v165, v165, v229
    v_add_f32 v166, v166, v230
    v_add_f32 v167, v167, v231
    v_add_f32 v168, v168, v232
    v_add_f32 v169, v169, v233
    v_add_f32 v170, v170, v234
    v_add_f32 v171, v171, v235
    v_add_f32 v172, v172, v236
    v_add_f32 v173, v173, v237
    v_add_f32 v174, v174, v238
    v_add_f32 v175, v175, v239
    ds_read_b128 v[224:227], v18 offset:1152
    ds_read_b128 v[228:231], v18 offset:1184
    ds_read_b128 v[232:235], v18 offset:1216
    ds_read_b128 v[236:239], v18 offset:1248
    s_waitcnt lgkmcnt(0)
    v_add_f32 v160, v160, v224
    v_add_f32 v161, v161, v225
    v_add_f32 v162, v162, v226
    v_add_f32 v163, v163, v227
    v_add_f32 v164, v164, v228
    v_add_f32 v165, v165, v229
    v_add_f32 v166, v166, v230
    v_add_f32 v167, v167, v231
    v_add_f32 v168, v168, v232
    v_add_f32 v169, v169, v233
    v_add_f32 v170, v170, v234
    v_add_f32 v171, v171, v235
    v_add_f32 v172, v172, v236
    v_add_f32 v173, v173, v237
    v_add_f32 v174, v174, v238
    v_add_f32 v175, v175, v239
    v_add_f32 v12, v12, v14
    v_add_f32 v13, v13, v15
    v_mov_b32 v16, v12
    s_nop 1
    v_permlane32_swap_b32 v12, v16
    v_add_f32 v12, v12, v16
    v_mov_b32 v16, v13
    s_nop 1
    v_permlane32_swap_b32 v13, v16
    v_add_f32 v13, v13, v16
    v_mul_f32 v14, 0x3b000000, v12
    v_mul_f32 v16, 0x3b000000, v13
    v_fma_f32 v16, -v14, v14, v16
    v_max_f32 v16, 0, v16
    v_cvt_pk_bf16_f32 v17, v14, v14
    v_lshlrev_b32 v14, 16, v17
    v_cvt_pk_bf16_f32 v17, v16, v16
    v_lshlrev_b32 v16, 16, v17
    v_add_f32 v16, 0x3727c5ac, v16
    v_cvt_pk_bf16_f32 v17, v16, v16
    v_lshlrev_b32 v16, 16, v17
    v_sqrt_f32 v16, v16
    s_nop 0
    v_cvt_pk_bf16_f32 v17, v16, v16
    v_lshlrev_b32 v16, 16, v17
    v_rcp_f32 v15, v16
    v_fma_f32 v128, -v14, v160, v128
    v_fma_f32 v129, -v14, v161, v129
    v_fma_f32 v130, -v14, v162, v130
    v_fma_f32 v131, -v14, v163, v131
    v_fma_f32 v132, -v14, v164, v132
    v_fma_f32 v133, -v14, v165, v133
    v_fma_f32 v134, -v14, v166, v134
    v_fma_f32 v135, -v14, v167, v135
    v_fma_f32 v136, -v14, v168, v136
    v_fma_f32 v137, -v14, v169, v137
    v_fma_f32 v138, -v14, v170, v138
    v_fma_f32 v139, -v14, v171, v139
    v_fma_f32 v140, -v14, v172, v140
    v_fma_f32 v141, -v14, v173, v141
    v_fma_f32 v142, -v14, v174, v142
    v_fma_f32 v143, -v14, v175, v143
    v_mul_f32 v128, v15, v128
    v_mul_f32 v129, v15, v129
    v_mul_f32 v130, v15, v130
    v_mul_f32 v131, v15, v131
    v_mul_f32 v132, v15, v132
    v_mul_f32 v133, v15, v133
    v_mul_f32 v134, v15, v134
    v_mul_f32 v135, v15, v135
    v_mul_f32 v136, v15, v136
    v_mul_f32 v137, v15, v137
    v_mul_f32 v138, v15, v138
    v_mul_f32 v139, v15, v139
    v_mul_f32 v140, v15, v140
    v_mul_f32 v141, v15, v141
    v_mul_f32 v142, v15, v142
    v_mul_f32 v143, v15, v143
    v_cvt_pk_bf16_f32 v60, v128, v129
    v_cvt_pk_bf16_f32 v61, v130, v131
    v_cvt_pk_bf16_f32 v62, v132, v133
    v_cvt_pk_bf16_f32 v63, v134, v135
    v_cvt_pk_bf16_f32 v64, v136, v137
    v_cvt_pk_bf16_f32 v65, v138, v139
    v_cvt_pk_bf16_f32 v66, v140, v141
    v_cvt_pk_bf16_f32 v67, v142, v143
    v_lshrrev_b32 v18, 5, v1
    v_bfe_u32 v19, v1, 2, 2
    v_lshl_add_u32 v18, v18, 2, v19
    v_lshlrev_b32 v18, 5, v18
    v_and_b32 v19, 3, v1
    v_lshl_add_u32 v18, v19, 3, v18
    v_add_u32 v18, 98304, v18
    ds_read_b64_tr_b16 v[72:73], v18 offset:0
    ds_read_b64_tr_b16 v[74:75], v18 offset:256
    ds_read_b64_tr_b16 v[76:77], v18 offset:512
    ds_read_b64_tr_b16 v[78:79], v18 offset:768
    v_mov_b32 v176, 0
    v_mov_b32 v177, 0
    v_mov_b32 v178, 0
    v_mov_b32 v179, 0
    v_mov_b32 v180, 0
    v_mov_b32 v181, 0
    v_mov_b32 v182, 0
    v_mov_b32 v183, 0
    v_mov_b32 v184, 0
    v_mov_b32 v185, 0
    v_mov_b32 v186, 0
    v_mov_b32 v187, 0
    v_mov_b32 v188, 0
    v_mov_b32 v189, 0
    v_mov_b32 v190, 0
    v_mov_b32 v191, 0
    v_mov_b32 v192, 0
    v_mov_b32 v193, 0
    v_mov_b32 v194, 0
    v_mov_b32 v195, 0
    v_mov_b32 v196, 0
    v_mov_b32 v197, 0
    v_mov_b32 v198, 0
    v_mov_b32 v199, 0
    v_mov_b32 v200, 0
    v_mov_b32 v201, 0
    v_mov_b32 v202, 0
    v_mov_b32 v203, 0
    v_mov_b32 v204, 0
    v_mov_b32 v205, 0
    v_mov_b32 v206, 0
    v_mov_b32 v207, 0
    s_waitcnt lgkmcnt(0)
    v_mfma_f32_32x32x16_bf16 v[176:191], v[72:75], v[60:63], v[176:191]
    v_mfma_f32_32x32x16_bf16 v[192:207], v[76:79], v[64:67], v[192:207]
    v_and_b32 v16, 31, v1
    s_lshl_b32 s29, s27, 7
    s_lshl_b32 s30, s39, 5
    s_add_u32 s29, s29, s30
    v_add_u32 v20, s29, v16
    v_lshrrev_b32 v17, 5, v1
    v_lshlrev_b32 v22, 11, v20
    s_lshl_b32 s30, s28, 7
    v_add_u32 v22, s30, v22
    v_lshl_add_u32 v22, v17, 3, v22
    s_nop 0
    v_cvt_pk_bf16_f32 v90, v176, v177
    v_lshlrev_b32 v208, 16, v90
    v_and_b32 v209, 0xffff0000, v90
    v_cvt_pk_bf16_f32 v90, v178, v179
    v_lshlrev_b32 v210, 16, v90
    v_and_b32 v211, 0xffff0000, v90
    v_cvt_pk_bf16_f32 v90, v180, v181
    v_lshlrev_b32 v212, 16, v90
    v_and_b32 v213, 0xffff0000, v90
    v_cvt_pk_bf16_f32 v90, v182, v183
    v_lshlrev_b32 v214, 16, v90
    v_and_b32 v215, 0xffff0000, v90
    v_cvt_pk_bf16_f32 v90, v192, v193
    v_lshlrev_b32 v232, 16, v90
    v_and_b32 v233, 0xffff0000, v90
    v_cvt_pk_bf16_f32 v90, v194, v195
    v_lshlrev_b32 v234, 16, v90
    v_and_b32 v235, 0xffff0000, v90
    v_cvt_pk_bf16_f32 v90, v196, v197
    v_lshlrev_b32 v236, 16, v90
    v_and_b32 v237, 0xffff0000, v90
    v_cvt_pk_bf16_f32 v90, v198, v199
    v_lshlrev_b32 v238, 16, v90
    v_and_b32 v239, 0xffff0000, v90
    v_max3_f32 v84, v208, v209, v210
    v_min3_f32 v85, v208, v209, v210
    v_max3_f32 v87, v232, v233, v234
    v_min3_f32 v88, v232, v233, v234
    v_max3_f32 v84, v84, v211, v212
    v_min3_f32 v85, v85, v211, v212
    v_max3_f32 v87, v87, v235, v236
    v_min3_f32 v88, v88, v235, v236
    v_max3_f32 v84, v84, v213, v214
    v_min3_f32 v85, v85, v213, v214
    v_max3_f32 v87, v87, v237, v238
    v_min3_f32 v88, v88, v237, v238
    v_max_f32 v84, v84, v215
    v_min_f32 v85, v85, v215
    v_max_f32 v87, v87, v239
    v_min_f32 v88, v88, v239
    v_mov_b32 v86, v84
    s_nop 1
    v_permlane32_swap_b32 v84, v86
    v_max_f32 v84, v84, v86
    v_mov_b32 v86, v85
    s_nop 1
    v_permlane32_swap_b32 v85, v86
    v_min_f32 v85, v85, v86
    v_mov_b32 v89, v87
    s_nop 1
    v_permlane32_swap_b32 v87, v89
    v_max_f32 v87, v87, v89
    v_mov_b32 v89, v88
    s_nop 1
    v_permlane32_swap_b32 v88, v89
    v_min_f32 v88, v88, v89
    v_mul_f32 v84, 0xbfb8aa3b, v84
    v_mul_f32 v85, 0x3fb8aa3b, v85
    v_mul_f32 v87, 0xbfb8aa3b, v87
    v_mul_f32 v88, 0x3fb8aa3b, v88
    s_mov_b32 s44, 0x3fb8aa3b
    v_fma_f32 v216, v208, s44, v84
    v_fma_f32 v224, -v208, s44, v85
    v_fma_f32 v240, v232, s44, v87
    v_fma_f32 v248, -v232, s44, v88
    v_fma_f32 v217, v209, s44, v84
    v_fma_f32 v225, -v209, s44, v85
    v_fma_f32 v241, v233, s44, v87
    v_fma_f32 v249, -v233, s44, v88
    v_fma_f32 v218, v210, s44, v84
    v_fma_f32 v226, -v210, s44, v85
    v_fma_f32 v242, v234, s44, v87
    v_fma_f32 v250, -v234, s44, v88
    v_fma_f32 v219, v211, s44, v84
    v_fma_f32 v227, -v211, s44, v85
    v_fma_f32 v243, v235, s44, v87
    v_fma_f32 v251, -v235, s44, v88
    v_fma_f32 v220, v212, s44, v84
    v_fma_f32 v228, -v212, s44, v85
    v_fma_f32 v244, v236, s44, v87
    v_fma_f32 v252, -v236, s44, v88
    v_fma_f32 v221, v213, s44, v84
    v_fma_f32 v229, -v213, s44, v85
    v_fma_f32 v245, v237, s44, v87
    v_fma_f32 v253, -v237, s44, v88
    v_fma_f32 v222, v214, s44, v84
    v_fma_f32 v230, -v214, s44, v85
    v_fma_f32 v246, v238, s44, v87
    v_fma_f32 v254, -v238, s44, v88
    v_fma_f32 v223, v215, s44, v84
    v_fma_f32 v231, -v215, s44, v85
    v_fma_f32 v247, v239, s44, v87
    v_fma_f32 v255, -v239, s44, v88
    v_exp_f32 v216, v216
    v_exp_f32 v224, v224
    v_exp_f32 v240, v240
    v_exp_f32 v248, v248
    v_exp_f32 v217, v217
    v_exp_f32 v225, v225
    v_exp_f32 v241, v241
    v_exp_f32 v249, v249
    v_exp_f32 v218, v218
    v_exp_f32 v226, v226
    v_exp_f32 v242, v242
    v_exp_f32 v250, v250
    v_exp_f32 v219, v219
    v_exp_f32 v227, v227
    v_exp_f32 v243, v243
    v_exp_f32 v251, v251
    v_exp_f32 v220, v220
    v_exp_f32 v228, v228
    v_exp_f32 v244, v244
    v_exp_f32 v252, v252
    v_exp_f32 v221, v221
    v_exp_f32 v229, v229
    v_exp_f32 v245, v245
    v_exp_f32 v253, v253
    v_exp_f32 v222, v222
    v_exp_f32 v230, v230
    v_exp_f32 v246, v246
    v_exp_f32 v254, v254
    v_exp_f32 v223, v223
    v_exp_f32 v231, v231
    v_exp_f32 v247, v247
    v_exp_f32 v255, v255
    v_add_f32 v84, v216, v217
    v_add_f32 v85, v224, v225
    v_add_f32 v87, v240, v241
    v_add_f32 v88, v248, v249
    v_add_f32 v84, v84, v218
    v_add_f32 v85, v85, v226
    v_add_f32 v87, v87, v242
    v_add_f32 v88, v88, v250
    v_add_f32 v84, v84, v219
    v_add_f32 v85, v85, v227
    v_add_f32 v87, v87, v243
    v_add_f32 v88, v88, v251
    v_add_f32 v84, v84, v220
    v_add_f32 v85, v85, v228
    v_add_f32 v87, v87, v244
    v_add_f32 v88, v88, v252
    v_add_f32 v84, v84, v221
    v_add_f32 v85, v85, v229
    v_add_f32 v87, v87, v245
    v_add_f32 v88, v88, v253
    v_add_f32 v84, v84, v222
    v_add_f32 v85, v85, v230
    v_add_f32 v87, v87, v246
    v_add_f32 v88, v88, v254
    v_add_f32 v84, v84, v223
    v_add_f32 v85, v85, v231
    v_add_f32 v87, v87, v247
    v_add_f32 v88, v88, v255
    v_mov_b32 v86, v84
    s_nop 1
    v_permlane32_swap_b32 v84, v86
    v_add_f32 v84, v84, v86
    v_mov_b32 v86, v85
    s_nop 1
    v_permlane32_swap_b32 v85, v86
    v_add_f32 v85, v85, v86
    v_mov_b32 v89, v87
    s_nop 1
    v_permlane32_swap_b32 v87, v89
    v_add_f32 v87, v87, v89
    v_mov_b32 v89, v88
    s_nop 1
    v_permlane32_swap_b32 v88, v89
    v_add_f32 v88, v88, v89
    v_rcp_f32 v84, v84
    v_rcp_f32 v85, v85
    v_rcp_f32 v87, v87
    v_rcp_f32 v88, v88
    v_mul_f32 v216, v216, v84
    v_mul_f32 v224, v224, v85
    v_mul_f32 v240, v240, v87
    v_mul_f32 v248, v248, v88
    v_mul_f32 v217, v217, v84
    v_mul_f32 v225, v225, v85
    v_mul_f32 v241, v241, v87
    v_mul_f32 v249, v249, v88
    v_mul_f32 v218, v218, v84
    v_mul_f32 v226, v226, v85
    v_mul_f32 v242, v242, v87
    v_mul_f32 v250, v250, v88
    v_mul_f32 v219, v219, v84
    v_mul_f32 v227, v227, v85
    v_mul_f32 v243, v243, v87
    v_mul_f32 v251, v251, v88
    v_mul_f32 v220, v220, v84
    v_mul_f32 v228, v228, v85
    v_mul_f32 v244, v244, v87
    v_mul_f32 v252, v252, v88
    v_mul_f32 v221, v221, v84
    v_mul_f32 v229, v229, v85
    v_mul_f32 v245, v245, v87
    v_mul_f32 v253, v253, v88
    v_mul_f32 v222, v222, v84
    v_mul_f32 v230, v230, v85
    v_mul_f32 v246, v246, v87
    v_mul_f32 v254, v254, v88
    v_mul_f32 v223, v223, v84
    v_mul_f32 v231, v231, v85
    v_mul_f32 v247, v247, v87
    v_mul_f32 v255, v255, v88
    v_cvt_pk_bf16_f32 v92, v216, v217
    v_cvt_pk_bf16_f32 v93, v218, v219
    buffer_store_dwordx2 v[92:93], v22, s[12:15], 0 offen offset:0
    v_cvt_pk_bf16_f32 v92, v220, v221
    v_cvt_pk_bf16_f32 v93, v222, v223
    buffer_store_dwordx2 v[92:93], v22, s[12:15], 0 offen offset:16
    v_cvt_pk_bf16_f32 v92, v224, v225
    v_cvt_pk_bf16_f32 v93, v226, v227
    buffer_store_dwordx2 v[92:93], v22, s[12:15], 0 offen offset:32
    v_cvt_pk_bf16_f32 v92, v228, v229
    v_cvt_pk_bf16_f32 v93, v230, v231
    buffer_store_dwordx2 v[92:93], v22, s[12:15], 0 offen offset:48
    v_cvt_pk_bf16_f32 v92, v240, v241
    v_cvt_pk_bf16_f32 v93, v242, v243
    buffer_store_dwordx2 v[92:93], v22, s[12:15], 0 offen offset:64
    v_cvt_pk_bf16_f32 v92, v244, v245
    v_cvt_pk_bf16_f32 v93, v246, v247
    buffer_store_dwordx2 v[92:93], v22, s[12:15], 0 offen offset:80
    v_cvt_pk_bf16_f32 v92, v248, v249
    v_cvt_pk_bf16_f32 v93, v250, v251
    buffer_store_dwordx2 v[92:93], v22, s[12:15], 0 offen offset:96
    v_cvt_pk_bf16_f32 v92, v252, v253
    v_cvt_pk_bf16_f32 v93, v254, v255
    buffer_store_dwordx2 v[92:93], v22, s[12:15], 0 offen offset:112
    s_barrier
    s_barrier
    s_endpgm
L_k1_tg1:
    s_waitcnt vmcnt(5)
    s_barrier
    ds_read_b128 v[96:99], v31
    ds_read_b64_tr_b16 v[64:65], v29 offset:0
    ds_read_b64_tr_b16 v[66:67], v29 offset:1024
    ds_read_b64_tr_b16 v[68:69], v30 offset:0
    ds_read_b64_tr_b16 v[70:71], v30 offset:1024
    ds_read_b128 v[100:103], v32
    ds_read_b64_tr_b16 v[72:73], v29 offset:4096
    ds_read_b64_tr_b16 v[74:75], v29 offset:5120
    ds_read_b64_tr_b16 v[76:77], v30 offset:4096
    ds_read_b64_tr_b16 v[78:79], v30 offset:5120
    s_waitcnt lgkmcnt(7)
    v_mfma_f32_32x32x16_bf16 v[128:143], v[64:67], v[96:99], v[128:143]
    v_lshlrev_b32 v16, 16, v98
    v_and_b32 v17, 0xffff0000, v98
    v_add_f32 v12, v12, v16
    v_add_f32 v13, v13, v17
    v_fma_f32 v14, v16, v16, v14
    v_fma_f32 v15, v17, v17, v15
    v_lshlrev_b32 v16, 16, v99
    v_and_b32 v17, 0xffff0000, v99
    v_add_f32 v12, v12, v16
    v_add_f32 v13, v13, v17
    v_fma_f32 v14, v16, v16, v14
    v_fma_f32 v15, v17, v17, v15
    s_cmp_lg_u32 s39, 0
    s_cbranch_scc1 L_k1_ws_33
    v_lshlrev_b32 v18, 16, v64
    v_and_b32 v19, 0xffff0000, v64
    v_add_f32 v116, v116, v18
    v_add_f32 v117, v117, v19
    v_lshlrev_b32 v18, 16, v65
    v_and_b32 v19, 0xffff0000, v65
    v_add_f32 v116, v116, v18
    v_add_f32 v117, v117, v19
    v_lshlrev_b32 v18, 16, v66
    v_and_b32 v19, 0xffff0000, v66
    v_add_f32 v116, v116, v18
    v_add_f32 v117, v117, v19
    v_lshlrev_b32 v18, 16, v67
    v_and_b32 v19, 0xffff0000, v67
    v_add_f32 v116, v116, v18
    v_add_f32 v117, v117, v19
L_k1_ws_33:
    s_add_u32 s37, s38, 65536
    s_mov_b32 m0, s37
    s_movk_i32 s36, 256
    buffer_load_dwordx4 v2, s[4:7], s36 offen lds
    ds_read_b128 v[104:107], v33
    ds_read_b64_tr_b16 v[80:81], v29 offset:8192
    ds_read_b64_tr_b16 v[82:83], v29 offset:9216
    s_waitcnt lgkmcnt(8)
    v_mfma_f32_32x32x16_bf16 v[144:159], v[68:71], v[96:99], v[144:159]
    s_cmp_lg_u32 s39, 0
    s_cbranch_scc1 L_k1_ws_34
    v_lshlrev_b32 v18, 16, v68
    v_and_b32 v19, 0xffff0000, v68
    v_add_f32 v118, v118, v18
    v_add_f32 v119, v119, v19
    v_lshlrev_b32 v18, 16, v69
    v_and_b32 v19, 0xffff0000, v69
    v_add_f32 v118, v118, v18
    v_add_f32 v119, v119, v19
    v_lshlrev_b32 v18, 16, v70
    v_and_b32 v19, 0xffff0000, v70
    v_add_f32 v118, v118, v18
    v_add_f32 v119, v119, v19
    v_lshlrev_b32 v18, 16, v71
    v_and_b32 v19, 0xffff0000, v71
    v_add_f32 v118, v118, v18
    v_add_f32 v119, v119, v19
L_k1_ws_34:
    s_add_u32 s37, s38, 66560
    s_mov_b32 m0, s37
    s_movk_i32 s36, 256
    buffer_load_dwordx4 v10, s[4:7], s36 offen lds
    ds_read_b64_tr_b16 v[64:65], v30 offset:8192
    ds_read_b64_tr_b16 v[66:67], v30 offset:9216
    s_waitcnt lgkmcnt(7)
    v_mfma_f32_32x32x16_bf16 v[128:143], v[72:75], v[100:103], v[128:143]
    v_lshlrev_b32 v16, 16, v102
    v_and_b32 v17, 0xffff0000, v102
    v_add_f32 v12, v12, v16
    v_add_f32 v13, v13, v17
    v_fma_f32 v14, v16, v16, v14
    v_fma_f32 v15, v17, v17, v15
    v_lshlrev_b32 v16, 16, v103
    v_and_b32 v17, 0xffff0000, v103
    v_add_f32 v12, v12, v16
    v_add_f32 v13, v13, v17
    v_fma_f32 v14, v16, v16, v14
    v_fma_f32 v15, v17, v17, v15
    s_cmp_lg_u32 s39, 1
    s_cbranch_scc1 L_k1_ws_35
    v_lshlrev_b32 v18, 16, v72
    v_and_b32 v19, 0xffff0000, v72
    v_add_f32 v116, v116, v18
    v_add_f32 v117, v117, v19
    v_lshlrev_b32 v18, 16, v73
    v_and_b32 v19, 0xffff0000, v73
    v_add_f32 v116, v116, v18
    v_add_f32 v117, v117, v19
    v_lshlrev_b32 v18, 16, v74
    v_and_b32 v19, 0xffff0000, v74
    v_add_f32 v116, v116, v18
    v_add_f32 v117, v117, v19
    v_lshlrev_b32 v18, 16, v75
    v_and_b32 v19, 0xffff0000, v75
    v_add_f32 v116, v116, v18
    v_add_f32 v117, v117, v19
L_k1_ws_35:
    s_add_u32 s36, s34, 393216
    s_add_u32 s37, s35, 65536
    s_mov_b32 m0, s37
    s_mov_b64 exec, s[32:33]
    buffer_load_dwordx4 v3, s[8:11], s36 offen lds
    s_mov_b64 exec, -1
    ds_read_b128 v[108:111], v34
    ds_read_b64_tr_b16 v[68:69], v29 offset:12288
    ds_read_b64_tr_b16 v[70:71], v29 offset:13312
    s_waitcnt lgkmcnt(8)
    v_mfma_f32_32x32x16_bf16 v[144:159], v[76:79], v[100:103], v[144:159]
    s_cmp_lg_u32 s39, 1
    s_cbranch_scc1 L_k1_ws_36
    v_lshlrev_b32 v18, 16, v76
    v_and_b32 v19, 0xffff0000, v76
    v_add_f32 v118, v118, v18
    v_add_f32 v119, v119, v19
    v_lshlrev_b32 v18, 16, v77
    v_and_b32 v19, 0xffff0000, v77
    v_add_f32 v118, v118, v18
    v_add_f32 v119, v119, v19
    v_lshlrev_b32 v18, 16, v78
    v_and_b32 v19, 0xffff0000, v78
    v_add_f32 v118, v118, v18
    v_add_f32 v119, v119, v19
    v_lshlrev_b32 v18, 16, v79
    v_and_b32 v19, 0xffff0000, v79
    v_add_f32 v118, v118, v18
    v_add_f32 v119, v119, v19
L_k1_ws_36:
    s_add_u32 s36, s34, 405504
    s_add_u32 s37, s35, 66560
    s_mov_b32 m0, s37
    s_mov_b64 exec, s[32:33]
    buffer_load_dwordx4 v3, s[8:11], s36 offen lds
    s_mov_b64 exec, -1
    ds_read_b64_tr_b16 v[72:73], v30 offset:12288
    ds_read_b64_tr_b16 v[74:75], v30 offset:13312
    s_waitcnt lgkmcnt(7)
    v_mfma_f32_32x32x16_bf16 v[128:143], v[80:83], v[104:107], v[128:143]
    v_lshlrev_b32 v16, 16, v106
    v_and_b32 v17, 0xffff0000, v106
    v_add_f32 v12, v12, v16
    v_add_f32 v13, v13, v17
    v_fma_f32 v14, v16, v16, v14
    v_fma_f32 v15, v17, v17, v15
    v_lshlrev_b32 v16, 16, v107
    v_and_b32 v17, 0xffff0000, v107
    v_add_f32 v12, v12, v16
    v_add_f32 v13, v13, v17
    v_fma_f32 v14, v16, v16, v14
    v_fma_f32 v15, v17, v17, v15
    s_cmp_lg_u32 s39, 2
    s_cbranch_scc1 L_k1_ws_37
    v_lshlrev_b32 v18, 16, v80
    v_and_b32 v19, 0xffff0000, v80
    v_add_f32 v116, v116, v18
    v_add_f32 v117, v117, v19
    v_lshlrev_b32 v18, 16, v81
    v_and_b32 v19, 0xffff0000, v81
    v_add_f32 v116, v116, v18
    v_add_f32 v117, v117, v19
    v_lshlrev_b32 v18, 16, v82
    v_and_b32 v19, 0xffff0000, v82
    v_add_f32 v116, v116, v18
    v_add_f32 v117, v117, v19
    v_lshlrev_b32 v18, 16, v83
    v_and_b32 v19, 0xffff0000, v83
    v_add_f32 v116, v116, v18
    v_add_f32 v117, v117, v19
L_k1_ws_37:
    s_waitcnt vmcnt(4)
    s_waitcnt lgkmcnt(0)
    s_barrier
    ds_read_b128 v[112:115], v39
    ds_read_b64_tr_b16 v[76:77], v37 offset:0
    ds_read_b64_tr_b16 v[78:79], v37 offset:1024
    v_mfma_f32_32x32x16_bf16 v[144:159], v[64:67], v[104:107], v[144:159]
    s_cmp_lg_u32 s39, 2
    s_cbranch_scc1 L_k1_ws_38
    v_lshlrev_b32 v18, 16, v64
    v_and_b32 v19, 0xffff0000, v64
    v_add_f32 v118, v118, v18
    v_add_f32 v119, v119, v19
    v_lshlrev_b32 v18, 16, v65
    v_and_b32 v19, 0xffff0000, v65
    v_add_f32 v118, v118, v18
    v_add_f32 v119, v119, v19
    v_lshlrev_b32 v18, 16, v66
    v_and_b32 v19, 0xffff0000, v66
    v_add_f32 v118, v118, v18
    v_add_f32 v119, v119, v19
    v_lshlrev_b32 v18, 16, v67
    v_and_b32 v19, 0xffff0000, v67
    v_add_f32 v118, v118, v18
    v_add_f32 v119, v119, v19
L_k1_ws_38:
    s_add_u32 s37, s38, 0
    s_mov_b32 m0, s37
    s_movk_i32 s36, 384
    buffer_load_dwordx4 v2, s[4:7], s36 offen lds
    ds_read_b64_tr_b16 v[80:81], v38 offset:0
    ds_read_b64_tr_b16 v[82:83], v38 offset:1024
    v_mfma_f32_32x32x16_bf16 v[128:143], v[68:71], v[108:111], v[128:143]
    v_lshlrev_b32 v16, 16, v110
    v_and_b32 v17, 0xffff0000, v110
    v_add_f32 v12, v12, v16
    v_add_f32 v13, v13, v17
    v_fma_f32 v14, v16, v16, v14
    v_fma_f32 v15, v17, v17, v15
    v_lshlrev_b32 v16, 16, v111
    v_and_b32 v17, 0xffff0000, v111
    v_add_f32 v12, v12, v16
    v_add_f32 v13, v13, v17
    v_fma_f32 v14, v16, v16, v14
    v_fma_f32 v15, v17, v17, v15
    s_cmp_lg_u32 s39, 3
    s_cbranch_scc1 L_k1_ws_39
    v_lshlrev_b32 v18, 16, v68
    v_and_b32 v19, 0xffff0000, v68
    v_add_f32 v116, v116, v18
    v_add_f32 v117, v117, v19
    v_lshlrev_b32 v18, 16, v69
    v_and_b32 v19, 0xffff0000, v69
    v_add_f32 v116, v116, v18
    v_add_f32 v117, v117, v19
    v_lshlrev_b32 v18, 16, v70
    v_and_b32 v19, 0xffff0000, v70
    v_add_f32 v116, v116, v18
    v_add_f32 v117, v117, v19
    v_lshlrev_b32 v18, 16, v71
    v_and_b32 v19, 0xffff0000, v71
    v_add_f32 v116, v116, v18
    v_add_f32 v117, v117, v19
L_k1_ws_39:
    s_add_u32 s37, s38, 1024
    s_mov_b32 m0, s37
    s_movk_i32 s36, 384
    buffer_load_dwordx4 v10, s[4:7], s36 offen lds
    ds_read_b128 v[96:99], v40
    ds_read_b64_tr_b16 v[64:65], v37 offset:4096
    ds_read_b64_tr_b16 v[66:67], v37 offset:5120
    v_mfma_f32_32x32x16_bf16 v[144:159], v[72:75], v[108:111], v[144:159]
    s_cmp_lg_u32 s39, 3
    s_cbranch_scc1 L_k1_ws_40
    v_lshlrev_b32 v18, 16, v72
    v_and_b32 v19, 0xffff0000, v72
    v_add_f32 v118, v118, v18
    v_add_f32 v119, v119, v19
    v_lshlrev_b32 v18, 16, v73
    v_and_b32 v19, 0xffff0000, v73
    v_add_f32 v118, v118, v18
    v_add_f32 v119, v119, v19
    v_lshlrev_b32 v18, 16, v74
    v_and_b32 v19, 0xffff0000, v74
    v_add_f32 v118, v118, v18
    v_add_f32 v119, v119, v19
    v_lshlrev_b32 v18, 16, v75
    v_and_b32 v19, 0xffff0000, v75
    v_add_f32 v118, v118, v18
    v_add_f32 v119, v119, v19
L_k1_ws_40:
    s_add_u32 s36, s34, 589824
    s_add_u32 s37, s35, 0
    s_mov_b32 m0, s37
    s_mov_b64 exec, s[32:33]
    buffer_load_dwordx4 v3, s[8:11], s36 offen lds
    s_mov_b64 exec, -1
    ds_read_b64_tr_b16 v[68:69], v38 offset:4096
    ds_read_b64_tr_b16 v[70:71], v38 offset:5120
    s_waitcnt lgkmcnt(7)
    v_mfma_f32_32x32x16_bf16 v[128:143], v[76:79], v[112:115], v[128:143]
    v_lshlrev_b32 v16, 16, v114
    v_and_b32 v17, 0xffff0000, v114
    v_add_f32 v12, v12, v16
    v_add_f32 v13, v13, v17
    v_fma_f32 v14, v16, v16, v14
    v_fma_f32 v15, v17, v17, v15
    v_lshlrev_b32 v16, 16, v115
    v_and_b32 v17, 0xffff0000, v115
    v_add_f32 v12, v12, v16
    v_add_f32 v13, v13, v17
    v_fma_f32 v14, v16, v16, v14
    v_fma_f32 v15, v17, v17, v15
    s_cmp_lg_u32 s39, 0
    s_cbranch_scc1 L_k1_ws_41
    v_lshlrev_b32 v18, 16, v76
    v_and_b32 v19, 0xffff0000, v76
    v_add_f32 v116, v116, v18
    v_add_f32 v117, v117, v19
    v_lshlrev_b32 v18, 16, v77
    v_and_b32 v19, 0xffff0000, v77
    v_add_f32 v116, v116, v18
    v_add_f32 v117, v117, v19
    v_lshlrev_b32 v18, 16, v78
    v_and_b32 v19, 0xffff0000, v78
    v_add_f32 v116, v116, v18
    v_add_f32 v117, v117, v19
    v_lshlrev_b32 v18, 16, v79
    v_and_b32 v19, 0xffff0000, v79
    v_add_f32 v116, v116, v18
    v_add_f32 v117, v117, v19
L_k1_ws_41:
    s_add_u32 s36, s34, 602112
    s_add_u32 s37, s35, 1024
    s_mov_b32 m0, s37
    s_mov_b64 exec, s[32:33]
    buffer_load_dwordx4 v3, s[8:11], s36 offen lds
    s_mov_b64 exec, -1
    ds_read_b128 v[100:103], v41
    ds_read_b64_tr_b16 v[72:73], v37 offset:8192
    ds_read_b64_tr_b16 v[74:75], v37 offset:9216
    s_waitcnt lgkmcnt(8)
    v_mfma_f32_32x32x16_bf16 v[144:159], v[80:83], v[112:115], v[144:159]
    s_cmp_lg_u32 s39, 0
    s_cbranch_scc1 L_k1_ws_42
    v_lshlrev_b32 v18, 16, v80
    v_and_b32 v19, 0xffff0000, v80
    v_add_f32 v118, v118, v18
    v_add_f32 v119, v119, v19
    v_lshlrev_b32 v18, 16, v81
    v_and_b32 v19, 0xffff0000, v81
    v_add_f32 v118, v118, v18
    v_add_f32 v119, v119, v19
    v_lshlrev_b32 v18, 16, v82
    v_and_b32 v19, 0xffff0000, v82
    v_add_f32 v118, v118, v18
    v_add_f32 v119, v119, v19
    v_lshlrev_b32 v18, 16, v83
    v_and_b32 v19, 0xffff0000, v83
    v_add_f32 v118, v118, v18
    v_add_f32 v119, v119, v19
L_k1_ws_42:
    ds_read_b64_tr_b16 v[76:77], v38 offset:8192
    ds_read_b64_tr_b16 v[78:79], v38 offset:9216
    s_waitcnt lgkmcnt(7)
    v_mfma_f32_32x32x16_bf16 v[128:143], v[64:67], v[96:99], v[128:143]
    v_lshlrev_b32 v16, 16, v98
    v_and_b32 v17, 0xffff0000, v98
    v_add_f32 v12, v12, v16
    v_add_f32 v13, v13, v17
    v_fma_f32 v14, v16, v16, v14
    v_fma_f32 v15, v17, v17, v15
    v_lshlrev_b32 v16, 16, v99
    v_and_b32 v17, 0xffff0000, v99
    v_add_f32 v12, v12, v16
    v_add_f32 v13, v13, v17
    v_fma_f32 v14, v16, v16, v14
    v_fma_f32 v15, v17, v17, v15
    s_cmp_lg_u32 s39, 1
    s_cbranch_scc1 L_k1_ws_43
    v_lshlrev_b32 v18, 16, v64
    v_and_b32 v19, 0xffff0000, v64
    v_add_f32 v116, v116, v18
    v_add_f32 v117, v117, v19
    v_lshlrev_b32 v18, 16, v65
    v_and_b32 v19, 0xffff0000, v65
    v_add_f32 v116, v116, v18
    v_add_f32 v117, v117, v19
    v_lshlrev_b32 v18, 16, v66
    v_and_b32 v19, 0xffff0000, v66
    v_add_f32 v116, v116, v18
    v_add_f32 v117, v117, v19
    v_lshlrev_b32 v18, 16, v67
    v_and_b32 v19, 0xffff0000, v67
    v_add_f32 v116, v116, v18
    v_add_f32 v117, v117, v19
L_k1_ws_43:
    ds_read_b128 v[104:107], v42
    ds_read_b64_tr_b16 v[80:81], v37 offset:12288
    ds_read_b64_tr_b16 v[82:83], v37 offset:13312
    s_waitcnt lgkmcnt(8)
    v_mfma_f32_32x32x16_bf16 v[144:159], v[68:71], v[96:99], v[144:159]
    s_cmp_lg_u32 s39, 1
    s_cbranch_scc1 L_k1_ws_44
    v_lshlrev_b32 v18, 16, v68
    v_and_b32 v19, 0xffff0000, v68
    v_add_f32 v118, v118, v18
    v_add_f32 v119, v119, v19
    v_lshlrev_b32 v18, 16, v69
    v_and_b32 v19, 0xffff0000, v69
    v_add_f32 v118, v118, v18
    v_add_f32 v119, v119, v19
    v_lshlrev_b32 v18, 16, v70
    v_and_b32 v19, 0xffff0000, v70
    v_add_f32 v118, v118, v18
    v_add_f32 v119, v119, v19
    v_lshlrev_b32 v18, 16, v71
    v_and_b32 v19, 0xffff0000, v71
    v_add_f32 v118, v118, v18
    v_add_f32 v119, v119, v19
L_k1_ws_44:
    ds_read_b64_tr_b16 v[64:65], v38 offset:12288
    ds_read_b64_tr_b16 v[66:67], v38 offset:13312
    s_waitcnt lgkmcnt(7)
    v_mfma_f32_32x32x16_bf16 v[128:143], v[72:75], v[100:103], v[128:143]
    v_lshlrev_b32 v16, 16, v102
    v_and_b32 v17, 0xffff0000, v102
    v_add_f32 v12, v12, v16
    v_add_f32 v13, v13, v17
    v_fma_f32 v14, v16, v16, v14
    v_fma_f32 v15, v17, v17, v15
    v_lshlrev_b32 v16, 16, v103
    v_and_b32 v17, 0xffff0000, v103
    v_add_f32 v12, v12, v16
    v_add_f32 v13, v13, v17
    v_fma_f32 v14, v16, v16, v14
    v_fma_f32 v15, v17, v17, v15
    s_cmp_lg_u32 s39, 2
    s_cbranch_scc1 L_k1_ws_45
    v_lshlrev_b32 v18, 16, v72
    v_and_b32 v19, 0xffff0000, v72
    v_add_f32 v116, v116, v18
    v_add_f32 v117, v117, v19
    v_lshlrev_b32 v18, 16, v73
    v_and_b32 v19, 0xffff0000, v73
    v_add_f32 v116, v116, v18
    v_add_f32 v117, v117, v19
    v_lshlrev_b32 v18, 16, v74
    v_and_b32 v19, 0xffff0000, v74
    v_add_f32 v116, v116, v18
    v_add_f32 v117, v117, v19
    v_lshlrev_b32 v18, 16, v75
    v_and_b32 v19, 0xffff0000, v75
    v_add_f32 v116, v116, v18
    v_add_f32 v117, v117, v19
L_k1_ws_45:
    s_waitcnt vmcnt(4)
    s_waitcnt lgkmcnt(0)
    s_barrier
    ds_read_b128 v[108:111], v47
    ds_read_b64_tr_b16 v[68:69], v45 offset:0
    ds_read_b64_tr_b16 v[70:71], v45 offset:1024
    v_mfma_f32_32x32x16_bf16 v[144:159], v[76:79], v[100:103], v[144:159]
    s_cmp_lg_u32 s39, 2
    s_cbranch_scc1 L_k1_ws_46
    v_lshlrev_b32 v18, 16, v76
    v_and_b32 v19, 0xffff0000, v76
    v_add_f32 v118, v118, v18
    v_add_f32 v119, v119, v19
    v_lshlrev_b32 v18, 16, v77
    v_and_b32 v19, 0xffff0000, v77
    v_add_f32 v118, v118, v18
    v_add_f32 v119, v119, v19
    v_lshlrev_b32 v18, 16, v78
    v_and_b32 v19, 0xffff0000, v78
    v_add_f32 v118, v118, v18
    v_add_f32 v119, v119, v19
    v_lshlrev_b32 v18, 16, v79
    v_and_b32 v19, 0xffff0000, v79
    v_add_f32 v118, v118, v18
    v_add_f32 v119, v119, v19
L_k1_ws_46:
    s_add_u32 s37, s38, 32768
    s_mov_b32 m0, s37
    s_movk_i32 s36, 512
    buffer_load_dwordx4 v2, s[4:7], s36 offen lds
    ds_read_b64_tr_b16 v[72:73], v46 offset:0
    ds_read_b64_tr_b16 v[74:75], v46 offset:1024
    v_mfma_f32_32x32x16_bf16 v[128:143], v[80:83], v[104:107], v[128:143]
    v_lshlrev_b32 v16, 16, v106
    v_and_b32 v17, 0xffff0000, v106
    v_add_f32 v12, v12, v16
    v_add_f32 v13, v13, v17
    v_fma_f32 v14, v16, v16, v14
    v_fma_f32 v15, v17, v17, v15
    v_lshlrev_b32 v16, 16, v107
    v_and_b32 v17, 0xffff0000, v107
    v_add_f32 v12, v12, v16
    v_add_f32 v13, v13, v17
    v_fma_f32 v14, v16, v16, v14
    v_fma_f32 v15, v17, v17, v15
    s_cmp_lg_u32 s39, 3
    s_cbranch_scc1 L_k1_ws_47
    v_lshlrev_b32 v18, 16, v80
    v_and_b32 v19, 0xffff0000, v80
    v_add_f32 v116, v116, v18
    v_add_f32 v117, v117, v19
    v_lshlrev_b32 v18, 16, v81
    v_and_b32 v19, 0xffff0000, v81
    v_add_f32 v116, v116, v18
    v_add_f32 v117, v117, v19
    v_lshlrev_b32 v18, 16, v82
    v_and_b32 v19, 0xffff0000, v82
    v_add_f32 v116, v116, v18
    v_add_f32 v117, v117, v19
    v_lshlrev_b32 v18, 16, v83
    v_and_b32 v19, 0xffff0000, v83
    v_add_f32 v116, v116, v18
    v_add_f32 v117, v117, v19
L_k1_ws_47:
    s_add_u32 s37, s38, 33792
    s_mov_b32 m0, s37
    s_movk_i32 s36, 512
    buffer_load_dwordx4 v10, s[4:7], s36 offen lds
    ds_read_b128 v[112:115], v48
    ds_read_b64_tr_b16 v[76:77], v45 offset:4096
    ds_read_b64_tr_b16 v[78:79], v45 offset:5120
    v_mfma_f32_32x32x16_bf16 v[144:159], v[64:67], v[104:107], v[144:159]
    s_cmp_lg_u32 s39, 3
    s_cbranch_scc1 L_k1_ws_48
    v_lshlrev_b32 v18, 16, v64
    v_and_b32 v19, 0xffff0000, v64
    v_add_f32 v118, v118, v18
    v_add_f32 v119, v119, v19
    v_lshlrev_b32 v18, 16, v65
    v_and_b32 v19, 0xffff0000, v65
    v_add_f32 v118, v118, v18
    v_add_f32 v119, v119, v19
    v_lshlrev_b32 v18, 16, v66
    v_and_b32 v19, 0xffff0000, v66
    v_add_f32 v118, v118, v18
    v_add_f32 v119, v119, v19
    v_lshlrev_b32 v18, 16, v67
    v_and_b32 v19, 0xffff0000, v67
    v_add_f32 v118, v118, v18
    v_add_f32 v119, v119, v19
L_k1_ws_48:
    s_add_u32 s36, s34, 786432
    s_add_u32 s37, s35, 32768
    s_mov_b32 m0, s37
    s_mov_b64 exec, s[32:33]
    buffer_load_dwordx4 v3, s[8:11], s36 offen lds
    s_mov_b64 exec, -1
    ds_read_b64_tr_b16 v[80:81], v46 offset:4096
    ds_read_b64_tr_b16 v[82:83], v46 offset:5120
    s_waitcnt lgkmcnt(7)
    v_mfma_f32_32x32x16_bf16 v[128:143], v[68:71], v[108:111], v[128:143]
    v_lshlrev_b32 v16, 16, v110
    v_and_b32 v17, 0xffff0000, v110
    v_add_f32 v12, v12, v16
    v_add_f32 v13, v13, v17
    v_fma_f32 v14, v16, v16, v14
    v_fma_f32 v15, v17, v17, v15
    v_lshlrev_b32 v16, 16, v111
    v_and_b32 v17, 0xffff0000, v111
    v_add_f32 v12, v12, v16
    v_add_f32 v13, v13, v17
    v_fma_f32 v14, v16, v16, v14
    v_fma_f32 v15, v17, v17, v15
    s_cmp_lg_u32 s39, 0
    s_cbranch_scc1 L_k1_ws_49
    v_lshlrev_b32 v18, 16, v68
    v_and_b32 v19, 0xffff0000, v68
    v_add_f32 v116, v116, v18
    v_add_f32 v117, v117, v19
    v_lshlrev_b32 v18, 16, v69
    v_and_b32 v19, 0xffff0000, v69
    v_add_f32 v116, v116, v18
    v_add_f32 v117, v117, v19
    v_lshlrev_b32 v18, 16, v70
    v_and_b32 v19, 0xffff0000, v70
    v_add_f32 v116, v116, v18
    v_add_f32 v117, v117, v19
    v_lshlrev_b32 v18, 16, v71
    v_and_b32 v19, 0xffff0000, v71
    v_add_f32 v116, v116, v18
    v_add_f32 v117, v117, v19
L_k1_ws_49:
    s_add_u32 s36, s34, 798720
    s_add_u32 s37, s35, 33792
    s_mov_b32 m0, s37
    s_mov_b64 exec, s[32:33]
    buffer_load_dwordx4 v3, s[8:11], s36 offen lds
    s_mov_b64 exec, -1
    ds_read_b128 v[96:99], v49
    ds_read_b64_tr_b16 v[64:65], v45 offset:8192
    ds_read_b64_tr_b16 v[66:67], v45 offset:9216
    s_waitcnt lgkmcnt(8)
    v_mfma_f32_32x32x16_bf16 v[144:159], v[72:75], v[108:111], v[144:159]
    s_cmp_lg_u32 s39, 0
    s_cbranch_scc1 L_k1_ws_50
    v_lshlrev_b32 v18, 16, v72
    v_and_b32 v19, 0xffff0000, v72
    v_add_f32 v118, v118, v18
    v_add_f32 v119, v119, v19
    v_lshlrev_b32 v18, 16, v73
    v_and_b32 v19, 0xffff0000, v73
    v_add_f32 v118, v118, v18
    v_add_f32 v119, v119, v19
    v_lshlrev_b32 v18, 16, v74
    v_and_b32 v19, 0xffff0000, v74
    v_add_f32 v118, v118, v18
    v_add_f32 v119, v119, v19
    v_lshlrev_b32 v18, 16, v75
    v_and_b32 v19, 0xffff0000, v75
    v_add_f32 v118, v118, v18
    v_add_f32 v119, v119, v19
L_k1_ws_50:
    ds_read_b64_tr_b16 v[68:69], v46 offset:8192
    ds_read_b64_tr_b16 v[70:71], v46 offset:9216
    s_waitcnt lgkmcnt(7)
    v_mfma_f32_32x32x16_bf16 v[128:143], v[76:79], v[112:115], v[128:143]
    v_lshlrev_b32 v16, 16, v114
    v_and_b32 v17, 0xffff0000, v114
    v_add_f32 v12, v12, v16
    v_add_f32 v13, v13, v17
    v_fma_f32 v14, v16, v16, v14
    v_fma_f32 v15, v17, v17, v15
    v_lshlrev_b32 v16, 16, v115
    v_and_b32 v17, 0xffff0000, v115
    v_add_f32 v12, v12, v16
    v_add_f32 v13, v13, v17
    v_fma_f32 v14, v16, v16, v14
    v_fma_f32 v15, v17, v17, v15
    s_cmp_lg_u32 s39, 1
    s_cbranch_scc1 L_k1_ws_51
    v_lshlrev_b32 v18, 16, v76
    v_and_b32 v19, 0xffff0000, v76
    v_add_f32 v116, v116, v18
    v_add_f32 v117, v117, v19
    v_lshlrev_b32 v18, 16, v77
    v_and_b32 v19, 0xffff0000, v77
    v_add_f32 v116, v116, v18
    v_add_f32 v117, v117, v19
    v_lshlrev_b32 v18, 16, v78
    v_and_b32 v19, 0xffff0000, v78
    v_add_f32 v116, v116, v18
    v_add_f32 v117, v117, v19
    v_lshlrev_b32 v18, 16, v79
    v_and_b32 v19, 0xffff0000, v79
    v_add_f32 v116, v116, v18
    v_add_f32 v117, v117, v19
L_k1_ws_51:
    ds_read_b128 v[100:103], v50
    ds_read_b64_tr_b16 v[72:73], v45 offset:12288
    ds_read_b64_tr_b16 v[74:75], v45 offset:13312
    s_waitcnt lgkmcnt(8)
    v_mfma_f32_32x32x16_bf16 v[144:159], v[80:83], v[112:115], v[144:159]
    s_cmp_lg_u32 s39, 1
    s_cbranch_scc1 L_k1_ws_52
    v_lshlrev_b32 v18, 16, v80
    v_and_b32 v19, 0xffff0000, v80
    v_add_f32 v118, v118, v18
    v_add_f32 v119, v119, v19
    v_lshlrev_b32 v18, 16, v81
    v_and_b32 v19, 0xffff0000, v81
    v_add_f32 v118, v118, v18
    v_add_f32 v119, v119, v19
    v_lshlrev_b32 v18, 16, v82
    v_and_b32 v19, 0xffff0000, v82
    v_add_f32 v118, v118, v18
    v_add_f32 v119, v119, v19
    v_lshlrev_b32 v18, 16, v83
    v_and_b32 v19, 0xffff0000, v83
    v_add_f32 v118, v118, v18
    v_add_f32 v119, v119, v19
L_k1_ws_52:
    ds_read_b64_tr_b16 v[76:77], v46 offset:12288
    ds_read_b64_tr_b16 v[78:79], v46 offset:13312
    s_waitcnt lgkmcnt(7)
    v_mfma_f32_32x32x16_bf16 v[128:143], v[64:67], v[96:99], v[128:143]
    v_lshlrev_b32 v16, 16, v98
    v_and_b32 v17, 0xffff0000, v98
    v_add_f32 v12, v12, v16
    v_add_f32 v13, v13, v17
    v_fma_f32 v14, v16, v16, v14
    v_fma_f32 v15, v17, v17, v15
    v_lshlrev_b32 v16, 16, v99
    v_and_b32 v17, 0xffff0000, v99
    v_add_f32 v12, v12, v16
    v_add_f32 v13, v13, v17
    v_fma_f32 v14, v16, v16, v14
    v_fma_f32 v15, v17, v17, v15
    s_cmp_lg_u32 s39, 2
    s_cbranch_scc1 L_k1_ws_53
    v_lshlrev_b32 v18, 16, v64
    v_and_b32 v19, 0xffff0000, v64
    v_add_f32 v116, v116, v18
    v_add_f32 v117, v117, v19
    v_lshlrev_b32 v18, 16, v65
    v_and_b32 v19, 0xffff0000, v65
    v_add_f32 v116, v116, v18
    v_add_f32 v117, v117, v19
    v_lshlrev_b32 v18, 16, v66
    v_and_b32 v19, 0xffff0000, v66
    v_add_f32 v116, v116, v18
    v_add_f32 v117, v117, v19
    v_lshlrev_b32 v18, 16, v67
    v_and_b32 v19, 0xffff0000, v67
    v_add_f32 v116, v116, v18
    v_add_f32 v117, v117, v19
L_k1_ws_53:
    s_waitcnt vmcnt(4)
    s_waitcnt lgkmcnt(0)
    s_barrier
    ds_read_b128 v[104:107], v31
    ds_read_b64_tr_b16 v[80:81], v29 offset:0
    ds_read_b64_tr_b16 v[82:83], v29 offset:1024
    v_mfma_f32_32x32x16_bf16 v[144:159], v[68:71], v[96:99], v[144:159]
    s_cmp_lg_u32 s39, 2
    s_cbranch_scc1 L_k1_ws_54
    v_lshlrev_b32 v18, 16, v68
    v_and_b32 v19, 0xffff0000, v68
    v_add_f32 v118, v118, v18
    v_add_f32 v119, v119, v19
    v_lshlrev_b32 v18, 16, v69
    v_and_b32 v19, 0xffff0000, v69
    v_add_f32 v118, v118, v18
    v_add_f32 v119, v119, v19
    v_lshlrev_b32 v18, 16, v70
    v_and_b32 v19, 0xffff0000, v70
    v_add_f32 v118, v118, v18
    v_add_f32 v119, v119, v19
    v_lshlrev_b32 v18, 16, v71
    v_and_b32 v19, 0xffff0000, v71
    v_add_f32 v118, v118, v18
    v_add_f32 v119, v119, v19
L_k1_ws_54:
    s_add_u32 s37, s38, 65536
    s_mov_b32 m0, s37
    s_movk_i32 s36, 640
    buffer_load_dwordx4 v2, s[4:7], s36 offen lds
    ds_read_b64_tr_b16 v[64:65], v30 offset:0
    ds_read_b64_tr_b16 v[66:67], v30 offset:1024
    v_mfma_f32_32x32x16_bf16 v[128:143], v[72:75], v[100:103], v[128:143]
    v_lshlrev_b32 v16, 16, v102
    v_and_b32 v17, 0xffff0000, v102
    v_add_f32 v12, v12, v16
    v_add_f32 v13, v13, v17
    v_fma_f32 v14, v16, v16, v14
    v_fma_f32 v15, v17, v17, v15
    v_lshlrev_b32 v16, 16, v103
    v_and_b32 v17, 0xffff0000, v103
    v_add_f32 v12, v12, v16
    v_add_f32 v13, v13, v17
    v_fma_f32 v14, v16, v16, v14
    v_fma_f32 v15, v17, v17, v15
    s_cmp_lg_u32 s39, 3
    s_cbranch_scc1 L_k1_ws_55
    v_lshlrev_b32 v18, 16, v72
    v_and_b32 v19, 0xffff0000, v72
    v_add_f32 v116, v116, v18
    v_add_f32 v117, v117, v19
    v_lshlrev_b32 v18, 16, v73
    v_and_b32 v19, 0xffff0000, v73
    v_add_f32 v116, v116, v18
    v_add_f32 v117, v117, v19
    v_lshlrev_b32 v18, 16, v74
    v_and_b32 v19, 0xffff0000, v74
    v_add_f32 v116, v116, v18
    v_add_f32 v117, v117, v19
    v_lshlrev_b32 v18, 16, v75
    v_and_b32 v19, 0xffff0000, v75
    v_add_f32 v116, v116, v18
    v_add_f32 v117, v117, v19
L_k1_ws_55:
    s_add_u32 s37, s38, 66560
    s_mov_b32 m0, s37
    s_movk_i32 s36, 640
    buffer_load_dwordx4 v10, s[4:7], s36 offen lds
    ds_read_b128 v[108:111], v32
    ds_read_b64_tr_b16 v[68:69], v29 offset:4096
    ds_read_b64_tr_b16 v[70:71], v29 offset:5120
    v_mfma_f32_32x32x16_bf16 v[144:159], v[76:79], v[100:103], v[144:159]
    s_cmp_lg_u32 s39, 3
    s_cbranch_scc1 L_k1_ws_56
    v_lshlrev_b32 v18, 16, v76
    v_and_b32 v19, 0xffff0000, v76
    v_add_f32 v118, v118, v18
    v_add_f32 v119, v119, v19
    v_lshlrev_b32 v18, 16, v77
    v_and_b32 v19, 0xffff0000, v77
    v_add_f32 v118, v118, v18
    v_add_f32 v119, v119, v19
    v_lshlrev_b32 v18, 16, v78
    v_and_b32 v19, 0xffff0000, v78
    v_add_f32 v118, v118, v18
    v_add_f32 v119, v119, v19
    v_lshlrev_b32 v18, 16, v79
    v_and_b32 v19, 0xffff0000, v79
    v_add_f32 v118, v118, v18
    v_add_f32 v119, v119, v19
L_k1_ws_56:
    s_add_u32 s36, s34, 983040
    s_add_u32 s37, s35, 65536
    s_mov_b32 m0, s37
    s_mov_b64 exec, s[32:33]
    buffer_load_dwordx4 v3, s[8:11], s36 offen lds
    s_mov_b64 exec, -1
    ds_read_b64_tr_b16 v[72:73], v30 offset:4096
    ds_read_b64_tr_b16 v[74:75], v30 offset:5120
    s_waitcnt lgkmcnt(7)
    v_mfma_f32_32x32x16_bf16 v[128:143], v[80:83], v[104:107], v[128:143]
    v_lshlrev_b32 v16, 16, v106
    v_and_b32 v17, 0xffff0000, v106
    v_add_f32 v12, v12, v16
    v_add_f32 v13, v13, v17
    v_fma_f32 v14, v16, v16, v14
    v_fma_f32 v15, v17, v17, v15
    v_lshlrev_b32 v16, 16, v107
    v_and_b32 v17, 0xffff0000, v107
    v_add_f32 v12, v12, v16
    v_add_f32 v13, v13, v17
    v_fma_f32 v14, v16, v16, v14
    v_fma_f32 v15, v17, v17, v15
    s_cmp_lg_u32 s39, 0
    s_cbranch_scc1 L_k1_ws_57
    v_lshlrev_b32 v18, 16, v80
    v_and_b32 v19, 0xffff0000, v80
    v_add_f32 v116, v116, v18
    v_add_f32 v117, v117, v19
    v_lshlrev_b32 v18, 16, v81
    v_and_b32 v19, 0xffff0000, v81
    v_add_f32 v116, v116, v18
    v_add_f32 v117, v117, v19
    v_lshlrev_b32 v18, 16, v82
    v_and_b32 v19, 0xffff0000, v82
    v_add_f32 v116, v116, v18
    v_add_f32 v117, v117, v19
    v_lshlrev_b32 v18, 16, v83
    v_and_b32 v19, 0xffff0000, v83
    v_add_f32 v116, v116, v18
    v_add_f32 v117, v117, v19
L_k1_ws_57:
    s_add_u32 s36, s34, 995328
    s_add_u32 s37, s35, 66560
    s_mov_b32 m0, s37
    s_mov_b64 exec, s[32:33]
    buffer_load_dwordx4 v3, s[8:11], s36 offen lds
    s_mov_b64 exec, -1
    ds_read_b128 v[112:115], v33
    ds_read_b64_tr_b16 v[76:77], v29 offset:8192
    ds_read_b64_tr_b16 v[78:79], v29 offset:9216
    s_waitcnt lgkmcnt(8)
    v_mfma_f32_32x32x16_bf16 v[144:159], v[64:67], v[104:107], v[144:159]
    s_cmp_lg_u32 s39, 0
    s_cbranch_scc1 L_k1_ws_58
    v_lshlrev_b32 v18, 16, v64
    v_and_b32 v19, 0xffff0000, v64
    v_add_f32 v118, v118, v18
    v_add_f32 v119, v119, v19
    v_lshlrev_b32 v18, 16, v65
    v_and_b32 v19, 0xffff0000, v65
    v_add_f32 v118, v118, v18
    v_add_f32 v119, v119, v19
    v_lshlrev_b32 v18, 16, v66
    v_and_b32 v19, 0xffff0000, v66
    v_add_f32 v118, v118, v18
    v_add_f32 v119, v119, v19
    v_lshlrev_b32 v18, 16, v67
    v_and_b32 v19, 0xffff0000, v67
    v_add_f32 v118, v118, v18
    v_add_f32 v119, v119, v19
L_k1_ws_58:
    ds_read_b64_tr_b16 v[80:81], v30 offset:8192
    ds_read_b64_tr_b16 v[82:83], v30 offset:9216
    s_waitcnt lgkmcnt(7)
    v_mfma_f32_32x32x16_bf16 v[128:143], v[68:71], v[108:111], v[128:143]
    v_lshlrev_b32 v16, 16, v110
    v_and_b32 v17, 0xffff0000, v110
    v_add_f32 v12, v12, v16
    v_add_f32 v13, v13, v17
    v_fma_f32 v14, v16, v16, v14
    v_fma_f32 v15, v17, v17, v15
    v_lshlrev_b32 v16, 16, v111
    v_and_b32 v17, 0xffff0000, v111
    v_add_f32 v12, v12, v16
    v_add_f32 v13, v13, v17
    v_fma_f32 v14, v16, v16, v14
    v_fma_f32 v15, v17, v17, v15
    s_cmp_lg_u32 s39, 1
    s_cbranch_scc1 L_k1_ws_59
    v_lshlrev_b32 v18, 16, v68
    v_and_b32 v19, 0xffff0000, v68
    v_add_f32 v116, v116, v18
    v_add_f32 v117, v117, v19
    v_lshlrev_b32 v18, 16, v69
    v_and_b32 v19, 0xffff0000, v69
    v_add_f32 v116, v116, v18
    v_add_f32 v117, v117, v19
    v_lshlrev_b32 v18, 16, v70
    v_and_b32 v19, 0xffff0000, v70
    v_add_f32 v116, v116, v18
    v_add_f32 v117, v117, v19
    v_lshlrev_b32 v18, 16, v71
    v_and_b32 v19, 0xffff0000, v71
    v_add_f32 v116, v116, v18
    v_add_f32 v117, v117, v19
L_k1_ws_59:
    ds_read_b128 v[96:99], v34
    ds_read_b64_tr_b16 v[64:65], v29 offset:12288
    ds_read_b64_tr_b16 v[66:67], v29 offset:13312
    s_waitcnt lgkmcnt(8)
    v_mfma_f32_32x32x16_bf16 v[144:159], v[72:75], v[108:111], v[144:159]
    s_cmp_lg_u32 s39, 1
    s_cbranch_scc1 L_k1_ws_60
    v_lshlrev_b32 v18, 16, v72
    v_and_b32 v19, 0xffff0000, v72
    v_add_f32 v118, v118, v18
    v_add_f32 v119, v119, v19
    v_lshlrev_b32 v18, 16, v73
    v_and_b32 v19, 0xffff0000, v73
    v_add_f32 v118, v118, v18
    v_add_f32 v119, v119, v19
    v_lshlrev_b32 v18, 16, v74
    v_and_b32 v19, 0xffff0000, v74
    v_add_f32 v118, v118, v18
    v_add_f32 v119, v119, v19
    v_lshlrev_b32 v18, 16, v75
    v_and_b32 v19, 0xffff0000, v75
    v_add_f32 v118, v118, v18
    v_add_f32 v119, v119, v19
L_k1_ws_60:
    ds_read_b64_tr_b16 v[68:69], v30 offset:12288
    ds_read_b64_tr_b16 v[70:71], v30 offset:13312
    s_waitcnt lgkmcnt(7)
    v_mfma_f32_32x32x16_bf16 v[128:143], v[76:79], v[112:115], v[128:143]
    v_lshlrev_b32 v16, 16, v114
    v_and_b32 v17, 0xffff0000, v114
    v_add_f32 v12, v12, v16
    v_add_f32 v13, v13, v17
    v_fma_f32 v14, v16, v16, v14
    v_fma_f32 v15, v17, v17, v15
    v_lshlrev_b32 v16, 16, v115
    v_and_b32 v17, 0xffff0000, v115
    v_add_f32 v12, v12, v16
    v_add_f32 v13, v13, v17
    v_fma_f32 v14, v16, v16, v14
    v_fma_f32 v15, v17, v17, v15
    s_cmp_lg_u32 s39, 2
    s_cbranch_scc1 L_k1_ws_61
    v_lshlrev_b32 v18, 16, v76
    v_and_b32 v19, 0xffff0000, v76
    v_add_f32 v116, v116, v18
    v_add_f32 v117, v117, v19
    v_lshlrev_b32 v18, 16, v77
    v_and_b32 v19, 0xffff0000, v77
    v_add_f32 v116, v116, v18
    v_add_f32 v117, v117, v19
    v_lshlrev_b32 v18, 16, v78
    v_and_b32 v19, 0xffff0000, v78
    v_add_f32 v116, v116, v18
    v_add_f32 v117, v117, v19
    v_lshlrev_b32 v18, 16, v79
    v_and_b32 v19, 0xffff0000, v79
    v_add_f32 v116, v116, v18
    v_add_f32 v117, v117, v19
L_k1_ws_61:
    s_waitcnt vmcnt(4)
    s_waitcnt lgkmcnt(0)
    s_barrier
    ds_read_b128 v[100:103], v39
    ds_read_b64_tr_b16 v[72:73], v37 offset:0
    ds_read_b64_tr_b16 v[74:75], v37 offset:1024
    v_mfma_f32_32x32x16_bf16 v[144:159], v[80:83], v[112:115], v[144:159]
    s_cmp_lg_u32 s39, 2
    s_cbranch_scc1 L_k1_ws_62
    v_lshlrev_b32 v18, 16, v80
    v_and_b32 v19, 0xffff0000, v80
    v_add_f32 v118, v118, v18
    v_add_f32 v119, v119, v19
    v_lshlrev_b32 v18, 16, v81
    v_and_b32 v19, 0xffff0000, v81
    v_add_f32 v118, v118, v18
    v_add_f32 v119, v119, v19
    v_lshlrev_b32 v18, 16, v82
    v_and_b32 v19, 0xffff0000, v82
    v_add_f32 v118, v118, v18
    v_add_f32 v119, v119, v19
    v_lshlrev_b32 v18, 16, v83
    v_and_b32 v19, 0xffff0000, v83
    v_add_f32 v118, v118, v18
    v_add_f32 v119, v119, v19
L_k1_ws_62:
    s_add_u32 s37, s38, 0
    s_mov_b32 m0, s37
    s_movk_i32 s36, 768
    buffer_load_dwordx4 v2, s[4:7], s36 offen lds
    ds_read_b64_tr_b16 v[76:77], v38 offset:0
    ds_read_b64_tr_b16 v[78:79], v38 offset:1024
    v_mfma_f32_32x32x16_bf16 v[128:143], v[64:67], v[96:99], v[128:143]
    v_lshlrev_b32 v16, 16, v98
    v_and_b32 v17, 0xffff0000, v98
    v_add_f32 v12, v12, v16
    v_add_f32 v13, v13, v17
    v_fma_f32 v14, v16, v16, v14
    v_fma_f32 v15, v17, v17, v15
    v_lshlrev_b32 v16, 16, v99
    v_and_b32 v17, 0xffff0000, v99
    v_add_f32 v12, v12, v16
    v_add_f32 v13, v13, v17
    v_fma_f32 v14, v16, v16, v14
    v_fma_f32 v15, v17, v17, v15
    s_cmp_lg_u32 s39, 3
    s_cbranch_scc1 L_k1_ws_63
    v_lshlrev_b32 v18, 16, v64
    v_and_b32 v19, 0xffff0000, v64
    v_add_f32 v116, v116, v18
    v_add_f32 v117, v117, v19
    v_lshlrev_b32 v18, 16, v65
    v_and_b32 v19, 0xffff0000, v65
    v_add_f32 v116, v116, v18
    v_add_f32 v117, v117, v19
    v_lshlrev_b32 v18, 16, v66
    v_and_b32 v19, 0xffff0000, v66
    v_add_f32 v116, v116, v18
    v_add_f32 v117, v117, v19
    v_lshlrev_b32 v18, 16, v67
    v_and_b32 v19, 0xffff0000, v67
    v_add_f32 v116, v116, v18
    v_add_f32 v117, v117, v19
L_k1_ws_63:
    s_add_u32 s37, s38, 1024
    s_mov_b32 m0, s37
    s_movk_i32 s36, 768
    buffer_load_dwordx4 v10, s[4:7], s36 offen lds
    ds_read_b128 v[104:107], v40
    ds_read_b64_tr_b16 v[80:81], v37 offset:4096
    ds_read_b64_tr_b16 v[82:83], v37 offset:5120
    v_mfma_f32_32x32x16_bf16 v[144:159], v[68:71], v[96:99], v[144:159]
    s_cmp_lg_u32 s39, 3
    s_cbranch_scc1 L_k1_ws_64
    v_lshlrev_b32 v18, 16, v68
    v_and_b32 v19, 0xffff0000, v68
    v_add_f32 v118, v118, v18
    v_add_f32 v119, v119, v19
    v_lshlrev_b32 v18, 16, v69
    v_and_b32 v19, 0xffff0000, v69
    v_add_f32 v118, v118, v18
    v_add_f32 v119, v119, v19
    v_lshlrev_b32 v18, 16, v70
    v_and_b32 v19, 0xffff0000, v70
    v_add_f32 v118, v118, v18
    v_add_f32 v119, v119, v19
    v_lshlrev_b32 v18, 16, v71
    v_and_b32 v19, 0xffff0000, v71
    v_add_f32 v118, v118, v18
    v_add_f32 v119, v119, v19
L_k1_ws_64:
    s_add_u32 s36, s34, 1179648
    s_add_u32 s37, s35, 0
    s_mov_b32 m0, s37
    s_mov_b64 exec, s[32:33]
    buffer_load_dwordx4 v3, s[8:11], s36 offen lds
    s_mov_b64 exec, -1
    ds_read_b64_tr_b16 v[64:65], v38 offset:4096
    ds_read_b64_tr_b16 v[66:67], v38 offset:5120
    s_waitcnt lgkmcnt(7)
    v_mfma_f32_32x32x16_bf16 v[128:143], v[72:75], v[100:103], v[128:143]
    v_lshlrev_b32 v16, 16, v102
    v_and_b32 v17, 0xffff0000, v102
    v_add_f32 v12, v12, v16
    v_add_f32 v13, v13, v17
    v_fma_f32 v14, v16, v16, v14
    v_fma_f32 v15, v17, v17, v15
    v_lshlrev_b32 v16, 16, v103
    v_and_b32 v17, 0xffff0000, v103
    v_add_f32 v12, v12, v16
    v_add_f32 v13, v13, v17
    v_fma_f32 v14, v16, v16, v14
    v_fma_f32 v15, v17, v17, v15
    s_cmp_lg_u32 s39, 0
    s_cbranch_scc1 L_k1_ws_65
    v_lshlrev_b32 v18, 16, v72
    v_and_b32 v19, 0xffff0000, v72
    v_add_f32 v116, v116, v18
    v_add_f32 v117, v117, v19
    v_lshlrev_b32 v18, 16, v73
    v_and_b32 v19, 0xffff0000, v73
    v_add_f32 v116, v116, v18
    v_add_f32 v117, v117, v19
    v_lshlrev_b32 v18, 16, v74
    v_and_b32 v19, 0xffff0000, v74
    v_add_f32 v116, v116, v18
    v_add_f32 v117, v117, v19
    v_lshlrev_b32 v18, 16, v75
    v_and_b32 v19, 0xffff0000, v75
    v_add_f32 v116, v116, v18
    v_add_f32 v117, v117, v19
L_k1_ws_65:
    s_add_u32 s36, s34, 1191936
    s_add_u32 s37, s35, 1024
    s_mov_b32 m0, s37
    s_mov_b64 exec, s[32:33]
    buffer_load_dwordx4 v3, s[8:11], s36 offen lds
    s_mov_b64 exec, -1
    ds_read_b128 v[108:111], v41
    ds_read_b64_tr_b16 v[68:69], v37 offset:8192
    ds_read_b64_tr_b16 v[70:71], v37 offset:9216
    s_waitcnt lgkmcnt(8)
    v_mfma_f32_32x32x16_bf16 v[144:159], v[76:79], v[100:103], v[144:159]
    s_cmp_lg_u32 s39, 0
    s_cbranch_scc1 L_k1_ws_66
    v_lshlrev_b32 v18, 16, v76
    v_and_b32 v19, 0xffff0000, v76
    v_add_f32 v118, v118, v18
    v_add_f32 v119, v119, v19
    v_lshlrev_b32 v18, 16, v77
    v_and_b32 v19, 0xffff0000, v77
    v_add_f32 v118, v118, v18
    v_add_f32 v119, v119, v19
    v_lshlrev_b32 v18, 16, v78
    v_and_b32 v19, 0xffff0000, v78
    v_add_f32 v118, v118, v18
    v_add_f32 v119, v119, v19
    v_lshlrev_b32 v18, 16, v79
    v_and_b32 v19, 0xffff0000, v79
    v_add_f32 v118, v118, v18
    v_add_f32 v119, v119, v19
L_k1_ws_66:
    ds_read_b64_tr_b16 v[72:73], v38 offset:8192
    ds_read_b64_tr_b16 v[74:75], v38 offset:9216
    s_waitcnt lgkmcnt(7)
    v_mfma_f32_32x32x16_bf16 v[128:143], v[80:83], v[104:107], v[128:143]
    v_lshlrev_b32 v16, 16, v106
    v_and_b32 v17, 0xffff0000, v106
    v_add_f32 v12, v12, v16
    v_add_f32 v13, v13, v17
    v_fma_f32 v14, v16, v16, v14
    v_fma_f32 v15, v17, v17, v15
    v_lshlrev_b32 v16, 16, v107
    v_and_b32 v17, 0xffff0000, v107
    v_add_f32 v12, v12, v16
    v_add_f32 v13, v13, v17
    v_fma_f32 v14, v16, v16, v14
    v_fma_f32 v15, v17, v17, v15
    s_cmp_lg_u32 s39, 1
    s_cbranch_scc1 L_k1_ws_67
    v_lshlrev_b32 v18, 16, v80
    v_and_b32 v19, 0xffff0000, v80
    v_add_f32 v116, v116, v18
    v_add_f32 v117, v117, v19
    v_lshlrev_b32 v18, 16, v81
    v_and_b32 v19, 0xffff0000, v81
    v_add_f32 v116, v116, v18
    v_add_f32 v117, v117, v19
    v_lshlrev_b32 v18, 16, v82
    v_and_b32 v19, 0xffff0000, v82
    v_add_f32 v116, v116, v18
    v_add_f32 v117, v117, v19
    v_lshlrev_b32 v18, 16, v83
    v_and_b32 v19, 0xffff0000, v83
    v_add_f32 v116, v116, v18
    v_add_f32 v117, v117, v19
L_k1_ws_67:
    ds_read_b128 v[112:115], v42
    ds_read_b64_tr_b16 v[76:77], v37 offset:12288
    ds_read_b64_tr_b16 v[78:79], v37 offset:13312
    s_waitcnt lgkmcnt(8)
    v_mfma_f32_32x32x16_bf16 v[144:159], v[64:67], v[104:107], v[144:159]
    s_cmp_lg_u32 s39, 1
    s_cbranch_scc1 L_k1_ws_68
    v_lshlrev_b32 v18, 16, v64
    v_and_b32 v19, 0xffff0000, v64
    v_add_f32 v118, v118, v18
    v_add_f32 v119, v119, v19
    v_lshlrev_b32 v18, 16, v65
    v_and_b32 v19, 0xffff0000, v65
    v_add_f32 v118, v118, v18
    v_add_f32 v119, v119, v19
    v_lshlrev_b32 v18, 16, v66
    v_and_b32 v19, 0xffff0000, v66
    v_add_f32 v118, v118, v18
    v_add_f32 v119, v119, v19
    v_lshlrev_b32 v18, 16, v67
    v_and_b32 v19, 0xffff0000, v67
    v_add_f32 v118, v118, v18
    v_add_f32 v119, v119, v19
L_k1_ws_68:
    ds_read_b64_tr_b16 v[80:81], v38 offset:12288
    ds_read_b64_tr_b16 v[82:83], v38 offset:13312
    s_waitcnt lgkmcnt(7)
    v_mfma_f32_32x32x16_bf16 v[128:143], v[68:71], v[108:111], v[128:143]
    v_lshlrev_b32 v16, 16, v110
    v_and_b32 v17, 0xffff0000, v110
    v_add_f32 v12, v12, v16
    v_add_f32 v13, v13, v17
    v_fma_f32 v14, v16, v16, v14
    v_fma_f32 v15, v17, v17, v15
    v_lshlrev_b32 v16, 16, v111
    v_and_b32 v17, 0xffff0000, v111
    v_add_f32 v12, v12, v16
    v_add_f32 v13, v13, v17
    v_fma_f32 v14, v16, v16, v14
    v_fma_f32 v15, v17, v17, v15
    s_cmp_lg_u32 s39, 2
    s_cbranch_scc1 L_k1_ws_69
    v_lshlrev_b32 v18, 16, v68
    v_and_b32 v19, 0xffff0000, v68
    v_add_f32 v116, v116, v18
    v_add_f32 v117, v117, v19
    v_lshlrev_b32 v18, 16, v69
    v_and_b32 v19, 0xffff0000, v69
    v_add_f32 v116, v116, v18
    v_add_f32 v117, v117, v19
    v_lshlrev_b32 v18, 16, v70
    v_and_b32 v19, 0xffff0000, v70
    v_add_f32 v116, v116, v18
    v_add_f32 v117, v117, v19
    v_lshlrev_b32 v18, 16, v71
    v_and_b32 v19, 0xffff0000, v71
    v_add_f32 v116, v116, v18
    v_add_f32 v117, v117, v19
L_k1_ws_69:
    s_waitcnt vmcnt(4)
    s_waitcnt lgkmcnt(0)
    s_barrier
    ds_read_b128 v[96:99], v47
    ds_read_b64_tr_b16 v[64:65], v45 offset:0
    ds_read_b64_tr_b16 v[66:67], v45 offset:1024
    v_mfma_f32_32x32x16_bf16 v[144:159], v[72:75], v[108:111], v[144:159]
    s_cmp_lg_u32 s39, 2
    s_cbranch_scc1 L_k1_ws_70
    v_lshlrev_b32 v18, 16, v72
    v_and_b32 v19, 0xffff0000, v72
    v_add_f32 v118, v118, v18
    v_add_f32 v119, v119, v19
    v_lshlrev_b32 v18, 16, v73
    v_and_b32 v19, 0xffff0000, v73
    v_add_f32 v118, v118, v18
    v_add_f32 v119, v119, v19
    v_lshlrev_b32 v18, 16, v74
    v_and_b32 v19, 0xffff0000, v74
    v_add_f32 v118, v118, v18
    v_add_f32 v119, v119, v19
    v_lshlrev_b32 v18, 16, v75
    v_and_b32 v19, 0xffff0000, v75
    v_add_f32 v118, v118, v18
    v_add_f32 v119, v119, v19
L_k1_ws_70:
    s_add_u32 s37, s38, 32768
    s_mov_b32 m0, s37
    s_movk_i32 s36, 896
    buffer_load_dwordx4 v2, s[4:7], s36 offen lds
    ds_read_b64_tr_b16 v[68:69], v46 offset:0
    ds_read_b64_tr_b16 v[70:71], v46 offset:1024
    v_mfma_f32_32x32x16_bf16 v[128:143], v[76:79], v[112:115], v[128:143]
    v_lshlrev_b32 v16, 16, v114
    v_and_b32 v17, 0xffff0000, v114
    v_add_f32 v12, v12, v16
    v_add_f32 v13, v13, v17
    v_fma_f32 v14, v16, v16, v14
    v_fma_f32 v15, v17, v17, v15
    v_lshlrev_b32 v16, 16, v115
    v_and_b32 v17, 0xffff0000, v115
    v_add_f32 v12, v12, v16
    v_add_f32 v13, v13, v17
    v_fma_f32 v14, v16, v16, v14
    v_fma_f32 v15, v17, v17, v15
    s_cmp_lg_u32 s39, 3
    s_cbranch_scc1 L_k1_ws_71
    v_lshlrev_b32 v18, 16, v76
    v_and_b32 v19, 0xffff0000, v76
    v_add_f32 v116, v116, v18
    v_add_f32 v117, v117, v19
    v_lshlrev_b32 v18, 16, v77
    v_and_b32 v19, 0xffff0000, v77
    v_add_f32 v116, v116, v18
    v_add_f32 v117, v117, v19
    v_lshlrev_b32 v18, 16, v78
    v_and_b32 v19, 0xffff0000, v78
    v_add_f32 v116, v116, v18
    v_add_f32 v117, v117, v19
    v_lshlrev_b32 v18, 16, v79
    v_and_b32 v19, 0xffff0000, v79
    v_add_f32 v116, v116, v18
    v_add_f32 v117, v117, v19
L_k1_ws_71:
    s_add_u32 s37, s38, 33792
    s_mov_b32 m0, s37
    s_movk_i32 s36, 896
    buffer_load_dwordx4 v10, s[4:7], s36 offen lds
    ds_read_b128 v[100:103], v48
    ds_read_b64_tr_b16 v[72:73], v45 offset:4096
    ds_read_b64_tr_b16 v[74:75], v45 offset:5120
    v_mfma_f32_32x32x16_bf16 v[144:159], v[80:83], v[112:115], v[144:159]
    s_cmp_lg_u32 s39, 3
    s_cbranch_scc1 L_k1_ws_72
    v_lshlrev_b32 v18, 16, v80
    v_and_b32 v19, 0xffff0000, v80
    v_add_f32 v118, v118, v18
    v_add_f32 v119, v119, v19
    v_lshlrev_b32 v18, 16, v81
    v_and_b32 v19, 0xffff0000, v81
    v_add_f32 v118, v118, v18
    v_add_f32 v119, v119, v19
    v_lshlrev_b32 v18, 16, v82
    v_and_b32 v19, 0xffff0000, v82
    v_add_f32 v118, v118, v18
    v_add_f32 v119, v119, v19
    v_lshlrev_b32 v18, 16, v83
    v_and_b32 v19, 0xffff0000, v83
    v_add_f32 v118, v118, v18
    v_add_f32 v119, v119, v19
L_k1_ws_72:
    s_add_u32 s36, s34, 1376256
    s_add_u32 s37, s35, 32768
    s_mov_b32 m0, s37
    s_mov_b64 exec, s[32:33]
    buffer_load_dwordx4 v3, s[8:11], s36 offen lds
    s_mov_b64 exec, -1
    ds_read_b64_tr_b16 v[76:77], v46 offset:4096
    ds_read_b64_tr_b16 v[78:79], v46 offset:5120
    s_waitcnt lgkmcnt(7)
    v_mfma_f32_32x32x16_bf16 v[128:143], v[64:67], v[96:99], v[128:143]
    v_lshlrev_b32 v16, 16, v98
    v_and_b32 v17, 0xffff0000, v98
    v_add_f32 v12, v12, v16
    v_add_f32 v13, v13, v17
    v_fma_f32 v14, v16, v16, v14
    v_fma_f32 v15, v17, v17, v15
    v_lshlrev_b32 v16, 16, v99
    v_and_b32 v17, 0xffff0000, v99
    v_add_f32 v12, v12, v16
    v_add_f32 v13, v13, v17
    v_fma_f32 v14, v16, v16, v14
    v_fma_f32 v15, v17, v17, v15
    s_cmp_lg_u32 s39, 0
    s_cbranch_scc1 L_k1_ws_73
    v_lshlrev_b32 v18, 16, v64
    v_and_b32 v19, 0xffff0000, v64
    v_add_f32 v116, v116, v18
    v_add_f32 v117, v117, v19
    v_lshlrev_b32 v18, 16, v65
    v_and_b32 v19, 0xffff0000, v65
    v_add_f32 v116, v116, v18
    v_add_f32 v117, v117, v19
    v_lshlrev_b32 v18, 16, v66
    v_and_b32 v19, 0xffff0000, v66
    v_add_f32 v116, v116, v18
    v_add_f32 v117, v117, v19
    v_lshlrev_b32 v18, 16, v67
    v_and_b32 v19, 0xffff0000, v67
    v_add_f32 v116, v116, v18
    v_add_f32 v117, v117, v19
L_k1_ws_73:
    s_add_u32 s36, s34, 1388544
    s_add_u32 s37, s35, 33792
    s_mov_b32 m0, s37
    s_mov_b64 exec, s[32:33]
    buffer_load_dwordx4 v3, s[8:11], s36 offen lds
    s_mov_b64 exec, -1
    ds_read_b128 v[104:107], v49
    ds_read_b64_tr_b16 v[80:81], v45 offset:8192
    ds_read_b64_tr_b16 v[82:83], v45 offset:9216
    s_waitcnt lgkmcnt(8)
    v_mfma_f32_32x32x16_bf16 v[144:159], v[68:71], v[96:99], v[144:159]
    s_cmp_lg_u32 s39, 0
    s_cbranch_scc1 L_k1_ws_74
    v_lshlrev_b32 v18, 16, v68
    v_and_b32 v19, 0xffff0000, v68
    v_add_f32 v118, v118, v18
    v_add_f32 v119, v119, v19
    v_lshlrev_b32 v18, 16, v69
    v_and_b32 v19, 0xffff0000, v69
    v_add_f32 v118, v118, v18
    v_add_f32 v119, v119, v19
    v_lshlrev_b32 v18, 16, v70
    v_and_b32 v19, 0xffff0000, v70
    v_add_f32 v118, v118, v18
    v_add_f32 v119, v119, v19
    v_lshlrev_b32 v18, 16, v71
    v_and_b32 v19, 0xffff0000, v71
    v_add_f32 v118, v118, v18
    v_add_f32 v119, v119, v19
L_k1_ws_74:
    ds_read_b64_tr_b16 v[64:65], v46 offset:8192
    ds_read_b64_tr_b16 v[66:67], v46 offset:9216
    s_waitcnt lgkmcnt(7)
    v_mfma_f32_32x32x16_bf16 v[128:143], v[72:75], v[100:103], v[128:143]
    v_lshlrev_b32 v16, 16, v102
    v_and_b32 v17, 0xffff0000, v102
    v_add_f32 v12, v12, v16
    v_add_f32 v13, v13, v17
    v_fma_f32 v14, v16, v16, v14
    v_fma_f32 v15, v17, v17, v15
    v_lshlrev_b32 v16, 16, v103
    v_and_b32 v17, 0xffff0000, v103
    v_add_f32 v12, v12, v16
    v_add_f32 v13, v13, v17
    v_fma_f32 v14, v16, v16, v14
    v_fma_f32 v15, v17, v17, v15
    s_cmp_lg_u32 s39, 1
    s_cbranch_scc1 L_k1_ws_75
    v_lshlrev_b32 v18, 16, v72
    v_and_b32 v19, 0xffff0000, v72
    v_add_f32 v116, v116, v18
    v_add_f32 v117, v117, v19
    v_lshlrev_b32 v18, 16, v73
    v_and_b32 v19, 0xffff0000, v73
    v_add_f32 v116, v116, v18
    v_add_f32 v117, v117, v19
    v_lshlrev_b32 v18, 16, v74
    v_and_b32 v19, 0xffff0000, v74
    v_add_f32 v116, v116, v18
    v_add_f32 v117, v117, v19
    v_lshlrev_b32 v18, 16, v75
    v_and_b32 v19, 0xffff0000, v75
    v_add_f32 v116, v116, v18
    v_add_f32 v117, v117, v19
L_k1_ws_75:
    ds_read_b128 v[108:111], v50
    ds_read_b64_tr_b16 v[68:69], v45 offset:12288
    ds_read_b64_tr_b16 v[70:71], v45 offset:13312
    s_waitcnt lgkmcnt(8)
    v_mfma_f32_32x32x16_bf16 v[144:159], v[76:79], v[100:103], v[144:159]
    s_cmp_lg_u32 s39, 1
    s_cbranch_scc1 L_k1_ws_76
    v_lshlrev_b32 v18, 16, v76
    v_and_b32 v19, 0xffff0000, v76
    v_add_f32 v118, v118, v18
    v_add_f32 v119, v119, v19
    v_lshlrev_b32 v18, 16, v77
    v_and_b32 v19, 0xffff0000, v77
    v_add_f32 v118, v118, v18
    v_add_f32 v119, v119, v19
    v_lshlrev_b32 v18, 16, v78
    v_and_b32 v19, 0xffff0000, v78
    v_add_f32 v118, v118, v18
    v_add_f32 v119, v119, v19
    v_lshlrev_b32 v18, 16, v79
    v_and_b32 v19, 0xffff0000, v79
    v_add_f32 v118, v118, v18
    v_add_f32 v119, v119, v19
L_k1_ws_76:
    ds_read_b64_tr_b16 v[72:73], v46 offset:12288
    ds_read_b64_tr_b16 v[74:75], v46 offset:13312
    s_waitcnt lgkmcnt(7)
    v_mfma_f32_32x32x16_bf16 v[128:143], v[80:83], v[104:107], v[128:143]
    v_lshlrev_b32 v16, 16, v106
    v_and_b32 v17, 0xffff0000, v106
    v_add_f32 v12, v12, v16
    v_add_f32 v13, v13, v17
    v_fma_f32 v14, v16, v16, v14
    v_fma_f32 v15, v17, v17, v15
    v_lshlrev_b32 v16, 16, v107
    v_and_b32 v17, 0xffff0000, v107
    v_add_f32 v12, v12, v16
    v_add_f32 v13, v13, v17
    v_fma_f32 v14, v16, v16, v14
    v_fma_f32 v15, v17, v17, v15
    s_cmp_lg_u32 s39, 2
    s_cbranch_scc1 L_k1_ws_77
    v_lshlrev_b32 v18, 16, v80
    v_and_b32 v19, 0xffff0000, v80
    v_add_f32 v116, v116, v18
    v_add_f32 v117, v117, v19
    v_lshlrev_b32 v18, 16, v81
    v_and_b32 v19, 0xffff0000, v81
    v_add_f32 v116, v116, v18
    v_add_f32 v117, v117, v19
    v_lshlrev_b32 v18, 16, v82
    v_and_b32 v19, 0xffff0000, v82
    v_add_f32 v116, v116, v18
    v_add_f32 v117, v117, v19
    v_lshlrev_b32 v18, 16, v83
    v_and_b32 v19, 0xffff0000, v83
    v_add_f32 v116, v116, v18
    v_add_f32 v117, v117, v19
L_k1_ws_77:
    s_waitcnt vmcnt(4)
    s_waitcnt lgkmcnt(0)
    s_barrier
    ds_read_b128 v[112:115], v31
    ds_read_b64_tr_b16 v[76:77], v29 offset:0
    ds_read_b64_tr_b16 v[78:79], v29 offset:1024
    v_mfma_f32_32x32x16_bf16 v[144:159], v[64:67], v[104:107], v[144:159]
    s_cmp_lg_u32 s39, 2
    s_cbranch_scc1 L_k1_ws_78
    v_lshlrev_b32 v18, 16, v64
    v_and_b32 v19, 0xffff0000, v64
    v_add_f32 v118, v118, v18
    v_add_f32 v119, v119, v19
    v_lshlrev_b32 v18, 16, v65
    v_and_b32 v19, 0xffff0000, v65
    v_add_f32 v118, v118, v18
    v_add_f32 v119, v119, v19
    v_lshlrev_b32 v18, 16, v66
    v_and_b32 v19, 0xffff0000, v66
    v_add_f32 v118, v118, v18
    v_add_f32 v119, v119, v19
    v_lshlrev_b32 v18, 16, v67
    v_and_b32 v19, 0xffff0000, v67
    v_add_f32 v118, v118, v18
    v_add_f32 v119, v119, v19
L_k1_ws_78:
    ds_read_b64_tr_b16 v[80:81], v30 offset:0
    ds_read_b64_tr_b16 v[82:83], v30 offset:1024
    v_mfma_f32_32x32x16_bf16 v[128:143], v[68:71], v[108:111], v[128:143]
    v_lshlrev_b32 v16, 16, v110
    v_and_b32 v17, 0xffff0000, v110
    v_add_f32 v12, v12, v16
    v_add_f32 v13, v13, v17
    v_fma_f32 v14, v16, v16, v14
    v_fma_f32 v15, v17, v17, v15
    v_lshlrev_b32 v16, 16, v111
    v_and_b32 v17, 0xffff0000, v111
    v_add_f32 v12, v12, v16
    v_add_f32 v13, v13, v17
    v_fma_f32 v14, v16, v16, v14
    v_fma_f32 v15, v17, v17, v15
    s_cmp_lg_u32 s39, 3
    s_cbranch_scc1 L_k1_ws_79
    v_lshlrev_b32 v18, 16, v68
    v_and_b32 v19, 0xffff0000, v68
    v_add_f32 v116, v116, v18
    v_add_f32 v117, v117, v19
    v_lshlrev_b32 v18, 16, v69
    v_and_b32 v19, 0xffff0000, v69
    v_add_f32 v116, v116, v18
    v_add_f32 v117, v117, v19
    v_lshlrev_b32 v18, 16, v70
    v_and_b32 v19, 0xffff0000, v70
    v_add_f32 v116, v116, v18
    v_add_f32 v117, v117, v19
    v_lshlrev_b32 v18, 16, v71
    v_and_b32 v19, 0xffff0000, v71
    v_add_f32 v116, v116, v18
    v_add_f32 v117, v117, v19
L_k1_ws_79:
    ds_read_b128 v[96:99], v32
    ds_read_b64_tr_b16 v[64:65], v29 offset:4096
    ds_read_b64_tr_b16 v[66:67], v29 offset:5120
    v_mfma_f32_32x32x16_bf16 v[144:159], v[72:75], v[108:111], v[144:159]
    s_cmp_lg_u32 s39, 3
    s_cbranch_scc1 L_k1_ws_80
    v_lshlrev_b32 v18, 16, v72
    v_and_b32 v19, 0xffff0000, v72
    v_add_f32 v118, v118, v18
    v_add_f32 v119, v119, v19
    v_lshlrev_b32 v18, 16, v73
    v_and_b32 v19, 0xffff0000, v73
    v_add_f32 v118, v118, v18
    v_add_f32 v119, v119, v19
    v_lshlrev_b32 v18, 16, v74
    v_and_b32 v19, 0xffff0000, v74
    v_add_f32 v118, v118, v18
    v_add_f32 v119, v119, v19
    v_lshlrev_b32 v18, 16, v75
    v_and_b32 v19, 0xffff0000, v75
    v_add_f32 v118, v118, v18
    v_add_f32 v119, v119, v19
L_k1_ws_80:
    ds_read_b64_tr_b16 v[68:69], v30 offset:4096
    ds_read_b64_tr_b16 v[70:71], v30 offset:5120
    s_waitcnt lgkmcnt(7)
    v_mfma_f32_32x32x16_bf16 v[128:143], v[76:79], v[112:115], v[128:143]
    v_lshlrev_b32 v16, 16, v114
    v_and_b32 v17, 0xffff0000, v114
    v_add_f32 v12, v12, v16
    v_add_f32 v13, v13, v17
    v_fma_f32 v14, v16, v16, v14
    v_fma_f32 v15, v17, v17, v15
    v_lshlrev_b32 v16, 16, v115
    v_and_b32 v17, 0xffff0000, v115
    v_add_f32 v12, v12, v16
    v_add_f32 v13, v13, v17
    v_fma_f32 v14, v16, v16, v14
    v_fma_f32 v15, v17, v17, v15
    s_cmp_lg_u32 s39, 0
    s_cbranch_scc1 L_k1_ws_81
    v_lshlrev_b32 v18, 16, v76
    v_and_b32 v19, 0xffff0000, v76
    v_add_f32 v116, v116, v18
    v_add_f32 v117, v117, v19
    v_lshlrev_b32 v18, 16, v77
    v_and_b32 v19, 0xffff0000, v77
    v_add_f32 v116, v116, v18
    v_add_f32 v117, v117, v19
    v_lshlrev_b32 v18, 16, v78
    v_and_b32 v19, 0xffff0000, v78
    v_add_f32 v116, v116, v18
    v_add_f32 v117, v117, v19
    v_lshlrev_b32 v18, 16, v79
    v_and_b32 v19, 0xffff0000, v79
    v_add_f32 v116, v116, v18
    v_add_f32 v117, v117, v19
L_k1_ws_81:
    ds_read_b128 v[100:103], v33
    ds_read_b64_tr_b16 v[72:73], v29 offset:8192
    ds_read_b64_tr_b16 v[74:75], v29 offset:9216
    s_waitcnt lgkmcnt(8)
    v_mfma_f32_32x32x16_bf16 v[144:159], v[80:83], v[112:115], v[144:159]
    s_cmp_lg_u32 s39, 0
    s_cbranch_scc1 L_k1_ws_82
    v_lshlrev_b32 v18, 16, v80
    v_and_b32 v19, 0xffff0000, v80
    v_add_f32 v118, v118, v18
    v_add_f32 v119, v119, v19
    v_lshlrev_b32 v18, 16, v81
    v_and_b32 v19, 0xffff0000, v81
    v_add_f32 v118, v118, v18
    v_add_f32 v119, v119, v19
    v_lshlrev_b32 v18, 16, v82
    v_and_b32 v19, 0xffff0000, v82
    v_add_f32 v118, v118, v18
    v_add_f32 v119, v119, v19
    v_lshlrev_b32 v18, 16, v83
    v_and_b32 v19, 0xffff0000, v83
    v_add_f32 v118, v118, v18
    v_add_f32 v119, v119, v19
L_k1_ws_82:
    ds_read_b64_tr_b16 v[76:77], v30 offset:8192
    ds_read_b64_tr_b16 v[78:79], v30 offset:9216
    s_waitcnt lgkmcnt(7)
    v_mfma_f32_32x32x16_bf16 v[128:143], v[64:67], v[96:99], v[128:143]
    v_lshlrev_b32 v16, 16, v98
    v_and_b32 v17, 0xffff0000, v98
    v_add_f32 v12, v12, v16
    v_add_f32 v13, v13, v17
    v_fma_f32 v14, v16, v16, v14
    v_fma_f32 v15, v17, v17, v15
    v_lshlrev_b32 v16, 16, v99
    v_and_b32 v17, 0xffff0000, v99
    v_add_f32 v12, v12, v16
    v_add_f32 v13, v13, v17
    v_fma_f32 v14, v16, v16, v14
    v_fma_f32 v15, v17, v17, v15
    s_cmp_lg_u32 s39, 1
    s_cbranch_scc1 L_k1_ws_83
    v_lshlrev_b32 v18, 16, v64
    v_and_b32 v19, 0xffff0000, v64
    v_add_f32 v116, v116, v18
    v_add_f32 v117, v117, v19
    v_lshlrev_b32 v18, 16, v65
    v_and_b32 v19, 0xffff0000, v65
    v_add_f32 v116, v116, v18
    v_add_f32 v117, v117, v19
    v_lshlrev_b32 v18, 16, v66
    v_and_b32 v19, 0xffff0000, v66
    v_add_f32 v116, v116, v18
    v_add_f32 v117, v117, v19
    v_lshlrev_b32 v18, 16, v67
    v_and_b32 v19, 0xffff0000, v67
    v_add_f32 v116, v116, v18
    v_add_f32 v117, v117, v19
L_k1_ws_83:
    ds_read_b128 v[104:107], v34
    ds_read_b64_tr_b16 v[80:81], v29 offset:12288
    ds_read_b64_tr_b16 v[82:83], v29 offset:13312
    s_waitcnt lgkmcnt(8)
    v_mfma_f32_32x32x16_bf16 v[144:159], v[68:71], v[96:99], v[144:159]
    s_cmp_lg_u32 s39, 1
    s_cbranch_scc1 L_k1_ws_84
    v_lshlrev_b32 v18, 16, v68
    v_and_b32 v19, 0xffff0000, v68
    v_add_f32 v118, v118, v18
    v_add_f32 v119, v119, v19
    v_lshlrev_b32 v18, 16, v69
    v_and_b32 v19, 0xffff0000, v69
    v_add_f32 v118, v118, v18
    v_add_f32 v119, v119, v19
    v_lshlrev_b32 v18, 16, v70
    v_and_b32 v19, 0xffff0000, v70
    v_add_f32 v118, v118, v18
    v_add_f32 v119, v119, v19
    v_lshlrev_b32 v18, 16, v71
    v_and_b32 v19, 0xffff0000, v71
    v_add_f32 v118, v118, v18
    v_add_f32 v119, v119, v19
L_k1_ws_84:
    ds_read_b64_tr_b16 v[64:65], v30 offset:12288
    ds_read_b64_tr_b16 v[66:67], v30 offset:13312
    s_waitcnt lgkmcnt(7)
    v_mfma_f32_32x32x16_bf16 v[128:143], v[72:75], v[100:103], v[128:143]
    v_lshlrev_b32 v16, 16, v102
    v_and_b32 v17, 0xffff0000, v102
    v_add_f32 v12, v12, v16
    v_add_f32 v13, v13, v17
    v_fma_f32 v14, v16, v16, v14
    v_fma_f32 v15, v17, v17, v15
    v_lshlrev_b32 v16, 16, v103
    v_and_b32 v17, 0xffff0000, v103
    v_add_f32 v12, v12, v16
    v_add_f32 v13, v13, v17
    v_fma_f32 v14, v16, v16, v14
    v_fma_f32 v15, v17, v17, v15
    s_cmp_lg_u32 s39, 2
    s_cbranch_scc1 L_k1_ws_85
    v_lshlrev_b32 v18, 16, v72
    v_and_b32 v19, 0xffff0000, v72
    v_add_f32 v116, v116, v18
    v_add_f32 v117, v117, v19
    v_lshlrev_b32 v18, 16, v73
    v_and_b32 v19, 0xffff0000, v73
    v_add_f32 v116, v116, v18
    v_add_f32 v117, v117, v19
    v_lshlrev_b32 v18, 16, v74
    v_and_b32 v19, 0xffff0000, v74
    v_add_f32 v116, v116, v18
    v_add_f32 v117, v117, v19
    v_lshlrev_b32 v18, 16, v75
    v_and_b32 v19, 0xffff0000, v75
    v_add_f32 v116, v116, v18
    v_add_f32 v117, v117, v19
L_k1_ws_85:
    s_waitcnt vmcnt(0)
    s_waitcnt lgkmcnt(0)
    s_barrier
    ds_read_b128 v[108:111], v39
    ds_read_b64_tr_b16 v[68:69], v37 offset:0
    ds_read_b64_tr_b16 v[70:71], v37 offset:1024
    v_mfma_f32_32x32x16_bf16 v[144:159], v[76:79], v[100:103], v[144:159]
    s_cmp_lg_u32 s39, 2
    s_cbranch_scc1 L_k1_ws_86
    v_lshlrev_b32 v18, 16, v76
    v_and_b32 v19, 0xffff0000, v76
    v_add_f32 v118, v118, v18
    v_add_f32 v119, v119, v19
    v_lshlrev_b32 v18, 16, v77
    v_and_b32 v19, 0xffff0000, v77
    v_add_f32 v118, v118, v18
    v_add_f32 v119, v119, v19
    v_lshlrev_b32 v18, 16, v78
    v_and_b32 v19, 0xffff0000, v78
    v_add_f32 v118, v118, v18
    v_add_f32 v119, v119, v19
    v_lshlrev_b32 v18, 16, v79
    v_and_b32 v19, 0xffff0000, v79
    v_add_f32 v118, v118, v18
    v_add_f32 v119, v119, v19
L_k1_ws_86:
    ds_read_b64_tr_b16 v[72:73], v38 offset:0
    ds_read_b64_tr_b16 v[74:75], v38 offset:1024
    v_mfma_f32_32x32x16_bf16 v[128:143], v[80:83], v[104:107], v[128:143]
    v_lshlrev_b32 v16, 16, v106
    v_and_b32 v17, 0xffff0000, v106
    v_add_f32 v12, v12, v16
    v_add_f32 v13, v13, v17
    v_fma_f32 v14, v16, v16, v14
    v_fma_f32 v15, v17, v17, v15
    v_lshlrev_b32 v16, 16, v107
    v_and_b32 v17, 0xffff0000, v107
    v_add_f32 v12, v12, v16
    v_add_f32 v13, v13, v17
    v_fma_f32 v14, v16, v16, v14
    v_fma_f32 v15, v17, v17, v15
    s_cmp_lg_u32 s39, 3
    s_cbranch_scc1 L_k1_ws_87
    v_lshlrev_b32 v18, 16, v80
    v_and_b32 v19, 0xffff0000, v80
    v_add_f32 v116, v116, v18
    v_add_f32 v117, v117, v19
    v_lshlrev_b32 v18, 16, v81
    v_and_b32 v19, 0xffff0000, v81
    v_add_f32 v116, v116, v18
    v_add_f32 v117, v117, v19
    v_lshlrev_b32 v18, 16, v82
    v_and_b32 v19, 0xffff0000, v82
    v_add_f32 v116, v116, v18
    v_add_f32 v117, v117, v19
    v_lshlrev_b32 v18, 16, v83
    v_and_b32 v19, 0xffff0000, v83
    v_add_f32 v116, v116, v18
    v_add_f32 v117, v117, v19
L_k1_ws_87:
    ds_read_b128 v[112:115], v40
    ds_read_b64_tr_b16 v[76:77], v37 offset:4096
    ds_read_b64_tr_b16 v[78:79], v37 offset:5120
    v_mfma_f32_32x32x16_bf16 v[144:159], v[64:67], v[104:107], v[144:159]
    s_cmp_lg_u32 s39, 3
    s_cbranch_scc1 L_k1_ws_88
    v_lshlrev_b32 v18, 16, v64
    v_and_b32 v19, 0xffff0000, v64
    v_add_f32 v118, v118, v18
    v_add_f32 v119, v119, v19
    v_lshlrev_b32 v18, 16, v65
    v_and_b32 v19, 0xffff0000, v65
    v_add_f32 v118, v118, v18
    v_add_f32 v119, v119, v19
    v_lshlrev_b32 v18, 16, v66
    v_and_b32 v19, 0xffff0000, v66
    v_add_f32 v118, v118, v18
    v_add_f32 v119, v119, v19
    v_lshlrev_b32 v18, 16, v67
    v_and_b32 v19, 0xffff0000, v67
    v_add_f32 v118, v118, v18
    v_add_f32 v119, v119, v19
L_k1_ws_88:
    ds_read_b64_tr_b16 v[80:81], v38 offset:4096
    ds_read_b64_tr_b16 v[82:83], v38 offset:5120
    s_waitcnt lgkmcnt(7)
    v_mfma_f32_32x32x16_bf16 v[128:143], v[68:71], v[108:111], v[128:143]
    v_lshlrev_b32 v16, 16, v110
    v_and_b32 v17, 0xffff0000, v110
    v_add_f32 v12, v12, v16
    v_add_f32 v13, v13, v17
    v_fma_f32 v14, v16, v16, v14
    v_fma_f32 v15, v17, v17, v15
    v_lshlrev_b32 v16, 16, v111
    v_and_b32 v17, 0xffff0000, v111
    v_add_f32 v12, v12, v16
    v_add_f32 v13, v13, v17
    v_fma_f32 v14, v16, v16, v14
    v_fma_f32 v15, v17, v17, v15
    s_cmp_lg_u32 s39, 0
    s_cbranch_scc1 L_k1_ws_89
    v_lshlrev_b32 v18, 16, v68
    v_and_b32 v19, 0xffff0000, v68
    v_add_f32 v116, v116, v18
    v_add_f32 v117, v117, v19
    v_lshlrev_b32 v18, 16, v69
    v_and_b32 v19, 0xffff0000, v69
    v_add_f32 v116, v116, v18
    v_add_f32 v117, v117, v19
    v_lshlrev_b32 v18, 16, v70
    v_and_b32 v19, 0xffff0000, v70
    v_add_f32 v116, v116, v18
    v_add_f32 v117, v117, v19
    v_lshlrev_b32 v18, 16, v71
    v_and_b32 v19, 0xffff0000, v71
    v_add_f32 v116, v116, v18
    v_add_f32 v117, v117, v19
L_k1_ws_89:
    ds_read_b128 v[96:99], v41
    ds_read_b64_tr_b16 v[64:65], v37 offset:8192
    ds_read_b64_tr_b16 v[66:67], v37 offset:9216
    s_waitcnt lgkmcnt(8)
    v_mfma_f32_32x32x16_bf16 v[144:159], v[72:75], v[108:111], v[144:159]
    s_cmp_lg_u32 s39, 0
    s_cbranch_scc1 L_k1_ws_90
    v_lshlrev_b32 v18, 16, v72
    v_and_b32 v19, 0xffff0000, v72
    v_add_f32 v118, v118, v18
    v_add_f32 v119, v119, v19
    v_lshlrev_b32 v18, 16, v73
    v_and_b32 v19, 0xffff0000, v73
    v_add_f32 v118, v118, v18
    v_add_f32 v119, v119, v19
    v_lshlrev_b32 v18, 16, v74
    v_and_b32 v19, 0xffff0000, v74
    v_add_f32 v118, v118, v18
    v_add_f32 v119, v119, v19
    v_lshlrev_b32 v18, 16, v75
    v_and_b32 v19, 0xffff0000, v75
    v_add_f32 v118, v118, v18
    v_add_f32 v119, v119, v19
L_k1_ws_90:
    ds_read_b64_tr_b16 v[68:69], v38 offset:8192
    ds_read_b64_tr_b16 v[70:71], v38 offset:9216
    s_waitcnt lgkmcnt(7)
    v_mfma_f32_32x32x16_bf16 v[128:143], v[76:79], v[112:115], v[128:143]
    v_lshlrev_b32 v16, 16, v114
    v_and_b32 v17, 0xffff0000, v114
    v_add_f32 v12, v12, v16
    v_add_f32 v13, v13, v17
    v_fma_f32 v14, v16, v16, v14
    v_fma_f32 v15, v17, v17, v15
    v_lshlrev_b32 v16, 16, v115
    v_and_b32 v17, 0xffff0000, v115
    v_add_f32 v12, v12, v16
    v_add_f32 v13, v13, v17
    v_fma_f32 v14, v16, v16, v14
    v_fma_f32 v15, v17, v17, v15
    s_cmp_lg_u32 s39, 1
    s_cbranch_scc1 L_k1_ws_91
    v_lshlrev_b32 v18, 16, v76
    v_and_b32 v19, 0xffff0000, v76
    v_add_f32 v116, v116, v18
    v_add_f32 v117, v117, v19
    v_lshlrev_b32 v18, 16, v77
    v_and_b32 v19, 0xffff0000, v77
    v_add_f32 v116, v116, v18
    v_add_f32 v117, v117, v19
    v_lshlrev_b32 v18, 16, v78
    v_and_b32 v19, 0xffff0000, v78
    v_add_f32 v116, v116, v18
    v_add_f32 v117, v117, v19
    v_lshlrev_b32 v18, 16, v79
    v_and_b32 v19, 0xffff0000, v79
    v_add_f32 v116, v116, v18
    v_add_f32 v117, v117, v19
L_k1_ws_91:
    ds_read_b128 v[100:103], v42
    ds_read_b64_tr_b16 v[72:73], v37 offset:12288
    ds_read_b64_tr_b16 v[74:75], v37 offset:13312
    s_waitcnt lgkmcnt(8)
    v_mfma_f32_32x32x16_bf16 v[144:159], v[80:83], v[112:115], v[144:159]
    s_cmp_lg_u32 s39, 1
    s_cbranch_scc1 L_k1_ws_92
    v_lshlrev_b32 v18, 16, v80
    v_and_b32 v19, 0xffff0000, v80
    v_add_f32 v118, v118, v18
    v_add_f32 v119, v119, v19
    v_lshlrev_b32 v18, 16, v81
    v_and_b32 v19, 0xffff0000, v81
    v_add_f32 v118, v118, v18
    v_add_f32 v119, v119, v19
    v_lshlrev_b32 v18, 16, v82
    v_and_b32 v19, 0xffff0000, v82
    v_add_f32 v118, v118, v18
    v_add_f32 v119, v119, v19
    v_lshlrev_b32 v18, 16, v83
    v_and_b32 v19, 0xffff0000, v83
    v_add_f32 v118, v118, v18
    v_add_f32 v119, v119, v19
L_k1_ws_92:
    ds_read_b64_tr_b16 v[76:77], v38 offset:12288
    ds_read_b64_tr_b16 v[78:79], v38 offset:13312
    s_waitcnt lgkmcnt(7)
    v_mfma_f32_32x32x16_bf16 v[128:143], v[64:67], v[96:99], v[128:143]
    v_lshlrev_b32 v16, 16, v98
    v_and_b32 v17, 0xffff0000, v98
    v_add_f32 v12, v12, v16
    v_add_f32 v13, v13, v17
    v_fma_f32 v14, v16, v16, v14
    v_fma_f32 v15, v17, v17, v15
    v_lshlrev_b32 v16, 16, v99
    v_and_b32 v17, 0xffff0000, v99
    v_add_f32 v12, v12, v16
    v_add_f32 v13, v13, v17
    v_fma_f32 v14, v16, v16, v14
    v_fma_f32 v15, v17, v17, v15
    s_cmp_lg_u32 s39, 2
    s_cbranch_scc1 L_k1_ws_93
    v_lshlrev_b32 v18, 16, v64
    v_and_b32 v19, 0xffff0000, v64
    v_add_f32 v116, v116, v18
    v_add_f32 v117, v117, v19
    v_lshlrev_b32 v18, 16, v65
    v_and_b32 v19, 0xffff0000, v65
    v_add_f32 v116, v116, v18
    v_add_f32 v117, v117, v19
    v_lshlrev_b32 v18, 16, v66
    v_and_b32 v19, 0xffff0000, v66
    v_add_f32 v116, v116, v18
    v_add_f32 v117, v117, v19
    v_lshlrev_b32 v18, 16, v67
    v_and_b32 v19, 0xffff0000, v67
    v_add_f32 v116, v116, v18
    v_add_f32 v117, v117, v19
L_k1_ws_93:
    s_waitcnt lgkmcnt(5)
    v_mfma_f32_32x32x16_bf16 v[144:159], v[68:71], v[96:99], v[144:159]
    s_cmp_lg_u32 s39, 2
    s_cbranch_scc1 L_k1_ws_94
    v_lshlrev_b32 v18, 16, v68
    v_and_b32 v19, 0xffff0000, v68
    v_add_f32 v118, v118, v18
    v_add_f32 v119, v119, v19
    v_lshlrev_b32 v18, 16, v69
    v_and_b32 v19, 0xffff0000, v69
    v_add_f32 v118, v118, v18
    v_add_f32 v119, v119, v19
    v_lshlrev_b32 v18, 16, v70
    v_and_b32 v19, 0xffff0000, v70
    v_add_f32 v118, v118, v18
    v_add_f32 v119, v119, v19
    v_lshlrev_b32 v18, 16, v71
    v_and_b32 v19, 0xffff0000, v71
    v_add_f32 v118, v118, v18
    v_add_f32 v119, v119, v19
L_k1_ws_94:
    s_waitcnt lgkmcnt(2)
    v_mfma_f32_32x32x16_bf16 v[128:143], v[72:75], v[100:103], v[128:143]
    v_lshlrev_b32 v16, 16, v102
    v_and_b32 v17, 0xffff0000, v102
    v_add_f32 v12, v12, v16
    v_add_f32 v13, v13, v17
    v_fma_f32 v14, v16, v16, v14
    v_fma_f32 v15, v17, v17, v15
    v_lshlrev_b32 v16, 16, v103
    v_and_b32 v17, 0xffff0000, v103
    v_add_f32 v12, v12, v16
    v_add_f32 v13, v13, v17
    v_fma_f32 v14, v16, v16, v14
    v_fma_f32 v15, v17, v17, v15
    s_cmp_lg_u32 s39, 3
    s_cbranch_scc1 L_k1_ws_95
    v_lshlrev_b32 v18, 16, v72
    v_and_b32 v19, 0xffff0000, v72
    v_add_f32 v116, v116, v18
    v_add_f32 v117, v117, v19
    v_lshlrev_b32 v18, 16, v73
    v_and_b32 v19, 0xffff0000, v73
    v_add_f32 v116, v116, v18
    v_add_f32 v117, v117, v19
    v_lshlrev_b32 v18, 16, v74
    v_and_b32 v19, 0xffff0000, v74
    v_add_f32 v116, v116, v18
    v_add_f32 v117, v117, v19
    v_lshlrev_b32 v18, 16, v75
    v_and_b32 v19, 0xffff0000, v75
    v_add_f32 v116, v116, v18
    v_add_f32 v117, v117, v19
L_k1_ws_95:
    s_waitcnt lgkmcnt(0)
    v_mfma_f32_32x32x16_bf16 v[144:159], v[76:79], v[100:103], v[144:159]
    s_cmp_lg_u32 s39, 3
    s_cbranch_scc1 L_k1_ws_96
    v_lshlrev_b32 v18, 16, v76
    v_and_b32 v19, 0xffff0000, v76
    v_add_f32 v118, v118, v18
    v_add_f32 v119, v119, v19
    v_lshlrev_b32 v18, 16, v77
    v_and_b32 v19, 0xffff0000, v77
    v_add_f32 v118, v118, v18
    v_add_f32 v119, v119, v19
    v_lshlrev_b32 v18, 16, v78
    v_and_b32 v19, 0xffff0000, v78
    v_add_f32 v118, v118, v18
    v_add_f32 v119, v119, v19
    v_lshlrev_b32 v18, 16, v79
    v_and_b32 v19, 0xffff0000, v79
    v_add_f32 v118, v118, v18
    v_add_f32 v119, v119, v19
L_k1_ws_96:
    v_add_f32 v12, v12, v13
    v_add_f32 v13, v14, v15
    s_lshl_b32 s30, s39, 10
    v_lshlrev_b32 v16, 3, v1
    v_add_u32 v16, s30, v16
    v_add_u32 v17, 99840, v16
    v_add_u32 v16, 99328, v16
    ds_write_b64 v17, v[12:13]
    v_add_f32 v116, v116, v117
    v_mov_b32 v18, v116
    s_nop 1
    v_permlane32_swap_b32 v116, v18
    v_add_f32 v116, v116, v18
    v_and_b32 v18, 31, v1
    v_lshlrev_b32 v18, 2, v18
    s_mul_i32 s30, s39, 384
    v_add_u32 v18, s30, v18
    v_add_u32 v18, 103424, v18
    ds_write_b32 v18, v116 offset:128
    v_add_f32 v118, v118, v119
    v_mov_b32 v18, v118
    s_nop 1
    v_permlane32_swap_b32 v118, v18
    v_add_f32 v118, v118, v18
    v_and_b32 v18, 31, v1
    v_lshlrev_b32 v18, 2, v18
    s_mul_i32 s30, s39, 384
    v_add_u32 v18, s30, v18
    v_add_u32 v18, 103424, v18
    ds_write_b32 v18, v118 offset:256
    s_waitcnt lgkmcnt(0)
    s_barrier
    ds_read_b64 v[14:15], v16
    v_lshrrev_b32 v18, 5, v1
    v_lshlrev_b32 v18, 4, v18
    v_add_u32 v18, 103424, v18
    ds_read_b128 v[160:163], v18 offset:128
    ds_read_b128 v[164:167], v18 offset:160
    ds_read_b128 v[168:171], v18 offset:192
    ds_read_b128 v[172:175], v18 offset:224
    ds_read_b128 v[224:227], v18 offset:512
    ds_read_b128 v[228:231], v18 offset:544
    ds_read_b128 v[232:235], v18 offset:576
    ds_read_b128 v[236:239], v18 offset:608
    s_waitcnt lgkmcnt(0)
    v_add_f32 v160, v160, v224
    v_add_f32 v161, v161, v225
    v_add_f32 v162, v162, v226
    v_add_f32 v163, v163, v227
    v_add_f32 v164, v164, v228
    v_add_f32 v165, v165, v229
    v_add_f32 v166, v166, v230
    v_add_f32 v167, v167, v231
    v_add_f32 v168, v168, v232
    v_add_f32 v169, v169, v233
    v_add_f32 v170, v170, v234
    v_add_f32 v171, v171, v235
    v_add_f32 v172, v172, v236
    v_add_f32 v173, v173, v237
    v_add_f32 v174, v174, v238
    v_add_f32 v175, v175, v239
    ds_read_b128 v[224:227], v18 offset:896
    ds_read_b128 v[228:231], v18 offset:928
    ds_read_b128 v[232:235], v18 offset:960
    ds_read_b128 v[236:239], v18 offset:992
    s_waitcnt lgkmcnt(0)
    v_add_f32 v160, v160, v224
    v_add_f32 v161, v161, v225
    v_add_f32 v162, v162, v226
    v_add_f32 v163, v163, v227
    v_add_f32 v164, v164, v228
    v_add_f32 v165, v165, v229
    v_add_f32 v166, v166, v230
    v_add_f32 v167, v167, v231
    v_add_f32 v168, v168, v232
    v_add_f32 v169, v169, v233
    v_add_f32 v170, v170, v234
    v_add_f32 v171, v171, v235
    v_add_f32 v172, v172, v236
    v_add_f32 v173, v173, v237
    v_add_f32 v174, v174, v238
    v_add_f32 v175, v175, v239
    ds_read_b128 v[224:227], v18 offset:1280
    ds_read_b128 v[228:231], v18 offset:1312
    ds_read_b128 v[232:235], v18 offset:1344
    ds_read_b128 v[236:239], v18 offset:1376
    s_waitcnt lgkmcnt(0)
    v_add_f32 v160, v160, v224
    v_add_f32 v161, v161, v225
    v_add_f32 v162, v162, v226
    v_add_f32 v163, v163, v227
    v_add_f32 v164, v164, v228
    v_add_f32 v165, v165, v229
    v_add_f32 v166, v166, v230
    v_add_f32 v167, v167, v231
    v_add_f32 v168, v168, v232
    v_add_f32 v169, v169, v233
    v_add_f32 v170, v170, v234
    v_add_f32 v171, v171, v235
    v_add_f32 v172, v172, v236
    v_add_f32 v173, v173, v237
    v_add_f32 v174, v174, v238
    v_add_f32 v175, v175, v239
    ds_read_b128 v[176:179], v18 offset:256
    ds_read_b128 v[180:183], v18 offset:288
    ds_read_b128 v[184:187], v18 offset:320
    ds_read_b128 v[188:191], v18 offset:352
    ds_read_b128 v[224:227], v18 offset:640
    ds_read_b128 v[228:231], v18 offset:672
    ds_read_b128 v[232:235], v18 offset:704
    ds_read_b128 v[236:239], v18 offset:736
    s_waitcnt lgkmcnt(0)
    v_add_f32 v176, v176, v224
    v_add_f32 v177, v177, v225
    v_add_f32 v178, v178, v226
    v_add_f32 v179, v179, v227
    v_add_f32 v180, v180, v228
    v_add_f32 v181, v181, v229
    v_add_f32 v182, v182, v230
    v_add_f32 v183, v183, v231
    v_add_f32 v184, v184, v232
    v_add_f32 v185, v185, v233
    v_add_f32 v186, v186, v234
    v_add_f32 v187, v187, v235
    v_add_f32 v188, v188, v236
    v_add_f32 v189, v189, v237
    v_add_f32 v190, v190, v238
    v_add_f32 v191, v191, v239
    ds_read_b128 v[224:227], v18 offset:1024
    ds_read_b128 v[228:231], v18 offset:1056
    ds_read_b128 v[232:235], v18 offset:1088
    ds_read_b128 v[236:239], v18 offset:1120
    s_waitcnt lgkmcnt(0)
    v_add_f32 v176, v176, v224
    v_add_f32 v177, v177, v225
    v_add_f32 v178, v178, v226
    v_add_f32 v179, v179, v227
    v_add_f32 v180, v180, v228
    v_add_f32 v181, v181, v229
    v_add_f32 v182, v182, v230
    v_add_f32 v183, v183, v231
    v_add_f32 v184, v184, v232
    v_add_f32 v185, v185, v233
    v_add_f32 v186, v186, v234
    v_add_f32 v187, v187, v235
    v_add_f32 v188, v188, v236
    v_add_f32 v189, v189, v237
    v_add_f32 v190, v190, v238
    v_add_f32 v191, v191, v239
    ds_read_b128 v[224:227], v18 offset:1408
    ds_read_b128 v[228:231], v18 offset:1440
    ds_read_b128 v[232:235], v18 offset:1472
    ds_read_b128 v[236:239], v18 offset:1504
    s_waitcnt lgkmcnt(0)
    v_add_f32 v176, v176, v224
    v_add_f32 v177, v177, v225
    v_add_f32 v178, v178, v226
    v_add_f32 v179, v179, v227
    v_add_f32 v180, v180, v228
    v_add_f32 v181, v181, v229
    v_add_f32 v182, v182, v230
    v_add_f32 v183, v183, v231
    v_add_f32 v184, v184, v232
    v_add_f32 v185, v185, v233
    v_add_f32 v186, v186, v234
    v_add_f32 v187, v187, v235
    v_add_f32 v188, v188, v236
    v_add_f32 v189, v189, v237
    v_add_f32 v190, v190, v238
    v_add_f32 v191, v191, v239
    v_add_f32 v12, v12, v14
    v_add_f32 v13, v13, v15
    v_mov_b32 v16, v12
    s_nop 1
    v_permlane32_swap_b32 v12, v16
    v_add_f32 v12, v12, v16
    v_mov_b32 v16, v13
    s_nop 1
    v_permlane32_swap_b32 v13, v16
    v_add_f32 v13, v13, v16
    v_mul_f32 v14, 0x3b000000, v12
    v_mul_f32 v16, 0x3b000000, v13
    v_fma_f32 v16, -v14, v14, v16
    v_max_f32 v16, 0, v16
    v_cvt_pk_bf16_f32 v17, v14, v14
    v_lshlrev_b32 v14, 16, v17
    v_cvt_pk_bf16_f32 v17, v16, v16
    v_lshlrev_b32 v16, 16, v17
    v_add_f32 v16, 0x3727c5ac, v16
    v_cvt_pk_bf16_f32 v17, v16, v16
    v_lshlrev_b32 v16, 16, v17
    v_sqrt_f32 v16, v16
    s_nop 0
    v_cvt_pk_bf16_f32 v17, v16, v16
    v_lshlrev_b32 v16, 16, v17
    v_rcp_f32 v15, v16
    v_fma_f32 v128, -v14, v160, v128
    v_fma_f32 v129, -v14, v161, v129
    v_fma_f32 v130, -v14, v162, v130
    v_fma_f32 v131, -v14, v163, v131
    v_fma_f32 v132, -v14, v164, v132
    v_fma_f32 v133, -v14, v165, v133
    v_fma_f32 v134, -v14, v166, v134
    v_fma_f32 v135, -v14, v167, v135
    v_fma_f32 v136, -v14, v168, v136
    v_fma_f32 v137, -v14, v169, v137
    v_fma_f32 v138, -v14, v170, v138
    v_fma_f32 v139, -v14, v171, v139
    v_fma_f32 v140, -v14, v172, v140
    v_fma_f32 v141, -v14, v173, v141
    v_fma_f32 v142, -v14, v174, v142
    v_fma_f32 v143, -v14, v175, v143
    v_mul_f32 v128, v15, v128
    v_mul_f32 v129, v15, v129
    v_mul_f32 v130, v15, v130
    v_mul_f32 v131, v15, v131
    v_mul_f32 v132, v15, v132
    v_mul_f32 v133, v15, v133
    v_mul_f32 v134, v15, v134
    v_mul_f32 v135, v15, v135
    v_mul_f32 v136, v15, v136
    v_mul_f32 v137, v15, v137
    v_mul_f32 v138, v15, v138
    v_mul_f32 v139, v15, v139
    v_mul_f32 v140, v15, v140
    v_mul_f32 v141, v15, v141
    v_mul_f32 v142, v15, v142
    v_mul_f32 v143, v15, v143
    v_fma_f32 v144, -v14, v176, v144
    v_fma_f32 v145, -v14, v177, v145
    v_fma_f32 v146, -v14, v178, v146
    v_fma_f32 v147, -v14, v179, v147
    v_fma_f32 v148, -v14, v180, v148
    v_fma_f32 v149, -v14, v181, v149
    v_fma_f32 v150, -v14, v182, v150
    v_fma_f32 v151, -v14, v183, v151
    v_fma_f32 v152, -v14, v184, v152
    v_fma_f32 v153, -v14, v185, v153
    v_fma_f32 v154, -v14, v186, v154
    v_fma_f32 v155, -v14, v187, v155
    v_fma_f32 v156, -v14, v188, v156
    v_fma_f32 v157, -v14, v189, v157
    v_fma_f32 v158, -v14, v190, v158
    v_fma_f32 v159, -v14, v191, v159
    v_mul_f32 v144, v15, v144
    v_mul_f32 v145, v15, v145
    v_mul_f32 v146, v15, v146
    v_mul_f32 v147, v15, v147
    v_mul_f32 v148, v15, v148
    v_mul_f32 v149, v15, v149
    v_mul_f32 v150, v15, v150
    v_mul_f32 v151, v15, v151
    v_mul_f32 v152, v15, v152
    v_mul_f32 v153, v15, v153
    v_mul_f32 v154, v15, v154
    v_mul_f32 v155, v15, v155
    v_mul_f32 v156, v15, v156
    v_mul_f32 v157, v15, v157
    v_mul_f32 v158, v15, v158
    v_mul_f32 v159, v15, v159
    v_cvt_pk_bf16_f32 v60, v128, v129
    v_cvt_pk_bf16_f32 v61, v130, v131
    v_cvt_pk_bf16_f32 v62, v132, v133
    v_cvt_pk_bf16_f32 v63, v134, v135
    v_cvt_pk_bf16_f32 v64, v136, v137
    v_cvt_pk_bf16_f32 v65, v138, v139
    v_cvt_pk_bf16_f32 v66, v140, v141
    v_cvt_pk_bf16_f32 v67, v142, v143
    v_lshrrev_b32 v18, 5, v1
    v_bfe_u32 v19, v1, 2, 2
    v_lshl_add_u32 v18, v18, 2, v19
    v_lshlrev_b32 v18, 5, v18
    v_and_b32 v19, 3, v1
    v_lshl_add_u32 v18, v19, 3, v18
    v_add_u32 v18, 98304, v18
    ds_read_b64_tr_b16 v[72:73], v18 offset:0
    ds_read_b64_tr_b16 v[74:75], v18 offset:256
    ds_read_b64_tr_b16 v[76:77], v18 offset:512
    ds_read_b64_tr_b16 v[78:79], v18 offset:768
    v_mov_b32 v176, 0
    v_mov_b32 v177, 0
    v_mov_b32 v178, 0
    v_mov_b32 v179, 0
    v_mov_b32 v180, 0
    v_mov_b32 v181, 0
    v_mov_b32 v182, 0
    v_mov_b32 v183, 0
    v_mov_b32 v184, 0
    v_mov_b32 v185, 0
    v_mov_b32 v186, 0
    v_mov_b32 v187, 0
    v_mov_b32 v188, 0
    v_mov_b32 v189, 0
    v_mov_b32 v190, 0
    v_mov_b32 v191, 0
    v_mov_b32 v192, 0
    v_mov_b32 v193, 0
    v_mov_b32 v194, 0
    v_mov_b32 v195, 0
    v_mov_b32 v196, 0
    v_mov_b32 v197, 0
    v_mov_b32 v198, 0
    v_mov_b32 v199, 0
    v_mov_b32 v200, 0
    v_mov_b32 v201, 0
    v_mov_b32 v202, 0
    v_mov_b32 v203, 0
    v_mov_b32 v204, 0
    v_mov_b32 v205, 0
    v_mov_b32 v206, 0
    v_mov_b32 v207, 0
    s_waitcnt lgkmcnt(0)
    v_mfma_f32_32x32x16_bf16 v[176:191], v[72:75], v[60:63], v[176:191]
    v_mfma_f32_32x32x16_bf16 v[192:207], v[76:79], v[64:67], v[192:207]
    v_and_b32 v16, 31, v1
    s_lshl_b32 s29, s27, 7
    s_lshl_b32 s30, s39, 5
    s_add_u32 s29, s29, s30
    v_add_u32 v20, s29, v16
    v_lshrrev_b32 v17, 5, v1
    s_lshl_b32 s30, s39, 12
    v_lshlrev_b32 v22, 7, v16
    v_add_u32 v22, s30, v22
    v_lshl_add_u32 v22, v17, 3, v22
    v_lshlrev_b32 v23, 6, v16
    v_add_u32 v23, s30, v23
    v_lshl_add_u32 v23, v17, 3, v23
    v_add_u32 v23, 16384, v23
    v_cvt_pk_bf16_f32 v90, v176, v177
    v_lshlrev_b32 v208, 16, v90
    v_and_b32 v209, 0xffff0000, v90
    v_cvt_pk_bf16_f32 v90, v178, v179
    v_lshlrev_b32 v210, 16, v90
    v_and_b32 v211, 0xffff0000, v90
    v_cvt_pk_bf16_f32 v90, v180, v181
    v_lshlrev_b32 v212, 16, v90
    v_and_b32 v213, 0xffff0000, v90
    v_cvt_pk_bf16_f32 v90, v182, v183
    v_lshlrev_b32 v214, 16, v90
    v_and_b32 v215, 0xffff0000, v90
    v_cvt_pk_bf16_f32 v90, v192, v193
    v_lshlrev_b32 v232, 16, v90
    v_and_b32 v233, 0xffff0000, v90
    v_cvt_pk_bf16_f32 v90, v194, v195
    v_lshlrev_b32 v234, 16, v90
    v_and_b32 v235, 0xffff0000, v90
    v_cvt_pk_bf16_f32 v90, v196, v197
    v_lshlrev_b32 v236, 16, v90
    v_and_b32 v237, 0xffff0000, v90
    v_cvt_pk_bf16_f32 v90, v198, v199
    v_lshlrev_b32 v238, 16, v90
    v_and_b32 v239, 0xffff0000, v90
    v_max3_f32 v84, v208, v209, v210
    v_min3_f32 v85, v208, v209, v210
    v_max3_f32 v87, v232, v233, v234
    v_min3_f32 v88, v232, v233, v234
    v_max3_f32 v84, v84, v211, v212
    v_min3_f32 v85, v85, v211, v212
    v_max3_f32 v87, v87, v235, v236
    v_min3_f32 v88, v88, v235, v236
    v_max3_f32 v84, v84, v213, v214
    v_min3_f32 v85, v85, v213, v214
    v_max3_f32 v87, v87, v237, v238
    v_min3_f32 v88, v88, v237, v238
    v_max_f32 v84, v84, v215
    v_min_f32 v85, v85, v215
    v_max_f32 v87, v87, v239
    v_min_f32 v88, v88, v239
    v_mov_b32 v86, v84
    s_nop 1
    v_permlane32_swap_b32 v84, v86
    v_max_f32 v84, v84, v86
    v_mov_b32 v86, v85
    s_nop 1
    v_permlane32_swap_b32 v85, v86
    v_min_f32 v85, v85, v86
    v_mov_b32 v89, v87
    s_nop 1
    v_permlane32_swap_b32 v87, v89
    v_max_f32 v87, v87, v89
    v_mov_b32 v89, v88
    s_nop 1
    v_permlane32_swap_b32 v88, v89
    v_min_f32 v88, v88, v89
    v_mul_f32 v84, 0xbfb8aa3b, v84
    v_mul_f32 v85, 0x3fb8aa3b, v85
    v_mul_f32 v87, 0xbfb8aa3b, v87
    v_mul_f32 v88, 0x3fb8aa3b, v88
    s_mov_b32 s44, 0x3fb8aa3b
    v_fma_f32 v216, v208, s44, v84
    v_fma_f32 v224, -v208, s44, v85
    v_fma_f32 v240, v232, s44, v87
    v_fma_f32 v248, -v232, s44, v88
    v_fma_f32 v217, v209, s44, v84
    v_fma_f32 v225, -v209, s44, v85
    v_fma_f32 v241, v233, s44, v87
    v_fma_f32 v249, -v233, s44, v88
    v_fma_f32 v218, v210, s44, v84
    v_fma_f32 v226, -v210, s44, v85
    v_fma_f32 v242, v234, s44, v87
    v_fma_f32 v250, -v234, s44, v88
    v_fma_f32 v219, v211, s44, v84
    v_fma_f32 v227, -v211, s44, v85
    v_fma_f32 v243, v235, s44, v87
    v_fma_f32 v251, -v235, s44, v88
    v_fma_f32 v220, v212, s44, v84
    v_fma_f32 v228, -v212, s44, v85
    v_fma_f32 v244, v236, s44, v87
    v_fma_f32 v252, -v236, s44, v88
    v_fma_f32 v221, v213, s44, v84
    v_fma_f32 v229, -v213, s44, v85
    v_fma_f32 v245, v237, s44, v87
    v_fma_f32 v253, -v237, s44, v88
    v_fma_f32 v222, v214, s44, v84
    v_fma_f32 v230, -v214, s44, v85
    v_fma_f32 v246, v238, s44, v87
    v_fma_f32 v254, -v238, s44, v88
    v_fma_f32 v223, v215, s44, v84
    v_fma_f32 v231, -v215, s44, v85
    v_fma_f32 v247, v239, s44, v87
    v_fma_f32 v255, -v239, s44, v88
    v_exp_f32 v216, v216
    v_exp_f32 v224, v224
    v_exp_f32 v240, v240
    v_exp_f32 v248, v248
    v_exp_f32 v217, v217
    v_exp_f32 v225, v225
    v_exp_f32 v241, v241
    v_exp_f32 v249, v249
    v_exp_f32 v218, v218
    v_exp_f32 v226, v226
    v_exp_f32 v242, v242
    v_exp_f32 v250, v250
    v_exp_f32 v219, v219
    v_exp_f32 v227, v227
    v_exp_f32 v243, v243
    v_exp_f32 v251, v251
    v_exp_f32 v220, v220
    v_exp_f32 v228, v228
    v_exp_f32 v244, v244
    v_exp_f32 v252, v252
    v_exp_f32 v221, v221
    v_exp_f32 v229, v229
    v_exp_f32 v245, v245
    v_exp_f32 v253, v253
    v_exp_f32 v222, v222
    v_exp_f32 v230, v230
    v_exp_f32 v246, v246
    v_exp_f32 v254, v254
    v_exp_f32 v223, v223
    v_exp_f32 v231, v231
    v_exp_f32 v247, v247
    v_exp_f32 v255, v255
    v_add_f32 v84, v216, v217
    v_add_f32 v85, v224, v225
    v_add_f32 v87, v240, v241
    v_add_f32 v88, v248, v249
    v_add_f32 v84, v84, v218
    v_add_f32 v85, v85, v226
    v_add_f32 v87, v87, v242
    v_add_f32 v88, v88, v250
    v_add_f32 v84, v84, v219
    v_add_f32 v85, v85, v227
    v_add_f32 v87, v87, v243
    v_add_f32 v88, v88, v251
    v_add_f32 v84, v84, v220
    v_add_f32 v85, v85, v228
    v_add_f32 v87, v87, v244
    v_add_f32 v88, v88, v252
    v_add_f32 v84, v84, v221
    v_add_f32 v85, v85, v229
    v_add_f32 v87, v87, v245
    v_add_f32 v88, v88, v253
    v_add_f32 v84, v84, v222
    v_add_f32 v85, v85, v230
    v_add_f32 v87, v87, v246
    v_add_f32 v88, v88, v254
    v_add_f32 v84, v84, v223
    v_add_f32 v85, v85, v231
    v_add_f32 v87, v87, v247
    v_add_f32 v88, v88, v255
    v_mov_b32 v86, v84
    s_nop 1
    v_permlane32_swap_b32 v84, v86
    v_add_f32 v84, v84, v86
    v_mov_b32 v86, v85
    s_nop 1
    v_permlane32_swap_b32 v85, v86
    v_add_f32 v85, v85, v86
    v_mov_b32 v89, v87
    s_nop 1
    v_permlane32_swap_b32 v87, v89
    v_add_f32 v87, v87, v89
    v_mov_b32 v89, v88
    s_nop 1
    v_permlane32_swap_b32 v88, v89
    v_add_f32 v88, v88, v89
    v_rcp_f32 v84, v84
    v_rcp_f32 v85, v85
    v_rcp_f32 v87, v87
    v_rcp_f32 v88, v88
    v_mul_f32 v216, v216, v84
    v_mul_f32 v224, v224, v85
    v_mul_f32 v240, v240, v87
    v_mul_f32 v248, v248, v88
    v_mul_f32 v217, v217, v84
    v_mul_f32 v225, v225, v85
    v_mul_f32 v241, v241, v87
    v_mul_f32 v249, v249, v88
    v_mul_f32 v218, v218, v84
    v_mul_f32 v226, v226, v85
    v_mul_f32 v242, v242, v87
    v_mul_f32 v250, v250, v88
    v_mul_f32 v219, v219, v84
    v_mul_f32 v227, v227, v85
    v_mul_f32 v243, v243, v87
    v_mul_f32 v251, v251, v88
    v_mul_f32 v220, v220, v84
    v_mul_f32 v228, v228, v85
    v_mul_f32 v244, v244, v87
    v_mul_f32 v252, v252, v88
    v_mul_f32 v221, v221, v84
    v_mul_f32 v229, v229, v85
    v_mul_f32 v245, v245, v87
    v_mul_f32 v253, v253, v88
    v_mul_f32 v222, v222, v84
    v_mul_f32 v230, v230, v85
    v_mul_f32 v246, v246, v87
    v_mul_f32 v254, v254, v88
    v_mul_f32 v223, v223, v84
    v_mul_f32 v231, v231, v85
    v_mul_f32 v247, v247, v87
    v_mul_f32 v255, v255, v88
    v_cvt_pk_bf16_f32 v92, v216, v217
    v_cvt_pk_bf16_f32 v93, v218, v219
    ds_write_b64 v22, v[92:93] offset:0
    v_cvt_pk_bf16_f32 v92, v220, v221
    v_cvt_pk_bf16_f32 v93, v222, v223
    ds_write_b64 v22, v[92:93] offset:16
    v_cvt_pk_bf16_f32 v92, v224, v225
    v_cvt_pk_bf16_f32 v93, v226, v227
    ds_write_b64 v22, v[92:93] offset:32
    v_cvt_pk_bf16_f32 v92, v228, v229
    v_cvt_pk_bf16_f32 v93, v230, v231
    ds_write_b64 v22, v[92:93] offset:48
    v_cvt_pk_bf16_f32 v92, v144, v145
    v_cvt_pk_bf16_f32 v93, v146, v147
    ds_write_b64 v23, v[92:93] offset:0
    v_cvt_pk_bf16_f32 v92, v148, v149
    v_cvt_pk_bf16_f32 v93, v150, v151
    ds_write_b64 v23, v[92:93] offset:16
    v_mov_b32 v92, 0x3f803f80
    v_mov_b32 v93, 0x3f803f80
    ds_write_b64 v23, v[92:93] offset:32
    ds_write_b64 v23, v[92:93] offset:48
    v_cvt_pk_bf16_f32 v92, v240, v241
    v_cvt_pk_bf16_f32 v93, v242, v243
    ds_write_b64 v22, v[92:93] offset:64
    v_cvt_pk_bf16_f32 v92, v244, v245
    v_cvt_pk_bf16_f32 v93, v246, v247
    ds_write_b64 v22, v[92:93] offset:80
    v_cvt_pk_bf16_f32 v92, v248, v249
    v_cvt_pk_bf16_f32 v93, v250, v251
    ds_write_b64 v22, v[92:93] offset:96
    v_cvt_pk_bf16_f32 v92, v252, v253
    v_cvt_pk_bf16_f32 v93, v254, v255
    ds_write_b64 v22, v[92:93] offset:112
    v_cvt_pk_bf16_f32 v92, v152, v153
    v_cvt_pk_bf16_f32 v93, v154, v155
    ds_write_b64 v23, v[92:93] offset:2048
    v_cvt_pk_bf16_f32 v92, v156, v157
    v_cvt_pk_bf16_f32 v93, v158, v159
    ds_write_b64 v23, v[92:93] offset:2064
    v_mov_b32 v92, 0x3f803f80
    v_mov_b32 v93, 0x3f803f80
    ds_write_b64 v23, v[92:93] offset:2080
    ds_write_b64 v23, v[92:93] offset:2096
    s_waitcnt lgkmcnt(0)
    v_lshl_add_u32 v18, v17, 3, 0
    v_bfe_u32 v19, v1, 2, 2
    v_add_u32 v18, v18, v19
    v_and_b32 v19, 3, v1
    v_bfe_u32 v21, v1, 4, 1
    v_lshl_add_u32 v19, v21, 2, v19
    s_lshl_b32 s30, s39, 12
    v_lshlrev_b32 v24, 7, v18
    v_lshl_add_u32 v24, v19, 3, v24
    v_add_u32 v24, s30, v24
    v_lshlrev_b32 v25, 6, v18
    v_lshl_add_u32 v25, v19, 3, v25
    v_add_u32 v25, s30, v25
    v_add_u32 v25, 16384, v25
    v_mov_b32 v176, 0
    v_mov_b32 v177, 0
    v_mov_b32 v178, 0
    v_mov_b32 v179, 0
    v_mov_b32 v180, 0
    v_mov_b32 v181, 0
    v_mov_b32 v182, 0
    v_mov_b32 v183, 0
    v_mov_b32 v184, 0
    v_mov_b32 v185, 0
    v_mov_b32 v186, 0
    v_mov_b32 v187, 0
    v_mov_b32 v188, 0
    v_mov_b32 v189, 0
    v_mov_b32 v190, 0
    v_mov_b32 v191, 0
    ds_read_b64_tr_b16 v[60:61], v24 offset:0
    ds_read_b64_tr_b16 v[64:65], v25 offset:0
    ds_read_b64_tr_b16 v[62:63], v24 offset:512
    ds_read_b64_tr_b16 v[66:67], v25 offset:256
    s_waitcnt lgkmcnt(0)
    v_mfma_f32_32x32x16_bf16 v[176:191], v[60:63], v[64:67], v[176:191]
    ds_read_b64_tr_b16 v[60:61], v24 offset:2048
    ds_read_b64_tr_b16 v[64:65], v25 offset:1024
    ds_read_b64_tr_b16 v[62:63], v24 offset:2560
    ds_read_b64_tr_b16 v[66:67], v25 offset:1280
    s_waitcnt lgkmcnt(0)
    v_mfma_f32_32x32x16_bf16 v[176:191], v[60:63], v[64:67], v[176:191]
    v_mov_b32 v192, 0
    v_mov_b32 v193, 0
    v_mov_b32 v194, 0
    v_mov_b32 v195, 0
    v_mov_b32 v196, 0
    v_mov_b32 v197, 0
    v_mov_b32 v198, 0
    v_mov_b32 v199, 0
    v_mov_b32 v200, 0
    v_mov_b32 v201, 0
    v_mov_b32 v202, 0
    v_mov_b32 v203, 0
    v_mov_b32 v204, 0
    v_mov_b32 v205, 0
    v_mov_b32 v206, 0
    v_mov_b32 v207, 0
    ds_read_b64_tr_b16 v[60:61], v24 offset:64
    ds_read_b64_tr_b16 v[64:65], v25 offset:2048
    ds_read_b64_tr_b16 v[62:63], v24 offset:576
    ds_read_b64_tr_b16 v[66:67], v25 offset:2304
    s_waitcnt lgkmcnt(0)
    v_mfma_f32_32x32x16_bf16 v[192:207], v[60:63], v[64:67], v[192:207]
    ds_read_b64_tr_b16 v[60:61], v24 offset:2112
    ds_read_b64_tr_b16 v[64:65], v25 offset:3072
    ds_read_b64_tr_b16 v[62:63], v24 offset:2624
    ds_read_b64_tr_b16 v[66:67], v25 offset:3328
    s_waitcnt lgkmcnt(0)
    v_mfma_f32_32x32x16_bf16 v[192:207], v[60:63], v[64:67], v[192:207]
    v_and_b32 v18, 31, v1
    v_min_u32 v19, 16, v18
    v_lshlrev_b32 v19, 5, v19
    v_lshl_add_u32 v19, v17, 4, v19
    s_mul_i32 s30, s39, 4352
    v_add_u32 v19, s30, v19
    v_add_u32 v19, 32768, v19
    v_cmp_ge_u32 vcc, 16, v18
    s_nop 1
    s_and_saveexec_b64 s[40:41], vcc
    ds_write_b128 v19, v[176:179] offset:0
    ds_write_b128 v19, v[180:183] offset:544
    ds_write_b128 v19, v[184:187] offset:1088
    ds_write_b128 v19, v[188:191] offset:1632
    ds_write_b128 v19, v[192:195] offset:2176
    ds_write_b128 v19, v[196:199] offset:2720
    ds_write_b128 v19, v[200:203] offset:3264
    ds_write_b128 v19, v[204:207] offset:3808
    s_waitcnt lgkmcnt(0)
    s_mov_b64 exec, s[40:41]
    s_barrier
    s_lshl_b32 s30, s39, 6
    v_add_u32 v18, s30, v1
    v_add_u32 v19, 0, v18
    v_cmp_gt_u32 vcc, 272, v19
    s_nop 1
    s_and_saveexec_b64 s[40:41], vcc
    v_lshlrev_b32 v20, 4, v19
    v_add_u32 v21, 32768, v20
    ds_read_b128 v[60:63], v21 offset:0
    ds_read_b128 v[64:67], v21 offset:4352
    ds_read_b128 v[68:71], v21 offset:8704
    ds_read_b128 v[72:75], v21 offset:13056
    s_waitcnt lgkmcnt(0)
    v_add_f32 v60, v60, v64
    v_add_f32 v68, v68, v72
    v_add_f32 v61, v61, v65
    v_add_f32 v69, v69, v73
    v_add_f32 v62, v62, v66
    v_add_f32 v70, v70, v74
    v_add_f32 v63, v63, v67
    v_add_f32 v71, v71, v75
    v_add_f32 v60, v60, v68
    v_add_f32 v61, v61, v69
    v_add_f32 v62, v62, v70
    v_add_f32 v63, v63, v71
    s_mul_i32 s30, s27, 69632
    s_mul_i32 s31, s28, 4352
    s_add_u32 s30, s30, s31
    buffer_store_dwordx4 v[60:63], v20, s[16:19], s30 offen
    s_mov_b64 exec, s[40:41]
    v_add_u32 v19, 256, v18
    v_cmp_gt_u32 vcc, 272, v19
    s_nop 1
    s_and_saveexec_b64 s[40:41], vcc
    v_lshlrev_b32 v20, 4, v19
    v_add_u32 v21, 32768, v20
    ds_read_b128 v[60:63], v21 offset:0
    ds_read_b128 v[64:67], v21 offset:4352
    ds_read_b128 v[68:71], v21 offset:8704
    ds_read_b128 v[72:75], v21 offset:13056
    s_waitcnt lgkmcnt(0)
    v_add_f32 v60, v60, v64
    v_add_f32 v68, v68, v72
    v_add_f32 v61, v61, v65
    v_add_f32 v69, v69, v73
    v_add_f32 v62, v62, v66
    v_add_f32 v70, v70, v74
    v_add_f32 v63, v63, v67
    v_add_f32 v71, v71, v75
    v_add_f32 v60, v60, v68
    v_add_f32 v61, v61, v69
    v_add_f32 v62, v62, v70
    v_add_f32 v63, v63, v71
    s_mul_i32 s30, s27, 69632
    s_mul_i32 s31, s28, 4352
    s_add_u32 s30, s30, s31
    buffer_store_dwordx4 v[60:63], v20, s[16:19], s30 offen
    s_mov_b64 exec, s[40:41]
    s_barrier
    s_endpgm
L_k1_done:
    s_endpgm
.text
.globl kaux_reduce_kernel
.p2align 8
.type kaux_reduce_kernel,@function
kaux_reduce_kernel:

    s_cmp_ge_u32 s2, 182
    s_cbranch_scc1 L_ka_done
    s_load_dwordx2 s[20:21], s[0:1], 80
    s_load_dwordx2 s[22:23], s[0:1], 40
    s_load_dwordx2 s[24:25], s[0:1], 48
    s_load_dwordx2 s[26:27], s[0:1], 56
    s_load_dwordx2 s[28:29], s[0:1], 24
    s_cmp_ge_u32 s2, 146
    s_cbranch_scc1 L_ka_pref
    s_cmp_ge_u32 s2, 34
    s_cbranch_scc1 L_ka_colsum
    s_lshl_b32 s3, s2, 8
    v_add_u32 v1, s3, v0
    v_lshlrev_b32 v2, 3, v1
    s_waitcnt lgkmcnt(0)
    s_add_u32 s4, s20, 4194304
    s_addc_u32 s5, s21, 0
    s_mov_b32 s6, 1114112
    s_mov_b32 s7, 0x00020000
    s_add_u32 s8, s20, 6291456
    s_addc_u32 s9, s21, 0
    s_mov_b32 s10, 34816
    s_mov_b32 s11, 0x00020000
    s_mov_b32 s12, 0
    buffer_load_dwordx2 v[8:9], v2, s[4:7], s12 offen
    s_mov_b32 s12, 69632
    buffer_load_dwordx2 v[10:11], v2, s[4:7], s12 offen
    s_mov_b32 s12, 139264
    buffer_load_dwordx2 v[12:13], v2, s[4:7], s12 offen
    s_mov_b32 s12, 208896
    buffer_load_dwordx2 v[14:15], v2, s[4:7], s12 offen
    s_mov_b32 s12, 278528
    buffer_load_dwordx2 v[16:17], v2, s[4:7], s12 offen
    s_mov_b32 s12, 348160
    buffer_load_dwordx2 v[18:19], v2, s[4:7], s12 offen
    s_mov_b32 s12, 417792
    buffer_load_dwordx2 v[20:21], v2, s[4:7], s12 offen
    s_mov_b32 s12, 487424
    buffer_load_dwordx2 v[22:23], v2, s[4:7], s12 offen
    s_mov_b32 s12, 557056
    buffer_load_dwordx2 v[24:25], v2, s[4:7], s12 offen
    s_mov_b32 s12, 626688
    buffer_load_dwordx2 v[26:27], v2, s[4:7], s12 offen
    s_mov_b32 s12, 696320
    buffer_load_dwordx2 v[28:29], v2, s[4:7], s12 offen
    s_mov_b32 s12, 765952
    buffer_load_dwordx2 v[30:31], v2, s[4:7], s12 offen
    s_mov_b32 s12, 835584
    buffer_load_dwordx2 v[32:33], v2, s[4:7], s12 offen
    s_mov_b32 s12, 905216
    buffer_load_dwordx2 v[34:35], v2, s[4:7], s12 offen
    s_mov_b32 s12, 974848
    buffer_load_dwordx2 v[36:37], v2, s[4:7], s12 offen
    s_mov_b32 s12, 1044480
    buffer_load_dwordx2 v[38:39], v2, s[4:7], s12 offen
    s_waitcnt vmcnt(15)
    v_mov_b32 v4, v8
    v_mov_b32 v5, v9
    s_waitcnt vmcnt(14)
    v_add_f32 v4, v4, v10
    v_add_f32 v5, v5, v11
    s_waitcnt vmcnt(13)
    v_add_f32 v4, v4, v12
    v_add_f32 v5, v5, v13
    s_waitcnt vmcnt(12)
    v_add_f32 v4, v4, v14
    v_add_f32 v5, v5, v15
    s_waitcnt vmcnt(11)
    v_add_f32 v4, v4, v16
    v_add_f32 v5, v5, v17
    s_waitcnt vmcnt(10)
    v_add_f32 v4, v4, v18
    v_add_f32 v5, v5, v19
    s_waitcnt vmcnt(9)
    v_add_f32 v4, v4, v20
    v_add_f32 v5, v5, v21
    s_waitcnt vmcnt(8)
    v_add_f32 v4, v4, v22
    v_add_f32 v5, v5, v23
    s_waitcnt vmcnt(7)
    v_add_f32 v4, v4, v24
    v_add_f32 v5, v5, v25
    s_waitcnt vmcnt(6)
    v_add_f32 v4, v4, v26
    v_add_f32 v5, v5, v27
    s_waitcnt vmcnt(5)
    v_add_f32 v4, v4, v28
    v_add_f32 v5, v5, v29
    s_waitcnt vmcnt(4)
    v_add_f32 v4, v4, v30
    v_add_f32 v5, v5, v31
    s_waitcnt vmcnt(3)
    v_add_f32 v4, v4, v32
    v_add_f32 v5, v5, v33
    s_waitcnt vmcnt(2)
    v_add_f32 v4, v4, v34
    v_add_f32 v5, v5, v35
    s_waitcnt vmcnt(1)
    v_add_f32 v4, v4, v36
    v_add_f32 v5, v5, v37
    s_waitcnt vmcnt(0)
    v_add_f32 v4, v4, v38
    v_add_f32 v5, v5, v39
    v_cvt_pk_bf16_f32 v6, v4, v5
    v_lshlrev_b32 v2, 2, v1
    buffer_store_dword v6, v2, s[8:11], 0 offen
    s_endpgm
L_ka_colsum:
    s_waitcnt lgkmcnt(0)
    s_nop 15
    s_sub_u32 s3, s2, 34
    s_cmp_ge_u32 s3, 56
    s_cselect_b32 s13, 1, 0
    s_mul_i32 s14, s13, 56
    s_sub_u32 s3, s3, s14
    s_cmp_eq_u32 s13, 0
    s_cselect_b32 s4, s22, s24
    s_cselect_b32 s5, s23, s25
    s_mov_b32 s6, 1835008
    s_mov_b32 s7, 0x00020000
    s_add_u32 s8, s20, 6356992
    s_addc_u32 s9, s21, 0
    s_mov_b32 s10, 14336
    s_mov_b32 s11, 0x00020000
    v_lshrrev_b32 v1, 2, v0
    v_and_b32 v2, 3, v0
    s_movk_i32 s12, 3584
    v_mul_lo_u32 v3, v1, s12
    v_lshl_add_u32 v3, v2, 4, v3
    s_lshl_b32 s12, s3, 6
    v_add_u32 v3, s12, v3
    s_mov_b32 s12, 0
    buffer_load_dwordx4 v[16:19], v3, s[4:7], s12 offen
    s_mov_b32 s12, 229376
    buffer_load_dwordx4 v[20:23], v3, s[4:7], s12 offen
    s_mov_b32 s12, 458752
    buffer_load_dwordx4 v[24:27], v3, s[4:7], s12 offen
    s_mov_b32 s12, 688128
    buffer_load_dwordx4 v[28:31], v3, s[4:7], s12 offen
    s_mov_b32 s12, 917504
    buffer_load_dwordx4 v[32:35], v3, s[4:7], s12 offen
    s_mov_b32 s12, 1146880
    buffer_load_dwordx4 v[36:39], v3, s[4:7], s12 offen
    s_mov_b32 s12, 1376256
    buffer_load_dwordx4 v[40:43], v3, s[4:7], s12 offen
    s_mov_b32 s12, 1605632
    buffer_load_dwordx4 v[44:47], v3, s[4:7], s12 offen
    v_mov_b32 v8, 0
    v_mov_b32 v9, 0
    v_mov_b32 v10, 0
    v_mov_b32 v11, 0
    v_mov_b32 v12, 0
    v_mov_b32 v13, 0
    v_mov_b32 v14, 0
    v_mov_b32 v15, 0
    s_waitcnt vmcnt(7)
    v_lshlrev_b32 v4, 16, v16
    v_and_b32 v5, 0xffff0000, v16
    v_add_f32 v8, v8, v4
    v_add_f32 v9, v9, v5
    v_lshlrev_b32 v4, 16, v17
    v_and_b32 v5, 0xffff0000, v17
    v_add_f32 v10, v10, v4
    v_add_f32 v11, v11, v5
    v_lshlrev_b32 v4, 16, v18
    v_and_b32 v5, 0xffff0000, v18
    v_add_f32 v12, v12, v4
    v_add_f32 v13, v13, v5
    v_lshlrev_b32 v4, 16, v19
    v_and_b32 v5, 0xffff0000, v19
    v_add_f32 v14, v14, v4
    v_add_f32 v15, v15, v5
    s_waitcnt vmcnt(6)
    v_lshlrev_b32 v4, 16, v20
    v_and_b32 v5, 0xffff0000, v20
    v_add_f32 v8, v8, v4
    v_add_f32 v9, v9, v5
    v_lshlrev_b32 v4, 16, v21
    v_and_b32 v5, 0xffff0000, v21
    v_add_f32 v10, v10, v4
    v_add_f32 v11, v11, v5
    v_lshlrev_b32 v4, 16, v22
    v_and_b32 v5, 0xffff0000, v22
    v_add_f32 v12, v12, v4
    v_add_f32 v13, v13, v5
    v_lshlrev_b32 v4, 16, v23
    v_and_b32 v5, 0xffff0000, v23
    v_add_f32 v14, v14, v4
    v_add_f32 v15, v15, v5
    s_waitcnt vmcnt(5)
    v_lshlrev_b32 v4, 16, v24
    v_and_b32 v5, 0xffff0000, v24
    v_add_f32 v8, v8, v4
    v_add_f32 v9, v9, v5
    v_lshlrev_b32 v4, 16, v25
    v_and_b32 v5, 0xffff0000, v25
    v_add_f32 v10, v10, v4
    v_add_f32 v11, v11, v5
    v_lshlrev_b32 v4, 16, v26
    v_and_b32 v5, 0xffff0000, v26
    v_add_f32 v12, v12, v4
    v_add_f32 v13, v13, v5
    v_lshlrev_b32 v4, 16, v27
    v_and_b32 v5, 0xffff0000, v27
    v_add_f32 v14, v14, v4
    v_add_f32 v15, v15, v5
    s_waitcnt vmcnt(4)
    v_lshlrev_b32 v4, 16, v28
    v_and_b32 v5, 0xffff0000, v28
    v_add_f32 v8, v8, v4
    v_add_f32 v9, v9, v5
    v_lshlrev_b32 v4, 16, v29
    v_and_b32 v5, 0xffff0000, v29
    v_add_f32 v10, v10, v4
    v_add_f32 v11, v11, v5
    v_lshlrev_b32 v4, 16, v30
    v_and_b32 v5, 0xffff0000, v30
    v_add_f32 v12, v12, v4
    v_add_f32 v13, v13, v5
    v_lshlrev_b32 v4, 16, v31
    v_and_b32 v5, 0xffff0000, v31
    v_add_f32 v14, v14, v4
    v_add_f32 v15, v15, v5
    s_waitcnt vmcnt(3)
    v_lshlrev_b32 v4, 16, v32
    v_and_b32 v5, 0xffff0000, v32
    v_add_f32 v8, v8, v4
    v_add_f32 v9, v9, v5
    v_lshlrev_b32 v4, 16, v33
    v_and_b32 v5, 0xffff0000, v33
    v_add_f32 v10, v10, v4
    v_add_f32 v11, v11, v5
    v_lshlrev_b32 v4, 16, v34
    v_and_b32 v5, 0xffff0000, v34
    v_add_f32 v12, v12, v4
    v_add_f32 v13, v13, v5
    v_lshlrev_b32 v4, 16, v35
    v_and_b32 v5, 0xffff0000, v35
    v_add_f32 v14, v14, v4
    v_add_f32 v15, v15, v5
    s_waitcnt vmcnt(2)
    v_lshlrev_b32 v4, 16, v36
    v_and_b32 v5, 0xffff0000, v36
    v_add_f32 v8, v8, v4
    v_add_f32 v9, v9, v5
    v_lshlrev_b32 v4, 16, v37
    v_and_b32 v5, 0xffff0000, v37
    v_add_f32 v10, v10, v4
    v_add_f32 v11, v11, v5
    v_lshlrev_b32 v4, 16, v38
    v_and_b32 v5, 0xffff0000, v38
    v_add_f32 v12, v12, v4
    v_add_f32 v13, v13, v5
    v_lshlrev_b32 v4, 16, v39
    v_and_b32 v5, 0xffff0000, v39
    v_add_f32 v14, v14, v4
    v_add_f32 v15, v15, v5
    s_waitcnt vmcnt(1)
    v_lshlrev_b32 v4, 16, v40
    v_and_b32 v5, 0xffff0000, v40
    v_add_f32 v8, v8, v4
    v_add_f32 v9, v9, v5
    v_lshlrev_b32 v4, 16, v41
    v_and_b32 v5, 0xffff0000, v41
    v_add_f32 v10, v10, v4
    v_add_f32 v11, v11, v5
    v_lshlrev_b32 v4, 16, v42
    v_and_b32 v5, 0xffff0000, v42
    v_add_f32 v12, v12, v4
    v_add_f32 v13, v13, v5
    v_lshlrev_b32 v4, 16, v43
    v_and_b32 v5, 0xffff0000, v43
    v_add_f32 v14, v14, v4
    v_add_f32 v15, v15, v5
    s_waitcnt vmcnt(0)
    v_lshlrev_b32 v4, 16, v44
    v_and_b32 v5, 0xffff0000, v44
    v_add_f32 v8, v8, v4
    v_add_f32 v9, v9, v5
    v_lshlrev_b32 v4, 16, v45
    v_and_b32 v5, 0xffff0000, v45
    v_add_f32 v10, v10, v4
    v_add_f32 v11, v11, v5
    v_lshlrev_b32 v4, 16, v46
    v_and_b32 v5, 0xffff0000, v46
    v_add_f32 v12, v12, v4
    v_add_f32 v13, v13, v5
    v_lshlrev_b32 v4, 16, v47
    v_and_b32 v5, 0xffff0000, v47
    v_add_f32 v14, v14, v4
    v_add_f32 v15, v15, v5
    v_lshlrev_b32 v4, 7, v1
    v_lshl_add_u32 v4, v2, 5, v4
    ds_write_b128 v4, v[8:11]
    ds_write_b128 v4, v[12:15] offset:16
    s_waitcnt lgkmcnt(0)
    s_barrier
    v_and_b32 v1, 31, v0
    v_lshrrev_b32 v2, 5, v0
    v_lshlrev_b32 v4, 10, v2
    v_lshl_add_u32 v4, v1, 2, v4
    ds_read_b32 v8, v4 offset:0
    ds_read_b32 v9, v4 offset:128
    ds_read_b32 v10, v4 offset:256
    ds_read_b32 v11, v4 offset:384
    ds_read_b32 v12, v4 offset:512
    ds_read_b32 v13, v4 offset:640
    ds_read_b32 v14, v4 offset:768
    ds_read_b32 v15, v4 offset:896
    s_waitcnt lgkmcnt(0)
    v_add_f32 v8, v8, v9
    v_add_f32 v8, v8, v10
    v_add_f32 v8, v8, v11
    v_add_f32 v8, v8, v12
    v_add_f32 v8, v8, v13
    v_add_f32 v8, v8, v14
    v_add_f32 v8, v8, v15
    v_lshlrev_b32 v4, 2, v0
    v_add_u32 v4, 8192, v4
    ds_write_b32 v4, v8
    s_waitcnt lgkmcnt(0)
    s_barrier
    v_and_b32 v4, 31, v0
    v_lshlrev_b32 v4, 2, v4
    v_add_u32 v4, 8192, v4
    ds_read_b32 v8, v4 offset:0
    ds_read_b32 v9, v4 offset:128
    ds_read_b32 v10, v4 offset:256
    ds_read_b32 v11, v4 offset:384
    ds_read_b32 v12, v4 offset:512
    ds_read_b32 v13, v4 offset:640
    ds_read_b32 v14, v4 offset:768
    ds_read_b32 v15, v4 offset:896
    s_waitcnt lgkmcnt(0)
    v_add_f32 v8, v8, v9
    v_add_f32 v8, v8, v10
    v_add_f32 v8, v8, v11
    v_add_f32 v8, v8, v12
    v_add_f32 v8, v8, v13
    v_add_f32 v8, v8, v14
    v_add_f32 v8, v8, v15
    s_mul_i32 s12, s13, 1792
    s_lshl_b32 s14, s3, 5
    s_add_u32 s12, s12, s14
    v_add_u32 v4, s12, v0
    v_lshlrev_b32 v4, 2, v4
    v_cmp_gt_u32 vcc, 32, v0
    s_nop 1
    s_and_saveexec_b64 s[16:17], vcc
    buffer_store_dword v8, v4, s[8:11], 0 offen
    s_mov_b64 exec, s[16:17]
    s_endpgm
L_ka_pref:
    s_waitcnt lgkmcnt(0)
    s_nop 15
    s_sub_u32 s3, s2, 146
    s_cmp_ge_u32 s3, 28
    s_cselect_b32 s4, s28, s26
    s_cselect_b32 s5, s29, s27
    s_mov_b32 s13, 524288
    s_mov_b32 s14, 1835008
    s_cselect_b32 s6, s13, s14
    s_mov_b32 s7, 0x00020000
    s_cselect_b32 s12, 28, 0
    s_sub_u32 s3, s3, s12
    s_lshl_b32 s3, s3, 16
    v_lshlrev_b32 v1, 4, v0
    v_add_u32 v1, s3, v1
    buffer_load_dwordx4 v[8:11], v1, s[4:7], 0 offen
    v_add_u32 v1, 4096, v1
    buffer_load_dwordx4 v[12:15], v1, s[4:7], 0 offen
    v_add_u32 v1, 4096, v1
    buffer_load_dwordx4 v[16:19], v1, s[4:7], 0 offen
    v_add_u32 v1, 4096, v1
    buffer_load_dwordx4 v[20:23], v1, s[4:7], 0 offen
    v_add_u32 v1, 4096, v1
    buffer_load_dwordx4 v[24:27], v1, s[4:7], 0 offen
    v_add_u32 v1, 4096, v1
    buffer_load_dwordx4 v[28:31], v1, s[4:7], 0 offen
    v_add_u32 v1, 4096, v1
    buffer_load_dwordx4 v[32:35], v1, s[4:7], 0 offen
    v_add_u32 v1, 4096, v1
    buffer_load_dwordx4 v[36:39], v1, s[4:7], 0 offen
    v_add_u32 v1, 4096, v1
    buffer_load_dwordx4 v[8:11], v1, s[4:7], 0 offen
    v_add_u32 v1, 4096, v1
    buffer_load_dwordx4 v[12:15], v1, s[4:7], 0 offen
    v_add_u32 v1, 4096, v1
    buffer_load_dwordx4 v[16:19], v1, s[4:7], 0 offen
    v_add_u32 v1, 4096, v1
    buffer_load_dwordx4 v[20:23], v1, s[4:7], 0 offen
    v_add_u32 v1, 4096, v1
    buffer_load_dwordx4 v[24:27], v1, s[4:7], 0 offen
    v_add_u32 v1, 4096, v1
    buffer_load_dwordx4 v[28:31], v1, s[4:7], 0 offen
    v_add_u32 v1, 4096, v1
    buffer_load_dwordx4 v[32:35], v1, s[4:7], 0 offen
    v_add_u32 v1, 4096, v1
    buffer_load_dwordx4 v[36:39], v1, s[4:7], 0 offen
    v_add_u32 v1, 4096, v1
    s_waitcnt vmcnt(0)
L_ka_done:
    s_endpgm
.text
.globl k2_attn_out_kernel
.p2align 8
.type k2_attn_out_kernel,@function
k2_attn_out_kernel:

    s_cmp_ge_u32 s2, 256
    s_cbranch_scc1 L_k2_done
    s_load_dwordx2 s[20:21], s[0:1], 80
    s_load_dwordx2 s[22:23], s[0:1], 24
    s_load_dwordx2 s[24:25], s[0:1], 0
    v_lshrrev_b32 v16, 6, v0
    v_and_b32 v1, 63, v0
    v_readfirstlane_b32 s26, v16
    s_and_b32 s27, s2, 7
    s_lshl_b32 s27, s27, 3
    s_bfe_u32 s28, s2, 0x30003
    s_add_u32 s27, s27, s28
    s_lshr_b32 s28, s2, 6
    v_lshrrev_b32 v17, 4, v1
    v_and_b32 v18, 15, v1
    v_lshlrev_b32 v19, 1, v17
    v_xor_b32 v19, v18, v19
    v_xor_b32 v20, 8, v19
    v_lshlrev_b32 v2, 10, v17
    s_lshl_b32 s30, s28, 8
    v_add_u32 v2, s30, v2
    v_lshl_add_u32 v3, v20, 4, v2
    v_lshl_add_u32 v2, v19, 4, v2
    s_lshl_b32 s34, s26, 16
    s_lshl_b32 s35, s26, 14
    s_waitcnt lgkmcnt(0)
    s_mov_b32 s4, s22
    s_mov_b32 s5, s23
    s_mov_b32 s6, 524288
    s_mov_b32 s7, 0x00020000
    s_mov_b32 s8, s20
    s_mov_b32 s9, s21
    s_mov_b32 s10, 4194304
    s_mov_b32 s11, 0x00020000
    s_add_u32 s12, s20, 6291456
    s_addc_u32 s13, s21, 0
    s_mov_b32 s14, 34816
    s_mov_b32 s15, 0x00020000
    s_mov_b32 s16, s24
    s_mov_b32 s17, s25
    s_mov_b32 s18, 2097152
    s_mov_b32 s19, 0x00020000
    s_add_u32 s40, s20, 8388608
    s_addc_u32 s41, s21, 0
    s_mov_b32 s42, 2097152
    s_mov_b32 s43, 0x00020000
    v_and_b32 v16, 15, v1
    v_lshrrev_b32 v17, 4, v1
    s_lshl_b32 s29, s27, 5
    v_add_u32 v18, s29, v16
    v_lshlrev_b32 v20, 11, v18
    v_lshl_add_u32 v20, v17, 4, v20
    s_lshl_b32 s30, s26, 8
    v_add_u32 v20, s30, v20
    buffer_load_dwordx4 v[64:67], v20, s[8:11], 0 offen offset:0
    buffer_load_dwordx4 v[68:71], v20, s[8:11], 0 offen offset:64
    buffer_load_dwordx4 v[72:75], v20, s[8:11], 0 offen offset:128
    buffer_load_dwordx4 v[76:79], v20, s[8:11], 0 offen offset:192
    v_add_u32 v21, 32768, v20
    buffer_load_dwordx4 v[80:83], v21, s[8:11], 0 offen offset:0
    buffer_load_dwordx4 v[84:87], v21, s[8:11], 0 offen offset:64
    buffer_load_dwordx4 v[88:91], v21, s[8:11], 0 offen offset:128
    buffer_load_dwordx4 v[92:95], v21, s[8:11], 0 offen offset:192
    s_lshl_b32 s30, s26, 2
    s_mul_i32 s30, s30, 1088
    v_mul_u32_u24 v21, 272, v17
    v_add_u32 v21, s30, v21
    v_lshl_add_u32 v22, v16, 4, v21
    v_add_u32 v23, 256, v21
    buffer_load_dwordx4 v[96:99], v22, s[12:15], 0 offen offset:0
    buffer_load_dwordx4 v[112:115], v23, s[12:15], 0 offen offset:0
    buffer_load_dwordx4 v[100:103], v22, s[12:15], 0 offen offset:1088
    buffer_load_dwordx4 v[116:119], v23, s[12:15], 0 offen offset:1088
    buffer_load_dwordx4 v[104:107], v22, s[12:15], 0 offen offset:2176
    buffer_load_dwordx4 v[120:123], v23, s[12:15], 0 offen offset:2176
    buffer_load_dwordx4 v[108:111], v22, s[12:15], 0 offen offset:3264
    buffer_load_dwordx4 v[124:127], v23, s[12:15], 0 offen offset:3264
    s_add_u32 s36, s34, 0
    s_add_u32 s37, s35, 0
    s_mov_b32 m0, s37
    s_nop 0
    buffer_load_dwordx4 v2, s[4:7], s36 offen lds
    s_add_u32 s36, s34, 4096
    s_add_u32 s37, s35, 1024
    s_mov_b32 m0, s37
    s_nop 0
    buffer_load_dwordx4 v3, s[4:7], s36 offen lds
    s_add_u32 s36, s34, 8192
    s_add_u32 s37, s35, 2048
    s_mov_b32 m0, s37
    s_nop 0
    buffer_load_dwordx4 v2, s[4:7], s36 offen lds
    s_add_u32 s36, s34, 12288
    s_add_u32 s37, s35, 3072
    s_mov_b32 m0, s37
    s_nop 0
    buffer_load_dwordx4 v3, s[4:7], s36 offen lds
    s_add_u32 s36, s34, 16384
    s_add_u32 s37, s35, 4096
    s_mov_b32 m0, s37
    s_nop 0
    buffer_load_dwordx4 v2, s[4:7], s36 offen lds
    s_add_u32 s36, s34, 20480
    s_add_u32 s37, s35, 5120
    s_mov_b32 m0, s37
    s_nop 0
    buffer_load_dwordx4 v3, s[4:7], s36 offen lds
    s_add_u32 s36, s34, 24576
    s_add_u32 s37, s35, 6144
    s_mov_b32 m0, s37
    s_nop 0
    buffer_load_dwordx4 v2, s[4:7], s36 offen lds
    s_add_u32 s36, s34, 28672
    s_add_u32 s37, s35, 7168
    s_mov_b32 m0, s37
    s_nop 0
    buffer_load_dwordx4 v3, s[4:7], s36 offen lds
    s_add_u32 s36, s34, 32768
    s_add_u32 s37, s35, 8192
    s_mov_b32 m0, s37
    s_nop 0
    buffer_load_dwordx4 v2, s[4:7], s36 offen lds
    s_add_u32 s36, s34, 36864
    s_add_u32 s37, s35, 9216
    s_mov_b32 m0, s37
    s_nop 0
    buffer_load_dwordx4 v3, s[4:7], s36 offen lds
    s_add_u32 s36, s34, 40960
    s_add_u32 s37, s35, 10240
    s_mov_b32 m0, s37
    s_nop 0
    buffer_load_dwordx4 v2, s[4:7], s36 offen lds
    s_add_u32 s36, s34, 45056
    s_add_u32 s37, s35, 11264
    s_mov_b32 m0, s37
    s_nop 0
    buffer_load_dwordx4 v3, s[4:7], s36 offen lds
    s_add_u32 s36, s34, 49152
    s_add_u32 s37, s35, 12288
    s_mov_b32 m0, s37
    s_nop 0
    buffer_load_dwordx4 v2, s[4:7], s36 offen lds
    s_add_u32 s36, s34, 53248
    s_add_u32 s37, s35, 13312
    s_mov_b32 m0, s37
    s_nop 0
    buffer_load_dwordx4 v3, s[4:7], s36 offen lds
    s_add_u32 s36, s34, 57344
    s_add_u32 s37, s35, 14336
    s_mov_b32 m0, s37
    s_nop 0
    buffer_load_dwordx4 v2, s[4:7], s36 offen lds
    s_add_u32 s36, s34, 61440
    s_add_u32 s37, s35, 15360
    s_mov_b32 m0, s37
    s_nop 0
    buffer_load_dwordx4 v3, s[4:7], s36 offen lds
    v_lshlrev_b32 v24, 10, v18
    s_lshl_b32 s30, s28, 8
    s_lshl_b32 s31, s26, 5
    s_add_u32 s30, s30, s31
    v_add_u32 v24, s30, v24
    v_lshl_add_u32 v24, v17, 3, v24
    v_add_u32 v25, 16384, v24
    buffer_load_dwordx2 v[56:57], v24, s[16:19], 0 offen
    buffer_load_dwordx2 v[58:59], v25, s[16:19], 0 offen
    v_bfe_u32 v18, v1, 2, 2
    v_and_b32 v19, 3, v1
    v_lshl_add_u32 v26, v17, 2, v18
    v_lshlrev_b32 v27, 8, v26
    v_add_u32 v27, s35, v27
    v_and_b32 v30, 1, v19
    v_lshl_add_u32 v27, v30, 3, v27
    v_and_b32 v26, 7, v26
    v_lshlrev_b32 v26, 1, v26
    v_lshrrev_b32 v30, 1, v19
    v_or_b32 v31, 0, v30
    v_xor_b32 v31, v31, v26
    v_lshl_add_u32 v32, v31, 4, v27
    v_or_b32 v31, 2, v30
    v_xor_b32 v31, v31, v26
    v_lshl_add_u32 v33, v31, 4, v27
    v_or_b32 v31, 4, v30
    v_xor_b32 v31, v31, v26
    v_lshl_add_u32 v34, v31, 4, v27
    v_or_b32 v31, 6, v30
    v_xor_b32 v31, v31, v26
    v_lshl_add_u32 v35, v31, 4, v27
    v_or_b32 v31, 8, v30
    v_xor_b32 v31, v31, v26
    v_lshl_add_u32 v36, v31, 4, v27
    v_or_b32 v31, 10, v30
    v_xor_b32 v31, v31, v26
    v_lshl_add_u32 v37, v31, 4, v27
    v_or_b32 v31, 12, v30
    v_xor_b32 v31, v31, v26
    v_lshl_add_u32 v38, v31, 4, v27
    v_or_b32 v31, 14, v30
    v_xor_b32 v31, v31, v26
    v_lshl_add_u32 v39, v31, 4, v27
    s_waitcnt vmcnt(24)
    v_mov_b32 v144, 0
    v_mov_b32 v145, 0
    v_mov_b32 v146, 0
    v_mov_b32 v147, 0
    v_mov_b32 v148, 0
    v_mov_b32 v149, 0
    v_mov_b32 v150, 0
    v_mov_b32 v151, 0
    v_mfma_f32_16x16x32_bf16 v[144:147], v[96:99], v[64:67], v[144:147]
    s_nop 0
    v_mfma_f32_16x16x32_bf16 v[148:151], v[112:115], v[64:67], v[148:151]
    s_nop 7
    v_cvt_pk_bf16_f32 v152, v148, v148
    v_lshlrev_b32 v148, 16, v152
    v_add_f32 v148, 0x358637bd, v148
    v_cvt_pk_bf16_f32 v152, v148, v148
    v_lshlrev_b32 v148, 16, v152
    v_rcp_f32 v153, v148
    v_cvt_pk_bf16_f32 v152, v144, v145
    v_lshlrev_b32 v144, 16, v152
    v_and_b32 v145, 0xffff0000, v152
    v_cvt_pk_bf16_f32 v152, v146, v147
    v_lshlrev_b32 v146, 16, v152
    v_and_b32 v147, 0xffff0000, v152
    v_mul_f32 v144, v144, v153
    v_mul_f32 v145, v145, v153
    v_mul_f32 v146, v146, v153
    v_mul_f32 v147, v147, v153
    v_cvt_pk_bf16_f32 v128, v144, v145
    v_cvt_pk_bf16_f32 v129, v146, v147
    s_waitcnt vmcnt(22)
    v_mov_b32 v144, 0
    v_mov_b32 v145, 0
    v_mov_b32 v146, 0
    v_mov_b32 v147, 0
    v_mov_b32 v148, 0
    v_mov_b32 v149, 0
    v_mov_b32 v150, 0
    v_mov_b32 v151, 0
    v_mfma_f32_16x16x32_bf16 v[144:147], v[100:103], v[68:71], v[144:147]
    s_nop 0
    v_mfma_f32_16x16x32_bf16 v[148:151], v[116:119], v[68:71], v[148:151]
    s_nop 7
    v_cvt_pk_bf16_f32 v152, v148, v148
    v_lshlrev_b32 v148, 16, v152
    v_add_f32 v148, 0x358637bd, v148
    v_cvt_pk_bf16_f32 v152, v148, v148
    v_lshlrev_b32 v148, 16, v152
    v_rcp_f32 v153, v148
    v_cvt_pk_bf16_f32 v152, v144, v145
    v_lshlrev_b32 v144, 16, v152
    v_and_b32 v145, 0xffff0000, v152
    v_cvt_pk_bf16_f32 v152, v146, v147
    v_lshlrev_b32 v146, 16, v152
    v_and_b32 v147, 0xffff0000, v152
    v_mul_f32 v144, v144, v153
    v_mul_f32 v145, v145, v153
    v_mul_f32 v146, v146, v153
    v_mul_f32 v147, v147, v153
    v_cvt_pk_bf16_f32 v130, v144, v145
    v_cvt_pk_bf16_f32 v131, v146, v147
    s_waitcnt vmcnt(20)
    v_mov_b32 v144, 0
    v_mov_b32 v145, 0
    v_mov_b32 v146, 0
    v_mov_b32 v147, 0
    v_mov_b32 v148, 0
    v_mov_b32 v149, 0
    v_mov_b32 v150, 0
    v_mov_b32 v151, 0
    v_mfma_f32_16x16x32_bf16 v[144:147], v[104:107], v[72:75], v[144:147]
    s_nop 0
    v_mfma_f32_16x16x32_bf16 v[148:151], v[120:123], v[72:75], v[148:151]
    s_nop 7
    v_cvt_pk_bf16_f32 v152, v148, v148
    v_lshlrev_b32 v148, 16, v152
    v_add_f32 v148, 0x358637bd, v148
    v_cvt_pk_bf16_f32 v152, v148, v148
    v_lshlrev_b32 v148, 16, v152
    v_rcp_f32 v153, v148
    v_cvt_pk_bf16_f32 v152, v144, v145
    v_lshlrev_b32 v144, 16, v152
    v_and_b32 v145, 0xffff0000, v152
    v_cvt_pk_bf16_f32 v152, v146, v147
    v_lshlrev_b32 v146, 16, v152
    v_and_b32 v147, 0xffff0000, v152
    v_mul_f32 v144, v144, v153
    v_mul_f32 v145, v145, v153
    v_mul_f32 v146, v146, v153
    v_mul_f32 v147, v147, v153
    v_cvt_pk_bf16_f32 v132, v144, v145
    v_cvt_pk_bf16_f32 v133, v146, v147
    s_waitcnt vmcnt(18)
    v_mov_b32 v144, 0
    v_mov_b32 v145, 0
    v_mov_b32 v146, 0
    v_mov_b32 v147, 0
    v_mov_b32 v148, 0
    v_mov_b32 v149, 0
    v_mov_b32 v150, 0
    v_mov_b32 v151, 0
    v_mfma_f32_16x16x32_bf16 v[144:147], v[108:111], v[76:79], v[144:147]
    s_nop 0
    v_mfma_f32_16x16x32_bf16 v[148:151], v[124:127], v[76:79], v[148:151]
    s_nop 7
    v_cvt_pk_bf16_f32 v152, v148, v148
    v_lshlrev_b32 v148, 16, v152
    v_add_f32 v148, 0x358637bd, v148
    v_cvt_pk_bf16_f32 v152, v148, v148
    v_lshlrev_b32 v148, 16, v152
    v_rcp_f32 v153, v148
    v_cvt_pk_bf16_f32 v152, v144, v145
    v_lshlrev_b32 v144, 16, v152
    v_and_b32 v145, 0xffff0000, v152
    v_cvt_pk_bf16_f32 v152, v146, v147
    v_lshlrev_b32 v146, 16, v152
    v_and_b32 v147, 0xffff0000, v152
    v_mul_f32 v144, v144, v153
    v_mul_f32 v145, v145, v153
    v_mul_f32 v146, v146, v153
    v_mul_f32 v147, v147, v153
    v_cvt_pk_bf16_f32 v134, v144, v145
    v_cvt_pk_bf16_f32 v135, v146, v147
    v_mov_b32 v144, 0
    v_mov_b32 v145, 0
    v_mov_b32 v146, 0
    v_mov_b32 v147, 0
    v_mov_b32 v148, 0
    v_mov_b32 v149, 0
    v_mov_b32 v150, 0
    v_mov_b32 v151, 0
    v_mfma_f32_16x16x32_bf16 v[144:147], v[96:99], v[80:83], v[144:147]
    s_nop 0
    v_mfma_f32_16x16x32_bf16 v[148:151], v[112:115], v[80:83], v[148:151]
    s_nop 7
    v_cvt_pk_bf16_f32 v152, v148, v148
    v_lshlrev_b32 v148, 16, v152
    v_add_f32 v148, 0x358637bd, v148
    v_cvt_pk_bf16_f32 v152, v148, v148
    v_lshlrev_b32 v148, 16, v152
    v_rcp_f32 v153, v148
    v_cvt_pk_bf16_f32 v152, v144, v145
    v_lshlrev_b32 v144, 16, v152
    v_and_b32 v145, 0xffff0000, v152
    v_cvt_pk_bf16_f32 v152, v146, v147
    v_lshlrev_b32 v146, 16, v152
    v_and_b32 v147, 0xffff0000, v152
    v_mul_f32 v144, v144, v153
    v_mul_f32 v145, v145, v153
    v_mul_f32 v146, v146, v153
    v_mul_f32 v147, v147, v153
    v_cvt_pk_bf16_f32 v136, v144, v145
    v_cvt_pk_bf16_f32 v137, v146, v147
    v_mov_b32 v144, 0
    v_mov_b32 v145, 0
    v_mov_b32 v146, 0
    v_mov_b32 v147, 0
    v_mov_b32 v148, 0
    v_mov_b32 v149, 0
    v_mov_b32 v150, 0
    v_mov_b32 v151, 0
    v_mfma_f32_16x16x32_bf16 v[144:147], v[100:103], v[84:87], v[144:147]
    s_nop 0
    v_mfma_f32_16x16x32_bf16 v[148:151], v[116:119], v[84:87], v[148:151]
    s_nop 7
    v_cvt_pk_bf16_f32 v152, v148, v148
    v_lshlrev_b32 v148, 16, v152
    v_add_f32 v148, 0x358637bd, v148
    v_cvt_pk_bf16_f32 v152, v148, v148
    v_lshlrev_b32 v148, 16, v152
    v_rcp_f32 v153, v148
    v_cvt_pk_bf16_f32 v152, v144, v145
    v_lshlrev_b32 v144, 16, v152
    v_and_b32 v145, 0xffff0000, v152
    v_cvt_pk_bf16_f32 v152, v146, v147
    v_lshlrev_b32 v146, 16, v152
    v_and_b32 v147, 0xffff0000, v152
    v_mul_f32 v144, v144, v153
    v_mul_f32 v145, v145, v153
    v_mul_f32 v146, v146, v153
    v_mul_f32 v147, v147, v153
    v_cvt_pk_bf16_f32 v138, v144, v145
    v_cvt_pk_bf16_f32 v139, v146, v147
    v_mov_b32 v144, 0
    v_mov_b32 v145, 0
    v_mov_b32 v146, 0
    v_mov_b32 v147, 0
    v_mov_b32 v148, 0
    v_mov_b32 v149, 0
    v_mov_b32 v150, 0
    v_mov_b32 v151, 0
    v_mfma_f32_16x16x32_bf16 v[144:147], v[104:107], v[88:91], v[144:147]
    s_nop 0
    v_mfma_f32_16x16x32_bf16 v[148:151], v[120:123], v[88:91], v[148:151]
    s_nop 7
    v_cvt_pk_bf16_f32 v152, v148, v148
    v_lshlrev_b32 v148, 16, v152
    v_add_f32 v148, 0x358637bd, v148
    v_cvt_pk_bf16_f32 v152, v148, v148
    v_lshlrev_b32 v148, 16, v152
    v_rcp_f32 v153, v148
    v_cvt_pk_bf16_f32 v152, v144, v145
    v_lshlrev_b32 v144, 16, v152
    v_and_b32 v145, 0xffff0000, v152
    v_cvt_pk_bf16_f32 v152, v146, v147
    v_lshlrev_b32 v146, 16, v152
    v_and_b32 v147, 0xffff0000, v152
    v_mul_f32 v144, v144, v153
    v_mul_f32 v145, v145, v153
    v_mul_f32 v146, v146, v153
    v_mul_f32 v147, v147, v153
    v_cvt_pk_bf16_f32 v140, v144, v145
    v_cvt_pk_bf16_f32 v141, v146, v147
    v_mov_b32 v144, 0
    v_mov_b32 v145, 0
    v_mov_b32 v146, 0
    v_mov_b32 v147, 0
    v_mov_b32 v148, 0
    v_mov_b32 v149, 0
    v_mov_b32 v150, 0
    v_mov_b32 v151, 0
    v_mfma_f32_16x16x32_bf16 v[144:147], v[108:111], v[92:95], v[144:147]
    s_nop 0
    v_mfma_f32_16x16x32_bf16 v[148:151], v[124:127], v[92:95], v[148:151]
    s_nop 7
    v_cvt_pk_bf16_f32 v152, v148, v148
    v_lshlrev_b32 v148, 16, v152
    v_add_f32 v148, 0x358637bd, v148
    v_cvt_pk_bf16_f32 v152, v148, v148
    v_lshlrev_b32 v148, 16, v152
    v_rcp_f32 v153, v148
    v_cvt_pk_bf16_f32 v152, v144, v145
    v_lshlrev_b32 v144, 16, v152
    v_and_b32 v145, 0xffff0000, v152
    v_cvt_pk_bf16_f32 v152, v146, v147
    v_lshlrev_b32 v146, 16, v152
    v_and_b32 v147, 0xffff0000, v152
    v_mul_f32 v144, v144, v153
    v_mul_f32 v145, v145, v153
    v_mul_f32 v146, v146, v153
    v_mul_f32 v147, v147, v153
    v_cvt_pk_bf16_f32 v142, v144, v145
    v_cvt_pk_bf16_f32 v143, v146, v147
    v_mov_b32 v160, 0
    v_mov_b32 v161, 0
    v_mov_b32 v162, 0
    v_mov_b32 v163, 0
    v_mov_b32 v164, 0
    v_mov_b32 v165, 0
    v_mov_b32 v166, 0
    v_mov_b32 v167, 0
    v_mov_b32 v168, 0
    v_mov_b32 v169, 0
    v_mov_b32 v170, 0
    v_mov_b32 v171, 0
    v_mov_b32 v172, 0
    v_mov_b32 v173, 0
    v_mov_b32 v174, 0
    v_mov_b32 v175, 0
    v_mov_b32 v176, 0
    v_mov_b32 v177, 0
    v_mov_b32 v178, 0
    v_mov_b32 v179, 0
    v_mov_b32 v180, 0
    v_mov_b32 v181, 0
    v_mov_b32 v182, 0
    v_mov_b32 v183, 0
    v_mov_b32 v184, 0
    v_mov_b32 v185, 0
    v_mov_b32 v186, 0
    v_mov_b32 v187, 0
    v_mov_b32 v188, 0
    v_mov_b32 v189, 0
    v_mov_b32 v190, 0
    v_mov_b32 v191, 0
    v_mov_b32 v192, 0
    v_mov_b32 v193, 0
    v_mov_b32 v194, 0
    v_mov_b32 v195, 0
    v_mov_b32 v196, 0
    v_mov_b32 v197, 0
    v_mov_b32 v198, 0
    v_mov_b32 v199, 0
    v_mov_b32 v200, 0
    v_mov_b32 v201, 0
    v_mov_b32 v202, 0
    v_mov_b32 v203, 0
    v_mov_b32 v204, 0
    v_mov_b32 v205, 0
    v_mov_b32 v206, 0
    v_mov_b32 v207, 0
    v_mov_b32 v208, 0
    v_mov_b32 v209, 0
    v_mov_b32 v210, 0
    v_mov_b32 v211, 0
    v_mov_b32 v212, 0
    v_mov_b32 v213, 0
    v_mov_b32 v214, 0
    v_mov_b32 v215, 0
    v_mov_b32 v216, 0
    v_mov_b32 v217, 0
    v_mov_b32 v218, 0
    v_mov_b32 v219, 0
    v_mov_b32 v220, 0
    v_mov_b32 v221, 0
    v_mov_b32 v222, 0
    v_mov_b32 v223, 0
    s_waitcnt vmcnt(2)
    ds_read_b64_tr_b16 v[96:97], v32 offset:0
    ds_read_b64_tr_b16 v[98:99], v32 offset:4096
    ds_read_b64_tr_b16 v[100:101], v33 offset:0
    ds_read_b64_tr_b16 v[102:103], v33 offset:4096
    ds_read_b64_tr_b16 v[104:105], v34 offset:0
    ds_read_b64_tr_b16 v[106:107], v34 offset:4096
    s_waitcnt lgkmcnt(4)
    v_mfma_f32_16x16x32_bf16 v[160:163], v[96:99], v[128:131], v[160:163]
    v_mfma_f32_16x16x32_bf16 v[192:195], v[96:99], v[136:139], v[192:195]
    ds_read_b64_tr_b16 v[108:109], v35 offset:0
    ds_read_b64_tr_b16 v[110:111], v35 offset:4096
    s_waitcnt lgkmcnt(4)
    v_mfma_f32_16x16x32_bf16 v[164:167], v[100:103], v[128:131], v[164:167]
    v_mfma_f32_16x16x32_bf16 v[196:199], v[100:103], v[136:139], v[196:199]
    ds_read_b64_tr_b16 v[96:97], v36 offset:0
    ds_read_b64_tr_b16 v[98:99], v36 offset:4096
    s_waitcnt lgkmcnt(4)
    v_mfma_f32_16x16x32_bf16 v[168:171], v[104:107], v[128:131], v[168:171]
    v_mfma_f32_16x16x32_bf16 v[200:203], v[104:107], v[136:139], v[200:203]
    ds_read_b64_tr_b16 v[100:101], v37 offset:0
    ds_read_b64_tr_b16 v[102:103], v37 offset:4096
    s_waitcnt lgkmcnt(4)
    v_mfma_f32_16x16x32_bf16 v[172:175], v[108:111], v[128:131], v[172:175]
    v_mfma_f32_16x16x32_bf16 v[204:207], v[108:111], v[136:139], v[204:207]
    ds_read_b64_tr_b16 v[104:105], v38 offset:0
    ds_read_b64_tr_b16 v[106:107], v38 offset:4096
    s_waitcnt lgkmcnt(4)
    v_mfma_f32_16x16x32_bf16 v[176:179], v[96:99], v[128:131], v[176:179]
    v_mfma_f32_16x16x32_bf16 v[208:211], v[96:99], v[136:139], v[208:211]
    ds_read_b64_tr_b16 v[108:109], v39 offset:0
    ds_read_b64_tr_b16 v[110:111], v39 offset:4096
    s_waitcnt lgkmcnt(4)
    v_mfma_f32_16x16x32_bf16 v[180:183], v[100:103], v[128:131], v[180:183]
    v_mfma_f32_16x16x32_bf16 v[212:215], v[100:103], v[136:139], v[212:215]
    ds_read_b64_tr_b16 v[96:97], v32 offset:8192
    ds_read_b64_tr_b16 v[98:99], v32 offset:12288
    s_waitcnt lgkmcnt(4)
    v_mfma_f32_16x16x32_bf16 v[184:187], v[104:107], v[128:131], v[184:187]
    v_mfma_f32_16x16x32_bf16 v[216:219], v[104:107], v[136:139], v[216:219]
    ds_read_b64_tr_b16 v[100:101], v33 offset:8192
    ds_read_b64_tr_b16 v[102:103], v33 offset:12288
    s_waitcnt lgkmcnt(4)
    v_mfma_f32_16x16x32_bf16 v[188:191], v[108:111], v[128:131], v[188:191]
    v_mfma_f32_16x16x32_bf16 v[220:223], v[108:111], v[136:139], v[220:223]
    ds_read_b64_tr_b16 v[104:105], v34 offset:8192
    ds_read_b64_tr_b16 v[106:107], v34 offset:12288
    s_waitcnt lgkmcnt(4)
    v_mfma_f32_16x16x32_bf16 v[160:163], v[96:99], v[132:135], v[160:163]
    v_mfma_f32_16x16x32_bf16 v[192:195], v[96:99], v[140:143], v[192:195]
    ds_read_b64_tr_b16 v[108:109], v35 offset:8192
    ds_read_b64_tr_b16 v[110:111], v35 offset:12288
    s_waitcnt lgkmcnt(4)
    v_mfma_f32_16x16x32_bf16 v[164:167], v[100:103], v[132:135], v[164:167]
    v_mfma_f32_16x16x32_bf16 v[196:199], v[100:103], v[140:143], v[196:199]
    ds_read_b64_tr_b16 v[96:97], v36 offset:8192
    ds_read_b64_tr_b16 v[98:99], v36 offset:12288
    s_waitcnt lgkmcnt(4)
    v_mfma_f32_16x16x32_bf16 v[168:171], v[104:107], v[132:135], v[168:171]
    v_mfma_f32_16x16x32_bf16 v[200:203], v[104:107], v[140:143], v[200:203]
    ds_read_b64_tr_b16 v[100:101], v37 offset:8192
    ds_read_b64_tr_b16 v[102:103], v37 offset:12288
    s_waitcnt lgkmcnt(4)
    v_mfma_f32_16x16x32_bf16 v[172:175], v[108:111], v[132:135], v[172:175]
    v_mfma_f32_16x16x32_bf16 v[204:207], v[108:111], v[140:143], v[204:207]
    ds_read_b64_tr_b16 v[104:105], v38 offset:8192
    ds_read_b64_tr_b16 v[106:107], v38 offset:12288
    s_waitcnt lgkmcnt(4)
    v_mfma_f32_16x16x32_bf16 v[176:179], v[96:99], v[132:135], v[176:179]
    v_mfma_f32_16x16x32_bf16 v[208:211], v[96:99], v[140:143], v[208:211]
    ds_read_b64_tr_b16 v[108:109], v39 offset:8192
    ds_read_b64_tr_b16 v[110:111], v39 offset:12288
    s_waitcnt lgkmcnt(4)
    v_mfma_f32_16x16x32_bf16 v[180:183], v[100:103], v[132:135], v[180:183]
    v_mfma_f32_16x16x32_bf16 v[212:215], v[100:103], v[140:143], v[212:215]
    s_waitcnt lgkmcnt(2)
    v_mfma_f32_16x16x32_bf16 v[184:187], v[104:107], v[132:135], v[184:187]
    v_mfma_f32_16x16x32_bf16 v[216:219], v[104:107], v[140:143], v[216:219]
    s_waitcnt lgkmcnt(0)
    v_mfma_f32_16x16x32_bf16 v[188:191], v[108:111], v[132:135], v[188:191]
    v_mfma_f32_16x16x32_bf16 v[220:223], v[108:111], v[140:143], v[220:223]
    s_barrier
    v_lshlrev_b32 v16, 4, v1
    s_lshl_b32 s30, s26, 14
    v_add_u32 v16, s30, v16
    ds_write_b128 v16, v[160:163] offset:0
    ds_write_b128 v16, v[192:195] offset:1024
    ds_write_b128 v16, v[164:167] offset:2048
    ds_write_b128 v16, v[196:199] offset:3072
    ds_write_b128 v16, v[168:171] offset:4096
    ds_write_b128 v16, v[200:203] offset:5120
    ds_write_b128 v16, v[172:175] offset:6144
    ds_write_b128 v16, v[204:207] offset:7168
    ds_write_b128 v16, v[176:179] offset:8192
    ds_write_b128 v16, v[208:211] offset:9216
    ds_write_b128 v16, v[180:183] offset:10240
    ds_write_b128 v16, v[212:215] offset:11264
    ds_write_b128 v16, v[184:187] offset:12288
    ds_write_b128 v16, v[216:219] offset:13312
    ds_write_b128 v16, v[188:191] offset:14336
    ds_write_b128 v16, v[220:223] offset:15360
    s_waitcnt lgkmcnt(0)
    s_barrier
    v_lshlrev_b32 v16, 4, v1
    s_lshl_b32 s30, s26, 11
    v_add_u32 v16, s30, v16
    v_add_u32 v17, 65536, v16
    ds_read_b128 v[64:67], v16 offset:0
    ds_read_b128 v[68:71], v16 offset:1024
    ds_read_b128 v[72:75], v16 offset:16384
    ds_read_b128 v[76:79], v16 offset:17408
    ds_read_b128 v[80:83], v16 offset:32768
    ds_read_b128 v[84:87], v16 offset:33792
    ds_read_b128 v[88:91], v16 offset:49152
    ds_read_b128 v[92:95], v16 offset:50176
    ds_read_b128 v[96:99], v17 offset:0
    ds_read_b128 v[100:103], v17 offset:1024
    ds_read_b128 v[104:107], v17 offset:16384
    ds_read_b128 v[108:111], v17 offset:17408
    ds_read_b128 v[112:115], v17 offset:32768
    ds_read_b128 v[116:119], v17 offset:33792
    ds_read_b128 v[120:123], v17 offset:49152
    ds_read_b128 v[124:127], v17 offset:50176
    s_waitcnt lgkmcnt(0)
    v_add_f32 v64, v64, v72
    v_add_f32 v65, v65, v73
    v_add_f32 v66, v66, v74
    v_add_f32 v67, v67, v75
    v_add_f32 v68, v68, v76
    v_add_f32 v69, v69, v77
    v_add_f32 v70, v70, v78
    v_add_f32 v71, v71, v79
    v_add_f32 v64, v64, v80
    v_add_f32 v65, v65, v81
    v_add_f32 v66, v66, v82
    v_add_f32 v67, v67, v83
    v_add_f32 v68, v68, v84
    v_add_f32 v69, v69, v85
    v_add_f32 v70, v70, v86
    v_add_f32 v71, v71, v87
    v_add_f32 v64, v64, v88
    v_add_f32 v65, v65, v89
    v_add_f32 v66, v66, v90
    v_add_f32 v67, v67, v91
    v_add_f32 v68, v68, v92
    v_add_f32 v69, v69, v93
    v_add_f32 v70, v70, v94
    v_add_f32 v71, v71, v95
    v_add_f32 v64, v64, v96
    v_add_f32 v65, v65, v97
    v_add_f32 v66, v66, v98
    v_add_f32 v67, v67, v99
    v_add_f32 v68, v68, v100
    v_add_f32 v69, v69, v101
    v_add_f32 v70, v70, v102
    v_add_f32 v71, v71, v103
    v_add_f32 v64, v64, v104
    v_add_f32 v65, v65, v105
    v_add_f32 v66, v66, v106
    v_add_f32 v67, v67, v107
    v_add_f32 v68, v68, v108
    v_add_f32 v69, v69, v109
    v_add_f32 v70, v70, v110
    v_add_f32 v71, v71, v111
    v_add_f32 v64, v64, v112
    v_add_f32 v65, v65, v113
    v_add_f32 v66, v66, v114
    v_add_f32 v67, v67, v115
    v_add_f32 v68, v68, v116
    v_add_f32 v69, v69, v117
    v_add_f32 v70, v70, v118
    v_add_f32 v71, v71, v119
    v_add_f32 v64, v64, v120
    v_add_f32 v65, v65, v121
    v_add_f32 v66, v66, v122
    v_add_f32 v67, v67, v123
    v_add_f32 v68, v68, v124
    v_add_f32 v69, v69, v125
    v_add_f32 v70, v70, v126
    v_add_f32 v71, v71, v127
    s_waitcnt vmcnt(0)
    v_cvt_pk_bf16_f32 v152, v64, v65
    v_lshlrev_b32 v64, 16, v152
    v_and_b32 v65, 0xffff0000, v152
    v_cvt_pk_bf16_f32 v153, v66, v67
    v_lshlrev_b32 v66, 16, v153
    v_and_b32 v67, 0xffff0000, v153
    v_lshlrev_b32 v154, 16, v56
    v_and_b32 v155, 0xffff0000, v56
    v_add_f32 v64, v64, v154
    v_add_f32 v65, v65, v155
    v_lshlrev_b32 v154, 16, v57
    v_and_b32 v155, 0xffff0000, v57
    v_add_f32 v66, v66, v154
    v_add_f32 v67, v67, v155
    v_cvt_pk_bf16_f32 v156, v64, v65
    v_cvt_pk_bf16_f32 v157, v66, v67
    v_cvt_pk_bf16_f32 v152, v68, v69
    v_lshlrev_b32 v68, 16, v152
    v_and_b32 v69, 0xffff0000, v152
    v_cvt_pk_bf16_f32 v153, v70, v71
    v_lshlrev_b32 v70, 16, v153
    v_and_b32 v71, 0xffff0000, v153
    v_lshlrev_b32 v154, 16, v58
    v_and_b32 v155, 0xffff0000, v58
    v_add_f32 v68, v68, v154
    v_add_f32 v69, v69, v155
    v_lshlrev_b32 v154, 16, v59
    v_and_b32 v155, 0xffff0000, v59
    v_add_f32 v70, v70, v154
    v_add_f32 v71, v71, v155
    v_cvt_pk_bf16_f32 v158, v68, v69
    v_cvt_pk_bf16_f32 v159, v70, v71
    buffer_store_dwordx2 v[156:157], v24, s[40:43], 0 offen
    buffer_store_dwordx2 v[158:159], v25, s[40:43], 0 offen
L_k2_done:
    s_endpgm
.text
.globl k3_ffn_up_kernel
.p2align 8
.type k3_ffn_up_kernel,@function
k3_ffn_up_kernel:

    s_cmp_ge_u32 s2, 256
    s_cbranch_scc1 L_k3_done
    s_load_dwordx2 s[20:21], s[0:1], 80
    s_load_dwordx2 s[22:23], s[0:1], 40
    s_load_dwordx2 s[24:25], s[0:1], 48
    v_lshrrev_b32 v16, 6, v0
    v_and_b32 v1, 63, v0
    v_readfirstlane_b32 s26, v16
    s_and_b32 s27, s2, 3
    s_lshl_b32 s27, s27, 2
    s_bfe_u32 s28, s2, 0x20003
    s_add_u32 s27, s27, s28
    s_bfe_u32 s28, s2, 0x10002
    s_lshl_b32 s28, s28, 3
    s_lshr_b32 s29, s2, 5
    s_add_u32 s28, s28, s29
    s_and_b32 s39, s26, 3
    v_lshrrev_b32 v17, 4, v1
    v_and_b32 v18, 15, v1
    v_lshlrev_b32 v19, 2, v17
    v_xor_b32 v18, v18, v19
    v_cmp_gt_u32 s[32:33], 14, v18
    s_movk_i32 s30, 3584
    v_mul_lo_u32 v3, v17, s30
    v_lshl_add_u32 v3, v18, 4, v3
    s_mul_i32 s30, s28, 224
    v_add_u32 v3, s30, v3
    v_lshrrev_b32 v17, 3, v1
    v_and_b32 v18, 7, v1
    v_lshrrev_b32 v19, 1, v17
    v_xor_b32 v18, v18, v19
    s_lshl_b32 s30, s27, 7
    s_lshl_b32 s36, s26, 4
    s_add_u32 s30, s30, s36
    v_add_u32 v17, s30, v17
    v_lshlrev_b32 v2, 10, v17
    v_xor_b32 v19, 4, v18
    v_lshl_add_u32 v10, v19, 4, v2
    v_add_u32 v10, 8192, v10
    v_lshl_add_u32 v2, v18, 4, v2
    s_lshl_b32 s38, s26, 11
    s_lshr_b32 s30, s26, 2
    s_mul_i32 s34, s39, 57344
    s_lshl_b32 s35, s39, 12
    s_lshl_b32 s36, s30, 14
    s_add_u32 s35, s35, s36
    s_add_u32 s35, s35, 16384
    s_waitcnt lgkmcnt(0)
    s_add_u32 s4, s20, 8388608
    s_addc_u32 s5, s21, 0
    s_mov_b32 s6, 2097152
    s_mov_b32 s7, 0x00020000
    s_cmp_eq_u32 s30, 0
    s_cselect_b32 s8, s22, s24
    s_cselect_b32 s9, s23, s25
    s_mov_b32 s10, 1835008
    s_mov_b32 s11, 0x00020000
    s_add_u32 s37, s38, 0
    s_mov_b32 m0, s37
    s_movk_i32 s36, 0
    buffer_load_dwordx4 v2, s[4:7], s36 offen lds
    s_add_u32 s37, s38, 1024
    s_mov_b32 m0, s37
    s_movk_i32 s36, 0
    buffer_load_dwordx4 v10, s[4:7], s36 offen lds
    s_add_u32 s36, s34, 0
    s_add_u32 s37, s35, 0
    s_mov_b32 m0, s37
    s_mov_b64 exec, s[32:33]
    buffer_load_dwordx4 v3, s[8:11], s36 offen lds
    s_mov_b64 exec, -1
    s_add_u32 s36, s34, 14336
    s_add_u32 s37, s35, 1024
    s_mov_b32 m0, s37
    s_mov_b64 exec, s[32:33]
    buffer_load_dwordx4 v3, s[8:11], s36 offen lds
    s_mov_b64 exec, -1
    s_add_u32 s36, s34, 28672
    s_add_u32 s37, s35, 2048
    s_mov_b32 m0, s37
    s_mov_b64 exec, s[32:33]
    buffer_load_dwordx4 v3, s[8:11], s36 offen lds
    s_mov_b64 exec, -1
    s_add_u32 s36, s34, 43008
    s_add_u32 s37, s35, 3072
    s_mov_b32 m0, s37
    s_mov_b64 exec, s[32:33]
    buffer_load_dwordx4 v3, s[8:11], s36 offen lds
    s_mov_b64 exec, -1
    s_add_u32 s12, s20, 12582912
    s_addc_u32 s13, s21, 0
    s_mov_b32 s14, 7340032
    s_mov_b32 s15, 0x00020000
    s_add_u32 s16, s20, 6356992
    s_addc_u32 s17, s21, 0
    s_mov_b32 s18, 14336
    s_mov_b32 s19, 0x00020000
    v_and_b32 v16, 31, v1
    v_lshrrev_b32 v17, 5, v1
    v_bfe_u32 v18, v1, 2, 2
    v_and_b32 v19, 3, v1
    v_bfe_u32 v20, v1, 4, 1
    s_lshl_b32 s29, s27, 7
    s_lshl_b32 s30, s39, 5
    s_add_u32 s29, s29, s30
    v_add_u32 v21, s29, v16
    s_movk_i32 s30, 3584
    v_mul_lo_u32 v22, v21, s30
    s_mul_i32 s30, s28, 224
    v_add_u32 v22, s30, v22
    v_lshl_add_u32 v22, v17, 3, v22
    v_lshrrev_b32 v23, 3, v16
    s_lshl_b32 s30, s39, 2
    v_add_u32 v23, s30, v23
    v_lshlrev_b32 v24, 10, v23
    v_and_b32 v23, 7, v16
    v_lshl_add_u32 v24, v23, 7, v24
    v_bfe_u32 v23, v16, 1, 3
    v_lshl_add_u32 v25, v17, 0, 0
    v_xor_b32 v25, v25, v23
    v_lshl_add_u32 v30, v25, 4, v24
    v_lshl_add_u32 v25, v17, 0, 2
    v_xor_b32 v25, v25, v23
    v_lshl_add_u32 v31, v25, 4, v24
    v_lshl_add_u32 v25, v17, 0, 4
    v_xor_b32 v25, v25, v23
    v_lshl_add_u32 v32, v25, 4, v24
    v_lshl_add_u32 v25, v17, 0, 6
    v_xor_b32 v25, v25, v23
    v_lshl_add_u32 v33, v25, 4, v24
    v_lshl_add_u32 v21, v17, 3, v18
    v_lshlrev_b32 v21, 8, v21
    v_and_b32 v23, 1, v19
    v_lshl_add_u32 v21, v23, 3, v21
    v_add_u32 v21, 16384, v21
    v_lshrrev_b32 v23, 1, v19
    v_lshl_add_u32 v24, v20, 1, v23
    v_xor_b32 v25, 0, v18
    v_lshl_add_u32 v4, v25, 6, v21
    v_lshl_add_u32 v4, v24, 4, v4
    v_xor_b32 v25, 1, v18
    v_lshl_add_u32 v5, v25, 6, v21
    v_lshl_add_u32 v5, v24, 4, v5
    v_xor_b32 v25, 2, v18
    v_lshl_add_u32 v6, v25, 6, v21
    v_lshl_add_u32 v6, v24, 4, v6
    v_xor_b32 v25, 3, v18
    v_lshl_add_u32 v7, v25, 6, v21
    v_lshl_add_u32 v7, v23, 4, v7
    v_lshl_add_u32 v7, v20, 14, v7
    v_lshrrev_b32 v16, 5, v0
    v_and_b32 v17, 31, v0
    v_min_u32 v16, 6, v16
    v_and_b32 v18, 1, v16
    v_lshrrev_b32 v19, 1, v16
    v_lshl_add_u32 v19, v19, 5, v17
    v_cmp_le_u32 vcc, 16, v17
    v_cmp_eq_u32 s[36:37], 6, v16
    s_nop 1
    s_and_b64 vcc, vcc, s[36:37]
    v_cndmask_b32 v18, v18, 1, vcc
    v_subrev_u32 v20, 16, v19
    v_cndmask_b32 v19, v19, v20, vcc
    s_mul_i32 s30, s28, 112
    v_add_u32 v19, s30, v19
    s_movk_i32 s30, 1792
    v_mul_lo_u32 v18, v18, s30
    v_add_u32 v19, v19, v18
    v_lshlrev_b32 v19, 2, v19
    buffer_load_dword v20, v19, s[16:19], 0 offen
    s_add_u32 s37, s38, 49152
    s_mov_b32 m0, s37
    s_movk_i32 s36, 128
    buffer_load_dwordx4 v2, s[4:7], s36 offen lds
    s_add_u32 s37, s38, 50176
    s_mov_b32 m0, s37
    s_movk_i32 s36, 128
    buffer_load_dwordx4 v10, s[4:7], s36 offen lds
    s_add_u32 s36, s34, 229376
    s_add_u32 s37, s35, 49152
    s_mov_b32 m0, s37
    s_mov_b64 exec, s[32:33]
    buffer_load_dwordx4 v3, s[8:11], s36 offen lds
    s_mov_b64 exec, -1
    s_add_u32 s36, s34, 243712
    s_add_u32 s37, s35, 50176
    s_mov_b32 m0, s37
    s_mov_b64 exec, s[32:33]
    buffer_load_dwordx4 v3, s[8:11], s36 offen lds
    s_mov_b64 exec, -1
    s_add_u32 s36, s34, 258048
    s_add_u32 s37, s35, 51200
    s_mov_b32 m0, s37
    s_mov_b64 exec, s[32:33]
    buffer_load_dwordx4 v3, s[8:11], s36 offen lds
    s_mov_b64 exec, -1
    s_add_u32 s36, s34, 272384
    s_add_u32 s37, s35, 52224
    s_mov_b32 m0, s37
    s_mov_b64 exec, s[32:33]
    buffer_load_dwordx4 v3, s[8:11], s36 offen lds
    s_mov_b64 exec, -1
    v_mov_b32 v128, 0
    v_mov_b32 v129, 0
    v_mov_b32 v130, 0
    v_mov_b32 v131, 0
    v_mov_b32 v132, 0
    v_mov_b32 v133, 0
    v_mov_b32 v134, 0
    v_mov_b32 v135, 0
    v_mov_b32 v136, 0
    v_mov_b32 v137, 0
    v_mov_b32 v138, 0
    v_mov_b32 v139, 0
    v_mov_b32 v140, 0
    v_mov_b32 v141, 0
    v_mov_b32 v142, 0
    v_mov_b32 v143, 0
    v_mov_b32 v144, 0
    v_mov_b32 v145, 0
    v_mov_b32 v146, 0
    v_mov_b32 v147, 0
    v_mov_b32 v148, 0
    v_mov_b32 v149, 0
    v_mov_b32 v150, 0
    v_mov_b32 v151, 0
    v_mov_b32 v152, 0
    v_mov_b32 v153, 0
    v_mov_b32 v154, 0
    v_mov_b32 v155, 0
    v_mov_b32 v156, 0
    v_mov_b32 v157, 0
    v_mov_b32 v158, 0
    v_mov_b32 v159, 0
    v_mov_b32 v160, 0
    v_mov_b32 v161, 0
    v_mov_b32 v162, 0
    v_mov_b32 v163, 0
    v_mov_b32 v164, 0
    v_mov_b32 v165, 0
    v_mov_b32 v166, 0
    v_mov_b32 v167, 0
    v_mov_b32 v168, 0
    v_mov_b32 v169, 0
    v_mov_b32 v170, 0
    v_mov_b32 v171, 0
    v_mov_b32 v172, 0
    v_mov_b32 v173, 0
    v_mov_b32 v174, 0
    v_mov_b32 v175, 0
    v_mov_b32 v176, 0
    v_mov_b32 v177, 0
    v_mov_b32 v178, 0
    v_mov_b32 v179, 0
    v_mov_b32 v180, 0
    v_mov_b32 v181, 0
    v_mov_b32 v182, 0
    v_mov_b32 v183, 0
    v_mov_b32 v184, 0
    v_mov_b32 v185, 0
    v_mov_b32 v186, 0
    v_mov_b32 v187, 0
    v_mov_b32 v188, 0
    v_mov_b32 v189, 0
    v_mov_b32 v190, 0
    v_mov_b32 v191, 0
    v_mov_b32 v12, 0
    v_mov_b32 v13, 0
    v_mov_b32 v14, 0
    v_mov_b32 v15, 0
    s_cmp_ge_u32 s26, 4
    s_cbranch_scc1 L_k3_tg1
    v_add_u32 v28, 0, v4
    v_add_u32 v29, 0, v5
    v_add_u32 v34, 49152, v4
    v_add_u32 v35, 49152, v5
    v_add_u32 v36, 49152, v30
    v_add_u32 v37, 49152, v31
    v_add_u32 v38, 49152, v32
    v_add_u32 v39, 49152, v33
    v_add_u32 v40, 98304, v4
    v_add_u32 v41, 98304, v5
    v_add_u32 v42, 98304, v30
    v_add_u32 v43, 98304, v31
    v_add_u32 v44, 98304, v32
    v_add_u32 v45, 98304, v33
    s_waitcnt vmcnt(7)
    s_barrier
    ds_read_b128 v[96:99], v30
    ds_read_b64_tr_b16 v[64:65], v28 offset:0
    ds_read_b64_tr_b16 v[66:67], v28 offset:1024
    ds_read_b64_tr_b16 v[68:69], v28 offset:16384
    ds_read_b64_tr_b16 v[70:71], v28 offset:17408
    ds_read_b64_tr_b16 v[72:73], v29 offset:0
    ds_read_b64_tr_b16 v[74:75], v29 offset:1024
    ds_read_b64_tr_b16 v[76:77], v29 offset:16384
    ds_read_b64_tr_b16 v[78:79], v29 offset:17408
    ds_read_b128 v[100:103], v31
    ds_read_b64_tr_b16 v[80:81], v28 offset:4096
    ds_read_b64_tr_b16 v[82:83], v28 offset:5120
    s_waitcnt lgkmcnt(9)
    v_mfma_f32_32x32x16_bf16 v[128:143], v[64:67], v[96:99], v[128:143]
    v_lshlrev_b32 v16, 16, v96
    v_and_b32 v17, 0xffff0000, v96
    v_add_f32 v12, v12, v16
    v_add_f32 v13, v13, v17
    v_fma_f32 v14, v16, v16, v14
    v_fma_f32 v15, v17, v17, v15
    ds_read_b64_tr_b16 v[84:85], v28 offset:20480
    ds_read_b64_tr_b16 v[86:87], v28 offset:21504
    s_waitcnt lgkmcnt(9)
    v_mfma_f32_32x32x16_bf16 v[144:159], v[68:71], v[96:99], v[144:159]
    v_lshlrev_b32 v16, 16, v97
    v_and_b32 v17, 0xffff0000, v97
    v_add_f32 v12, v12, v16
    v_add_f32 v13, v13, v17
    v_fma_f32 v14, v16, v16, v14
    v_fma_f32 v15, v17, v17, v15
    ds_read_b64_tr_b16 v[64:65], v29 offset:4096
    ds_read_b64_tr_b16 v[66:67], v29 offset:5120
    s_waitcnt lgkmcnt(9)
    v_mfma_f32_32x32x16_bf16 v[160:175], v[72:75], v[96:99], v[160:175]
    s_add_u32 s37, s38, 98304
    s_mov_b32 m0, s37
    s_movk_i32 s36, 256
    buffer_load_dwordx4 v2, s[4:7], s36 offen lds
    ds_read_b64_tr_b16 v[68:69], v29 offset:20480
    ds_read_b64_tr_b16 v[70:71], v29 offset:21504
    s_waitcnt lgkmcnt(9)
    v_mfma_f32_32x32x16_bf16 v[176:191], v[76:79], v[96:99], v[176:191]
    s_add_u32 s37, s38, 99328
    s_mov_b32 m0, s37
    s_movk_i32 s36, 256
    buffer_load_dwordx4 v10, s[4:7], s36 offen lds
    ds_read_b128 v[104:107], v32
    ds_read_b64_tr_b16 v[72:73], v28 offset:8192
    ds_read_b64_tr_b16 v[74:75], v28 offset:9216
    s_waitcnt lgkmcnt(9)
    v_mfma_f32_32x32x16_bf16 v[128:143], v[80:83], v[100:103], v[128:143]
    v_lshlrev_b32 v16, 16, v100
    v_and_b32 v17, 0xffff0000, v100
    v_add_f32 v12, v12, v16
    v_add_f32 v13, v13, v17
    v_fma_f32 v14, v16, v16, v14
    v_fma_f32 v15, v17, v17, v15
    ds_read_b64_tr_b16 v[76:77], v28 offset:24576
    ds_read_b64_tr_b16 v[78:79], v28 offset:25600
    s_waitcnt lgkmcnt(9)
    v_mfma_f32_32x32x16_bf16 v[144:159], v[84:87], v[100:103], v[144:159]
    v_lshlrev_b32 v16, 16, v101
    v_and_b32 v17, 0xffff0000, v101
    v_add_f32 v12, v12, v16
    v_add_f32 v13, v13, v17
    v_fma_f32 v14, v16, v16, v14
    v_fma_f32 v15, v17, v17, v15
    ds_read_b64_tr_b16 v[80:81], v29 offset:8192
    ds_read_b64_tr_b16 v[82:83], v29 offset:9216
    s_waitcnt lgkmcnt(9)
    v_mfma_f32_32x32x16_bf16 v[160:175], v[64:67], v[100:103], v[160:175]
    s_add_u32 s36, s34, 458752
    s_add_u32 s37, s35, 98304
    s_mov_b32 m0, s37
    s_mov_b64 exec, s[32:33]
    buffer_load_dwordx4 v3, s[8:11], s36 offen lds
    s_mov_b64 exec, -1
    ds_read_b64_tr_b16 v[84:85], v29 offset:24576
    ds_read_b64_tr_b16 v[86:87], v29 offset:25600
    s_waitcnt lgkmcnt(9)
    v_mfma_f32_32x32x16_bf16 v[176:191], v[68:71], v[100:103], v[176:191]
    s_add_u32 s36, s34, 473088
    s_add_u32 s37, s35, 99328
    s_mov_b32 m0, s37
    s_mov_b64 exec, s[32:33]
    buffer_load_dwordx4 v3, s[8:11], s36 offen lds
    s_mov_b64 exec, -1
    ds_read_b128 v[96:99], v33
    ds_read_b64_tr_b16 v[64:65], v28 offset:12288
    ds_read_b64_tr_b16 v[66:67], v28 offset:13312
    s_waitcnt lgkmcnt(9)
    v_mfma_f32_32x32x16_bf16 v[128:143], v[72:75], v[104:107], v[128:143]
    v_lshlrev_b32 v16, 16, v104
    v_and_b32 v17, 0xffff0000, v104
    v_add_f32 v12, v12, v16
    v_add_f32 v13, v13, v17
    v_fma_f32 v14, v16, v16, v14
    v_fma_f32 v15, v17, v17, v15
    ds_read_b64_tr_b16 v[68:69], v28 offset:28672
    ds_read_b64_tr_b16 v[70:71], v28 offset:29696
    s_waitcnt lgkmcnt(9)
    v_mfma_f32_32x32x16_bf16 v[144:159], v[76:79], v[104:107], v[144:159]
    v_lshlrev_b32 v16, 16, v105
    v_and_b32 v17, 0xffff0000, v105
    v_add_f32 v12, v12, v16
    v_add_f32 v13, v13, v17
    v_fma_f32 v14, v16, v16, v14
    v_fma_f32 v15, v17, v17, v15
    ds_read_b64_tr_b16 v[72:73], v29 offset:12288
    ds_read_b64_tr_b16 v[74:75], v29 offset:13312
    s_waitcnt lgkmcnt(9)
    v_mfma_f32_32x32x16_bf16 v[160:175], v[80:83], v[104:107], v[160:175]
    s_add_u32 s36, s34, 487424
    s_add_u32 s37, s35, 100352
    s_mov_b32 m0, s37
    s_mov_b64 exec, s[32:33]
    buffer_load_dwordx4 v3, s[8:11], s36 offen lds
    s_mov_b64 exec, -1
    ds_read_b64_tr_b16 v[76:77], v29 offset:28672
    ds_read_b64_tr_b16 v[78:79], v29 offset:29696
    s_waitcnt lgkmcnt(9)
    v_mfma_f32_32x32x16_bf16 v[176:191], v[84:87], v[104:107], v[176:191]
    s_add_u32 s36, s34, 501760
    s_add_u32 s37, s35, 101376
    s_mov_b32 m0, s37
    s_mov_b64 exec, s[32:33]
    buffer_load_dwordx4 v3, s[8:11], s36 offen lds
    s_mov_b64 exec, -1
    s_waitcnt vmcnt(6)
    s_waitcnt lgkmcnt(0)
    s_barrier
    ds_read_b128 v[100:103], v36
    ds_read_b64_tr_b16 v[80:81], v34 offset:0
    ds_read_b64_tr_b16 v[82:83], v34 offset:1024
    v_mfma_f32_32x32x16_bf16 v[128:143], v[64:67], v[96:99], v[128:143]
    v_lshlrev_b32 v16, 16, v96
    v_and_b32 v17, 0xffff0000, v96
    v_add_f32 v12, v12, v16
    v_add_f32 v13, v13, v17
    v_fma_f32 v14, v16, v16, v14
    v_fma_f32 v15, v17, v17, v15
    ds_read_b64_tr_b16 v[84:85], v34 offset:16384
    ds_read_b64_tr_b16 v[86:87], v34 offset:17408
    v_mfma_f32_32x32x16_bf16 v[144:159], v[68:71], v[96:99], v[144:159]
    v_lshlrev_b32 v16, 16, v97
    v_and_b32 v17, 0xffff0000, v97
    v_add_f32 v12, v12, v16
    v_add_f32 v13, v13, v17
    v_fma_f32 v14, v16, v16, v14
    v_fma_f32 v15, v17, v17, v15
    ds_read_b64_tr_b16 v[64:65], v35 offset:0
    ds_read_b64_tr_b16 v[66:67], v35 offset:1024
    v_mfma_f32_32x32x16_bf16 v[160:175], v[72:75], v[96:99], v[160:175]
    s_add_u32 s37, s38, 0
    s_mov_b32 m0, s37
    s_movk_i32 s36, 384
    buffer_load_dwordx4 v2, s[4:7], s36 offen lds
    ds_read_b64_tr_b16 v[68:69], v35 offset:16384
    ds_read_b64_tr_b16 v[70:71], v35 offset:17408
    v_mfma_f32_32x32x16_bf16 v[176:191], v[76:79], v[96:99], v[176:191]
    s_add_u32 s37, s38, 1024
    s_mov_b32 m0, s37
    s_movk_i32 s36, 384
    buffer_load_dwordx4 v10, s[4:7], s36 offen lds
    ds_read_b128 v[104:107], v37
    ds_read_b64_tr_b16 v[72:73], v34 offset:4096
    ds_read_b64_tr_b16 v[74:75], v34 offset:5120
    s_waitcnt lgkmcnt(9)
    v_mfma_f32_32x32x16_bf16 v[128:143], v[80:83], v[100:103], v[128:143]
    v_lshlrev_b32 v16, 16, v100
    v_and_b32 v17, 0xffff0000, v100
    v_add_f32 v12, v12, v16
    v_add_f32 v13, v13, v17
    v_fma_f32 v14, v16, v16, v14
    v_fma_f32 v15, v17, v17, v15
    ds_read_b64_tr_b16 v[76:77], v34 offset:20480
    ds_read_b64_tr_b16 v[78:79], v34 offset:21504
    s_waitcnt lgkmcnt(9)
    v_mfma_f32_32x32x16_bf16 v[144:159], v[84:87], v[100:103], v[144:159]
    v_lshlrev_b32 v16, 16, v101
    v_and_b32 v17, 0xffff0000, v101
    v_add_f32 v12, v12, v16
    v_add_f32 v13, v13, v17
    v_fma_f32 v14, v16, v16, v14
    v_fma_f32 v15, v17, v17, v15
    ds_read_b64_tr_b16 v[80:81], v35 offset:4096
    ds_read_b64_tr_b16 v[82:83], v35 offset:5120
    s_waitcnt lgkmcnt(9)
    v_mfma_f32_32x32x16_bf16 v[160:175], v[64:67], v[100:103], v[160:175]
    s_add_u32 s36, s34, 688128
    s_add_u32 s37, s35, 0
    s_mov_b32 m0, s37
    s_mov_b64 exec, s[32:33]
    buffer_load_dwordx4 v3, s[8:11], s36 offen lds
    s_mov_b64 exec, -1
    ds_read_b64_tr_b16 v[84:85], v35 offset:20480
    ds_read_b64_tr_b16 v[86:87], v35 offset:21504
    s_waitcnt lgkmcnt(9)
    v_mfma_f32_32x32x16_bf16 v[176:191], v[68:71], v[100:103], v[176:191]
    s_add_u32 s36, s34, 702464
    s_add_u32 s37, s35, 1024
    s_mov_b32 m0, s37
    s_mov_b64 exec, s[32:33]
    buffer_load_dwordx4 v3, s[8:11], s36 offen lds
    s_mov_b64 exec, -1
    ds_read_b128 v[96:99], v38
    ds_read_b64_tr_b16 v[64:65], v34 offset:8192
    ds_read_b64_tr_b16 v[66:67], v34 offset:9216
    s_waitcnt lgkmcnt(9)
    v_mfma_f32_32x32x16_bf16 v[128:143], v[72:75], v[104:107], v[128:143]
    v_lshlrev_b32 v16, 16, v104
    v_and_b32 v17, 0xffff0000, v104
    v_add_f32 v12, v12, v16
    v_add_f32 v13, v13, v17
    v_fma_f32 v14, v16, v16, v14
    v_fma_f32 v15, v17, v17, v15
    v_lshlrev_b32 v18, 2, v0
    v_add_u32 v18, 147456, v18
    v_min_u32 v18, 148476, v18
    ds_write_b32 v18, v20
    ds_read_b64_tr_b16 v[68:69], v34 offset:24576
    ds_read_b64_tr_b16 v[70:71], v34 offset:25600
    s_waitcnt lgkmcnt(10)
    v_mfma_f32_32x32x16_bf16 v[144:159], v[76:79], v[104:107], v[144:159]
    v_lshlrev_b32 v16, 16, v105
    v_and_b32 v17, 0xffff0000, v105
    v_add_f32 v12, v12, v16
    v_add_f32 v13, v13, v17
    v_fma_f32 v14, v16, v16, v14
    v_fma_f32 v15, v17, v17, v15
    ds_read_b64_tr_b16 v[72:73], v35 offset:8192
    ds_read_b64_tr_b16 v[74:75], v35 offset:9216
    s_waitcnt lgkmcnt(10)
    v_mfma_f32_32x32x16_bf16 v[160:175], v[80:83], v[104:107], v[160:175]
    s_add_u32 s36, s34, 716800
    s_add_u32 s37, s35, 2048
    s_mov_b32 m0, s37
    s_mov_b64 exec, s[32:33]
    buffer_load_dwordx4 v3, s[8:11], s36 offen lds
    s_mov_b64 exec, -1
    ds_read_b64_tr_b16 v[76:77], v35 offset:24576
    ds_read_b64_tr_b16 v[78:79], v35 offset:25600
    s_waitcnt lgkmcnt(10)
    v_mfma_f32_32x32x16_bf16 v[176:191], v[84:87], v[104:107], v[176:191]
    s_add_u32 s36, s34, 731136
    s_add_u32 s37, s35, 3072
    s_mov_b32 m0, s37
    s_mov_b64 exec, s[32:33]
    buffer_load_dwordx4 v3, s[8:11], s36 offen lds
    s_mov_b64 exec, -1
    ds_read_b128 v[100:103], v39
    ds_read_b64_tr_b16 v[80:81], v34 offset:12288
    ds_read_b64_tr_b16 v[82:83], v34 offset:13312
    s_waitcnt lgkmcnt(10)
    v_mfma_f32_32x32x16_bf16 v[128:143], v[64:67], v[96:99], v[128:143]
    v_lshlrev_b32 v16, 16, v96
    v_and_b32 v17, 0xffff0000, v96
    v_add_f32 v12, v12, v16
    v_add_f32 v13, v13, v17
    v_fma_f32 v14, v16, v16, v14
    v_fma_f32 v15, v17, v17, v15
    ds_read_b64_tr_b16 v[84:85], v34 offset:28672
    ds_read_b64_tr_b16 v[86:87], v34 offset:29696
    s_waitcnt lgkmcnt(9)
    v_mfma_f32_32x32x16_bf16 v[144:159], v[68:71], v[96:99], v[144:159]
    v_lshlrev_b32 v16, 16, v97
    v_and_b32 v17, 0xffff0000, v97
    v_add_f32 v12, v12, v16
    v_add_f32 v13, v13, v17
    v_fma_f32 v14, v16, v16, v14
    v_fma_f32 v15, v17, v17, v15
    ds_read_b64_tr_b16 v[64:65], v35 offset:12288
    ds_read_b64_tr_b16 v[66:67], v35 offset:13312
    s_waitcnt lgkmcnt(9)
    v_mfma_f32_32x32x16_bf16 v[160:175], v[72:75], v[96:99], v[160:175]
    ds_read_b64_tr_b16 v[68:69], v35 offset:28672
    ds_read_b64_tr_b16 v[70:71], v35 offset:29696
    s_waitcnt lgkmcnt(9)
    v_mfma_f32_32x32x16_bf16 v[176:191], v[76:79], v[96:99], v[176:191]
    s_waitcnt vmcnt(6)
    s_waitcnt lgkmcnt(0)
    s_barrier
    ds_read_b128 v[104:107], v42
    ds_read_b64_tr_b16 v[72:73], v40 offset:0
    ds_read_b64_tr_b16 v[74:75], v40 offset:1024
    v_mfma_f32_32x32x16_bf16 v[128:143], v[80:83], v[100:103], v[128:143]
    v_lshlrev_b32 v16, 16, v100
    v_and_b32 v17, 0xffff0000, v100
    v_add_f32 v12, v12, v16
    v_add_f32 v13, v13, v17
    v_fma_f32 v14, v16, v16, v14
    v_fma_f32 v15, v17, v17, v15
    ds_read_b64_tr_b16 v[76:77], v40 offset:16384
    ds_read_b64_tr_b16 v[78:79], v40 offset:17408
    v_mfma_f32_32x32x16_bf16 v[144:159], v[84:87], v[100:103], v[144:159]
    v_lshlrev_b32 v16, 16, v101
    v_and_b32 v17, 0xffff0000, v101
    v_add_f32 v12, v12, v16
    v_add_f32 v13, v13, v17
    v_fma_f32 v14, v16, v16, v14
    v_fma_f32 v15, v17, v17, v15
    ds_read_b64_tr_b16 v[80:81], v41 offset:0
    ds_read_b64_tr_b16 v[82:83], v41 offset:1024
    v_mfma_f32_32x32x16_bf16 v[160:175], v[64:67], v[100:103], v[160:175]
    s_add_u32 s37, s38, 49152
    s_mov_b32 m0, s37
    s_movk_i32 s36, 512
    buffer_load_dwordx4 v2, s[4:7], s36 offen lds
    ds_read_b64_tr_b16 v[84:85], v41 offset:16384
    ds_read_b64_tr_b16 v[86:87], v41 offset:17408
    v_mfma_f32_32x32x16_bf16 v[176:191], v[68:71], v[100:103], v[176:191]
    s_add_u32 s37, s38, 50176
    s_mov_b32 m0, s37
    s_movk_i32 s36, 512
    buffer_load_dwordx4 v10, s[4:7], s36 offen lds
    ds_read_b128 v[96:99], v43
    ds_read_b64_tr_b16 v[64:65], v40 offset:4096
    ds_read_b64_tr_b16 v[66:67], v40 offset:5120
    s_waitcnt lgkmcnt(9)
    v_mfma_f32_32x32x16_bf16 v[128:143], v[72:75], v[104:107], v[128:143]
    v_lshlrev_b32 v16, 16, v104
    v_and_b32 v17, 0xffff0000, v104
    v_add_f32 v12, v12, v16
    v_add_f32 v13, v13, v17
    v_fma_f32 v14, v16, v16, v14
    v_fma_f32 v15, v17, v17, v15
    ds_read_b64_tr_b16 v[68:69], v40 offset:20480
    ds_read_b64_tr_b16 v[70:71], v40 offset:21504
    s_waitcnt lgkmcnt(9)
    v_mfma_f32_32x32x16_bf16 v[144:159], v[76:79], v[104:107], v[144:159]
    v_lshlrev_b32 v16, 16, v105
    v_and_b32 v17, 0xffff0000, v105
    v_add_f32 v12, v12, v16
    v_add_f32 v13, v13, v17
    v_fma_f32 v14, v16, v16, v14
    v_fma_f32 v15, v17, v17, v15
    ds_read_b64_tr_b16 v[72:73], v41 offset:4096
    ds_read_b64_tr_b16 v[74:75], v41 offset:5120
    s_waitcnt lgkmcnt(9)
    v_mfma_f32_32x32x16_bf16 v[160:175], v[80:83], v[104:107], v[160:175]
    s_add_u32 s36, s34, 917504
    s_add_u32 s37, s35, 49152
    s_mov_b32 m0, s37
    s_mov_b64 exec, s[32:33]
    buffer_load_dwordx4 v3, s[8:11], s36 offen lds
    s_mov_b64 exec, -1
    ds_read_b64_tr_b16 v[76:77], v41 offset:20480
    ds_read_b64_tr_b16 v[78:79], v41 offset:21504
    s_waitcnt lgkmcnt(9)
    v_mfma_f32_32x32x16_bf16 v[176:191], v[84:87], v[104:107], v[176:191]
    s_add_u32 s36, s34, 931840
    s_add_u32 s37, s35, 50176
    s_mov_b32 m0, s37
    s_mov_b64 exec, s[32:33]
    buffer_load_dwordx4 v3, s[8:11], s36 offen lds
    s_mov_b64 exec, -1
    ds_read_b128 v[100:103], v44
    ds_read_b64_tr_b16 v[80:81], v40 offset:8192
    ds_read_b64_tr_b16 v[82:83], v40 offset:9216
    s_waitcnt lgkmcnt(9)
    v_mfma_f32_32x32x16_bf16 v[128:143], v[64:67], v[96:99], v[128:143]
    v_lshlrev_b32 v16, 16, v96
    v_and_b32 v17, 0xffff0000, v96
    v_add_f32 v12, v12, v16
    v_add_f32 v13, v13, v17
    v_fma_f32 v14, v16, v16, v14
    v_fma_f32 v15, v17, v17, v15
    ds_read_b64_tr_b16 v[84:85], v40 offset:24576
    ds_read_b64_tr_b16 v[86:87], v40 offset:25600
    s_waitcnt lgkmcnt(9)
    v_mfma_f32_32x32x16_bf16 v[144:159], v[68:71], v[96:99], v[144:159]
    v_lshlrev_b32 v16, 16, v97
    v_and_b32 v17, 0xffff0000, v97
    v_add_f32 v12, v12, v16
    v_add_f32 v13, v13, v17
    v_fma_f32 v14, v16, v16, v14
    v_fma_f32 v15, v17, v17, v15
    ds_read_b64_tr_b16 v[64:65], v41 offset:8192
    ds_read_b64_tr_b16 v[66:67], v41 offset:9216
    s_waitcnt lgkmcnt(9)
    v_mfma_f32_32x32x16_bf16 v[160:175], v[72:75], v[96:99], v[160:175]
    s_add_u32 s36, s34, 946176
    s_add_u32 s37, s35, 51200
    s_mov_b32 m0, s37
    s_mov_b64 exec, s[32:33]
    buffer_load_dwordx4 v3, s[8:11], s36 offen lds
    s_mov_b64 exec, -1
    ds_read_b64_tr_b16 v[68:69], v41 offset:24576
    ds_read_b64_tr_b16 v[70:71], v41 offset:25600
    s_waitcnt lgkmcnt(9)
    v_mfma_f32_32x32x16_bf16 v[176:191], v[76:79], v[96:99], v[176:191]
    s_add_u32 s36, s34, 960512
    s_add_u32 s37, s35, 52224
    s_mov_b32 m0, s37
    s_mov_b64 exec, s[32:33]
    buffer_load_dwordx4 v3, s[8:11], s36 offen lds
    s_mov_b64 exec, -1
    ds_read_b128 v[104:107], v45
    ds_read_b64_tr_b16 v[72:73], v40 offset:12288
    ds_read_b64_tr_b16 v[74:75], v40 offset:13312
    s_waitcnt lgkmcnt(9)
    v_mfma_f32_32x32x16_bf16 v[128:143], v[80:83], v[100:103], v[128:143]
    v_lshlrev_b32 v16, 16, v100
    v_and_b32 v17, 0xffff0000, v100
    v_add_f32 v12, v12, v16
    v_add_f32 v13, v13, v17
    v_fma_f32 v14, v16, v16, v14
    v_fma_f32 v15, v17, v17, v15
    ds_read_b64_tr_b16 v[76:77], v40 offset:28672
    ds_read_b64_tr_b16 v[78:79], v40 offset:29696
    s_waitcnt lgkmcnt(9)
    v_mfma_f32_32x32x16_bf16 v[144:159], v[84:87], v[100:103], v[144:159]
    v_lshlrev_b32 v16, 16, v101
    v_and_b32 v17, 0xffff0000, v101
    v_add_f32 v12, v12, v16
    v_add_f32 v13, v13, v17
    v_fma_f32 v14, v16, v16, v14
    v_fma_f32 v15, v17, v17, v15
    ds_read_b64_tr_b16 v[80:81], v41 offset:12288
    ds_read_b64_tr_b16 v[82:83], v41 offset:13312
    s_waitcnt lgkmcnt(9)
    v_mfma_f32_32x32x16_bf16 v[160:175], v[64:67], v[100:103], v[160:175]
    ds_read_b64_tr_b16 v[84:85], v41 offset:28672
    ds_read_b64_tr_b16 v[86:87], v41 offset:29696
    s_waitcnt lgkmcnt(9)
    v_mfma_f32_32x32x16_bf16 v[176:191], v[68:71], v[100:103], v[176:191]
    s_waitcnt vmcnt(6)
    s_waitcnt lgkmcnt(0)
    s_barrier
    ds_read_b128 v[96:99], v30
    ds_read_b64_tr_b16 v[64:65], v28 offset:0
    ds_read_b64_tr_b16 v[66:67], v28 offset:1024
    v_mfma_f32_32x32x16_bf16 v[128:143], v[72:75], v[104:107], v[128:143]
    v_lshlrev_b32 v16, 16, v104
    v_and_b32 v17, 0xffff0000, v104
    v_add_f32 v12, v12, v16
    v_add_f32 v13, v13, v17
    v_fma_f32 v14, v16, v16, v14
    v_fma_f32 v15, v17, v17, v15
    ds_read_b64_tr_b16 v[68:69], v28 offset:16384
    ds_read_b64_tr_b16 v[70:71], v28 offset:17408
    v_mfma_f32_32x32x16_bf16 v[144:159], v[76:79], v[104:107], v[144:159]
    v_lshlrev_b32 v16, 16, v105
    v_and_b32 v17, 0xffff0000, v105
    v_add_f32 v12, v12, v16
    v_add_f32 v13, v13, v17
    v_fma_f32 v14, v16, v16, v14
    v_fma_f32 v15, v17, v17, v15
    ds_read_b64_tr_b16 v[72:73], v29 offset:0
    ds_read_b64_tr_b16 v[74:75], v29 offset:1024
    v_mfma_f32_32x32x16_bf16 v[160:175], v[80:83], v[104:107], v[160:175]
    s_add_u32 s37, s38, 98304
    s_mov_b32 m0, s37
    s_movk_i32 s36, 640
    buffer_load_dwordx4 v2, s[4:7], s36 offen lds
    ds_read_b64_tr_b16 v[76:77], v29 offset:16384
    ds_read_b64_tr_b16 v[78:79], v29 offset:17408
    v_mfma_f32_32x32x16_bf16 v[176:191], v[84:87], v[104:107], v[176:191]
    s_add_u32 s37, s38, 99328
    s_mov_b32 m0, s37
    s_movk_i32 s36, 640
    buffer_load_dwordx4 v10, s[4:7], s36 offen lds
    ds_read_b128 v[100:103], v31
    ds_read_b64_tr_b16 v[80:81], v28 offset:4096
    ds_read_b64_tr_b16 v[82:83], v28 offset:5120
    s_waitcnt lgkmcnt(9)
    v_mfma_f32_32x32x16_bf16 v[128:143], v[64:67], v[96:99], v[128:143]
    v_lshlrev_b32 v16, 16, v96
    v_and_b32 v17, 0xffff0000, v96
    v_add_f32 v12, v12, v16
    v_add_f32 v13, v13, v17
    v_fma_f32 v14, v16, v16, v14
    v_fma_f32 v15, v17, v17, v15
    ds_read_b64_tr_b16 v[84:85], v28 offset:20480
    ds_read_b64_tr_b16 v[86:87], v28 offset:21504
    s_waitcnt lgkmcnt(9)
    v_mfma_f32_32x32x16_bf16 v[144:159], v[68:71], v[96:99], v[144:159]
    v_lshlrev_b32 v16, 16, v97
    v_and_b32 v17, 0xffff0000, v97
    v_add_f32 v12, v12, v16
    v_add_f32 v13, v13, v17
    v_fma_f32 v14, v16, v16, v14
    v_fma_f32 v15, v17, v17, v15
    ds_read_b64_tr_b16 v[64:65], v29 offset:4096
    ds_read_b64_tr_b16 v[66:67], v29 offset:5120
    s_waitcnt lgkmcnt(9)
    v_mfma_f32_32x32x16_bf16 v[160:175], v[72:75], v[96:99], v[160:175]
    s_add_u32 s36, s34, 1146880
    s_add_u32 s37, s35, 98304
    s_mov_b32 m0, s37
    s_mov_b64 exec, s[32:33]
    buffer_load_dwordx4 v3, s[8:11], s36 offen lds
    s_mov_b64 exec, -1
    ds_read_b64_tr_b16 v[68:69], v29 offset:20480
    ds_read_b64_tr_b16 v[70:71], v29 offset:21504
    s_waitcnt lgkmcnt(9)
    v_mfma_f32_32x32x16_bf16 v[176:191], v[76:79], v[96:99], v[176:191]
    s_add_u32 s36, s34, 1161216
    s_add_u32 s37, s35, 99328
    s_mov_b32 m0, s37
    s_mov_b64 exec, s[32:33]
    buffer_load_dwordx4 v3, s[8:11], s36 offen lds
    s_mov_b64 exec, -1
    ds_read_b128 v[104:107], v32
    ds_read_b64_tr_b16 v[72:73], v28 offset:8192
    ds_read_b64_tr_b16 v[74:75], v28 offset:9216
    s_waitcnt lgkmcnt(9)
    v_mfma_f32_32x32x16_bf16 v[128:143], v[80:83], v[100:103], v[128:143]
    v_lshlrev_b32 v16, 16, v100
    v_and_b32 v17, 0xffff0000, v100
    v_add_f32 v12, v12, v16
    v_add_f32 v13, v13, v17
    v_fma_f32 v14, v16, v16, v14
    v_fma_f32 v15, v17, v17, v15
    ds_read_b64_tr_b16 v[76:77], v28 offset:24576
    ds_read_b64_tr_b16 v[78:79], v28 offset:25600
    s_waitcnt lgkmcnt(9)
    v_mfma_f32_32x32x16_bf16 v[144:159], v[84:87], v[100:103], v[144:159]
    v_lshlrev_b32 v16, 16, v101
    v_and_b32 v17, 0xffff0000, v101
    v_add_f32 v12, v12, v16
    v_add_f32 v13, v13, v17
    v_fma_f32 v14, v16, v16, v14
    v_fma_f32 v15, v17, v17, v15
    ds_read_b64_tr_b16 v[80:81], v29 offset:8192
    ds_read_b64_tr_b16 v[82:83], v29 offset:9216
    s_waitcnt lgkmcnt(9)
    v_mfma_f32_32x32x16_bf16 v[160:175], v[64:67], v[100:103], v[160:175]
    s_add_u32 s36, s34, 1175552
    s_add_u32 s37, s35, 100352
    s_mov_b32 m0, s37
    s_mov_b64 exec, s[32:33]
    buffer_load_dwordx4 v3, s[8:11], s36 offen lds
    s_mov_b64 exec, -1
    ds_read_b64_tr_b16 v[84:85], v29 offset:24576
    ds_read_b64_tr_b16 v[86:87], v29 offset:25600
    s_waitcnt lgkmcnt(9)
    v_mfma_f32_32x32x16_bf16 v[176:191], v[68:71], v[100:103], v[176:191]
    s_add_u32 s36, s34, 1189888
    s_add_u32 s37, s35, 101376
    s_mov_b32 m0, s37
    s_mov_b64 exec, s[32:33]
    buffer_load_dwordx4 v3, s[8:11], s36 offen lds
    s_mov_b64 exec, -1
    ds_read_b128 v[96:99], v33
    ds_read_b64_tr_b16 v[64:65], v28 offset:12288
    ds_read_b64_tr_b16 v[66:67], v28 offset:13312
    s_waitcnt lgkmcnt(9)
    v_mfma_f32_32x32x16_bf16 v[128:143], v[72:75], v[104:107], v[128:143]
    v_lshlrev_b32 v16, 16, v104
    v_and_b32 v17, 0xffff0000, v104
    v_add_f32 v12, v12, v16
    v_add_f32 v13, v13, v17
    v_fma_f32 v14, v16, v16, v14
    v_fma_f32 v15, v17, v17, v15
    ds_read_b64_tr_b16 v[68:69], v28 offset:28672
    ds_read_b64_tr_b16 v[70:71], v28 offset:29696
    s_waitcnt lgkmcnt(9)
    v_mfma_f32_32x32x16_bf16 v[144:159], v[76:79], v[104:107], v[144:159]
    v_lshlrev_b32 v16, 16, v105
    v_and_b32 v17, 0xffff0000, v105
    v_add_f32 v12, v12, v16
    v_add_f32 v13, v13, v17
    v_fma_f32 v14, v16, v16, v14
    v_fma_f32 v15, v17, v17, v15
    ds_read_b64_tr_b16 v[72:73], v29 offset:12288
    ds_read_b64_tr_b16 v[74:75], v29 offset:13312
    s_waitcnt lgkmcnt(9)
    v_mfma_f32_32x32x16_bf16 v[160:175], v[80:83], v[104:107], v[160:175]
    ds_read_b64_tr_b16 v[76:77], v29 offset:28672
    ds_read_b64_tr_b16 v[78:79], v29 offset:29696
    s_waitcnt lgkmcnt(9)
    v_mfma_f32_32x32x16_bf16 v[176:191], v[84:87], v[104:107], v[176:191]
    s_waitcnt vmcnt(6)
    s_waitcnt lgkmcnt(0)
    s_barrier
    ds_read_b128 v[100:103], v36
    ds_read_b64_tr_b16 v[80:81], v34 offset:0
    ds_read_b64_tr_b16 v[82:83], v34 offset:1024
    v_mfma_f32_32x32x16_bf16 v[128:143], v[64:67], v[96:99], v[128:143]
    v_lshlrev_b32 v16, 16, v96
    v_and_b32 v17, 0xffff0000, v96
    v_add_f32 v12, v12, v16
    v_add_f32 v13, v13, v17
    v_fma_f32 v14, v16, v16, v14
    v_fma_f32 v15, v17, v17, v15
    ds_read_b64_tr_b16 v[84:85], v34 offset:16384
    ds_read_b64_tr_b16 v[86:87], v34 offset:17408
    v_mfma_f32_32x32x16_bf16 v[144:159], v[68:71], v[96:99], v[144:159]
    v_lshlrev_b32 v16, 16, v97
    v_and_b32 v17, 0xffff0000, v97
    v_add_f32 v12, v12, v16
    v_add_f32 v13, v13, v17
    v_fma_f32 v14, v16, v16, v14
    v_fma_f32 v15, v17, v17, v15
    ds_read_b64_tr_b16 v[64:65], v35 offset:0
    ds_read_b64_tr_b16 v[66:67], v35 offset:1024
    v_mfma_f32_32x32x16_bf16 v[160:175], v[72:75], v[96:99], v[160:175]
    s_add_u32 s37, s38, 0
    s_mov_b32 m0, s37
    s_movk_i32 s36, 768
    buffer_load_dwordx4 v2, s[4:7], s36 offen lds
    ds_read_b64_tr_b16 v[68:69], v35 offset:16384
    ds_read_b64_tr_b16 v[70:71], v35 offset:17408
    v_mfma_f32_32x32x16_bf16 v[176:191], v[76:79], v[96:99], v[176:191]
    s_add_u32 s37, s38, 1024
    s_mov_b32 m0, s37
    s_movk_i32 s36, 768
    buffer_load_dwordx4 v10, s[4:7], s36 offen lds
    ds_read_b128 v[104:107], v37
    ds_read_b64_tr_b16 v[72:73], v34 offset:4096
    ds_read_b64_tr_b16 v[74:75], v34 offset:5120
    s_waitcnt lgkmcnt(9)
    v_mfma_f32_32x32x16_bf16 v[128:143], v[80:83], v[100:103], v[128:143]
    v_lshlrev_b32 v16, 16, v100
    v_and_b32 v17, 0xffff0000, v100
    v_add_f32 v12, v12, v16
    v_add_f32 v13, v13, v17
    v_fma_f32 v14, v16, v16, v14
    v_fma_f32 v15, v17, v17, v15
    ds_read_b64_tr_b16 v[76:77], v34 offset:20480
    ds_read_b64_tr_b16 v[78:79], v34 offset:21504
    s_waitcnt lgkmcnt(9)
    v_mfma_f32_32x32x16_bf16 v[144:159], v[84:87], v[100:103], v[144:159]
    v_lshlrev_b32 v16, 16, v101
    v_and_b32 v17, 0xffff0000, v101
    v_add_f32 v12, v12, v16
    v_add_f32 v13, v13, v17
    v_fma_f32 v14, v16, v16, v14
    v_fma_f32 v15, v17, v17, v15
    ds_read_b64_tr_b16 v[80:81], v35 offset:4096
    ds_read_b64_tr_b16 v[82:83], v35 offset:5120
    s_waitcnt lgkmcnt(9)
    v_mfma_f32_32x32x16_bf16 v[160:175], v[64:67], v[100:103], v[160:175]
    s_add_u32 s36, s34, 1376256
    s_add_u32 s37, s35, 0
    s_mov_b32 m0, s37
    s_mov_b64 exec, s[32:33]
    buffer_load_dwordx4 v3, s[8:11], s36 offen lds
    s_mov_b64 exec, -1
    ds_read_b64_tr_b16 v[84:85], v35 offset:20480
    ds_read_b64_tr_b16 v[86:87], v35 offset:21504
    s_waitcnt lgkmcnt(9)
    v_mfma_f32_32x32x16_bf16 v[176:191], v[68:71], v[100:103], v[176:191]
    s_add_u32 s36, s34, 1390592
    s_add_u32 s37, s35, 1024
    s_mov_b32 m0, s37
    s_mov_b64 exec, s[32:33]
    buffer_load_dwordx4 v3, s[8:11], s36 offen lds
    s_mov_b64 exec, -1
    ds_read_b128 v[96:99], v38
    ds_read_b64_tr_b16 v[64:65], v34 offset:8192
    ds_read_b64_tr_b16 v[66:67], v34 offset:9216
    s_waitcnt lgkmcnt(9)
    v_mfma_f32_32x32x16_bf16 v[128:143], v[72:75], v[104:107], v[128:143]
    v_lshlrev_b32 v16, 16, v104
    v_and_b32 v17, 0xffff0000, v104
    v_add_f32 v12, v12, v16
    v_add_f32 v13, v13, v17
    v_fma_f32 v14, v16, v16, v14
    v_fma_f32 v15, v17, v17, v15
    ds_read_b64_tr_b16 v[68:69], v34 offset:24576
    ds_read_b64_tr_b16 v[70:71], v34 offset:25600
    s_waitcnt lgkmcnt(9)
    v_mfma_f32_32x32x16_bf16 v[144:159], v[76:79], v[104:107], v[144:159]
    v_lshlrev_b32 v16, 16, v105
    v_and_b32 v17, 0xffff0000, v105
    v_add_f32 v12, v12, v16
    v_add_f32 v13, v13, v17
    v_fma_f32 v14, v16, v16, v14
    v_fma_f32 v15, v17, v17, v15
    ds_read_b64_tr_b16 v[72:73], v35 offset:8192
    ds_read_b64_tr_b16 v[74:75], v35 offset:9216
    s_waitcnt lgkmcnt(9)
    v_mfma_f32_32x32x16_bf16 v[160:175], v[80:83], v[104:107], v[160:175]
    s_add_u32 s36, s34, 1404928
    s_add_u32 s37, s35, 2048
    s_mov_b32 m0, s37
    s_mov_b64 exec, s[32:33]
    buffer_load_dwordx4 v3, s[8:11], s36 offen lds
    s_mov_b64 exec, -1
    ds_read_b64_tr_b16 v[76:77], v35 offset:24576
    ds_read_b64_tr_b16 v[78:79], v35 offset:25600
    s_waitcnt lgkmcnt(9)
    v_mfma_f32_32x32x16_bf16 v[176:191], v[84:87], v[104:107], v[176:191]
    s_add_u32 s36, s34, 1419264
    s_add_u32 s37, s35, 3072
    s_mov_b32 m0, s37
    s_mov_b64 exec, s[32:33]
    buffer_load_dwordx4 v3, s[8:11], s36 offen lds
    s_mov_b64 exec, -1
    ds_read_b128 v[100:103], v39
    ds_read_b64_tr_b16 v[80:81], v34 offset:12288
    ds_read_b64_tr_b16 v[82:83], v34 offset:13312
    s_waitcnt lgkmcnt(9)
    v_mfma_f32_32x32x16_bf16 v[128:143], v[64:67], v[96:99], v[128:143]
    v_lshlrev_b32 v16, 16, v96
    v_and_b32 v17, 0xffff0000, v96
    v_add_f32 v12, v12, v16
    v_add_f32 v13, v13, v17
    v_fma_f32 v14, v16, v16, v14
    v_fma_f32 v15, v17, v17, v15
    ds_read_b64_tr_b16 v[84:85], v34 offset:28672
    ds_read_b64_tr_b16 v[86:87], v34 offset:29696
    s_waitcnt lgkmcnt(9)
    v_mfma_f32_32x32x16_bf16 v[144:159], v[68:71], v[96:99], v[144:159]
    v_lshlrev_b32 v16, 16, v97
    v_and_b32 v17, 0xffff0000, v97
    v_add_f32 v12, v12, v16
    v_add_f32 v13, v13, v17
    v_fma_f32 v14, v16, v16, v14
    v_fma_f32 v15, v17, v17, v15
    ds_read_b64_tr_b16 v[64:65], v35 offset:12288
    ds_read_b64_tr_b16 v[66:67], v35 offset:13312
    s_waitcnt lgkmcnt(9)
    v_mfma_f32_32x32x16_bf16 v[160:175], v[72:75], v[96:99], v[160:175]
    ds_read_b64_tr_b16 v[68:69], v35 offset:28672
    ds_read_b64_tr_b16 v[70:71], v35 offset:29696
    s_waitcnt lgkmcnt(9)
    v_mfma_f32_32x32x16_bf16 v[176:191], v[76:79], v[96:99], v[176:191]
    s_waitcnt vmcnt(6)
    s_waitcnt lgkmcnt(0)
    s_barrier
    ds_read_b128 v[104:107], v42
    ds_read_b64_tr_b16 v[72:73], v40 offset:0
    ds_read_b64_tr_b16 v[74:75], v40 offset:1024
    v_mfma_f32_32x32x16_bf16 v[128:143], v[80:83], v[100:103], v[128:143]
    v_lshlrev_b32 v16, 16, v100
    v_and_b32 v17, 0xffff0000, v100
    v_add_f32 v12, v12, v16
    v_add_f32 v13, v13, v17
    v_fma_f32 v14, v16, v16, v14
    v_fma_f32 v15, v17, v17, v15
    ds_read_b64_tr_b16 v[76:77], v40 offset:16384
    ds_read_b64_tr_b16 v[78:79], v40 offset:17408
    v_mfma_f32_32x32x16_bf16 v[144:159], v[84:87], v[100:103], v[144:159]
    v_lshlrev_b32 v16, 16, v101
    v_and_b32 v17, 0xffff0000, v101
    v_add_f32 v12, v12, v16
    v_add_f32 v13, v13, v17
    v_fma_f32 v14, v16, v16, v14
    v_fma_f32 v15, v17, v17, v15
    ds_read_b64_tr_b16 v[80:81], v41 offset:0
    ds_read_b64_tr_b16 v[82:83], v41 offset:1024
    v_mfma_f32_32x32x16_bf16 v[160:175], v[64:67], v[100:103], v[160:175]
    s_add_u32 s37, s38, 49152
    s_mov_b32 m0, s37
    s_movk_i32 s36, 896
    buffer_load_dwordx4 v2, s[4:7], s36 offen lds
    ds_read_b64_tr_b16 v[84:85], v41 offset:16384
    ds_read_b64_tr_b16 v[86:87], v41 offset:17408
    v_mfma_f32_32x32x16_bf16 v[176:191], v[68:71], v[100:103], v[176:191]
    s_add_u32 s37, s38, 50176
    s_mov_b32 m0, s37
    s_movk_i32 s36, 896
    buffer_load_dwordx4 v10, s[4:7], s36 offen lds
    ds_read_b128 v[96:99], v43
    ds_read_b64_tr_b16 v[64:65], v40 offset:4096
    ds_read_b64_tr_b16 v[66:67], v40 offset:5120
    s_waitcnt lgkmcnt(9)
    v_mfma_f32_32x32x16_bf16 v[128:143], v[72:75], v[104:107], v[128:143]
    v_lshlrev_b32 v16, 16, v104
    v_and_b32 v17, 0xffff0000, v104
    v_add_f32 v12, v12, v16
    v_add_f32 v13, v13, v17
    v_fma_f32 v14, v16, v16, v14
    v_fma_f32 v15, v17, v17, v15
    ds_read_b64_tr_b16 v[68:69], v40 offset:20480
    ds_read_b64_tr_b16 v[70:71], v40 offset:21504
    s_waitcnt lgkmcnt(9)
    v_mfma_f32_32x32x16_bf16 v[144:159], v[76:79], v[104:107], v[144:159]
    v_lshlrev_b32 v16, 16, v105
    v_and_b32 v17, 0xffff0000, v105
    v_add_f32 v12, v12, v16
    v_add_f32 v13, v13, v17
    v_fma_f32 v14, v16, v16, v14
    v_fma_f32 v15, v17, v17, v15
    ds_read_b64_tr_b16 v[72:73], v41 offset:4096
    ds_read_b64_tr_b16 v[74:75], v41 offset:5120
    s_waitcnt lgkmcnt(9)
    v_mfma_f32_32x32x16_bf16 v[160:175], v[80:83], v[104:107], v[160:175]
    s_add_u32 s36, s34, 1605632
    s_add_u32 s37, s35, 49152
    s_mov_b32 m0, s37
    s_mov_b64 exec, s[32:33]
    buffer_load_dwordx4 v3, s[8:11], s36 offen lds
    s_mov_b64 exec, -1
    ds_read_b64_tr_b16 v[76:77], v41 offset:20480
    ds_read_b64_tr_b16 v[78:79], v41 offset:21504
    s_waitcnt lgkmcnt(9)
    v_mfma_f32_32x32x16_bf16 v[176:191], v[84:87], v[104:107], v[176:191]
    s_add_u32 s36, s34, 1619968
    s_add_u32 s37, s35, 50176
    s_mov_b32 m0, s37
    s_mov_b64 exec, s[32:33]
    buffer_load_dwordx4 v3, s[8:11], s36 offen lds
    s_mov_b64 exec, -1
    ds_read_b128 v[100:103], v44
    ds_read_b64_tr_b16 v[80:81], v40 offset:8192
    ds_read_b64_tr_b16 v[82:83], v40 offset:9216
    s_waitcnt lgkmcnt(9)
    v_mfma_f32_32x32x16_bf16 v[128:143], v[64:67], v[96:99], v[128:143]
    v_lshlrev_b32 v16, 16, v96
    v_and_b32 v17, 0xffff0000, v96
    v_add_f32 v12, v12, v16
    v_add_f32 v13, v13, v17
    v_fma_f32 v14, v16, v16, v14
    v_fma_f32 v15, v17, v17, v15
    ds_read_b64_tr_b16 v[84:85], v40 offset:24576
    ds_read_b64_tr_b16 v[86:87], v40 offset:25600
    s_waitcnt lgkmcnt(9)
    v_mfma_f32_32x32x16_bf16 v[144:159], v[68:71], v[96:99], v[144:159]
    v_lshlrev_b32 v16, 16, v97
    v_and_b32 v17, 0xffff0000, v97
    v_add_f32 v12, v12, v16
    v_add_f32 v13, v13, v17
    v_fma_f32 v14, v16, v16, v14
    v_fma_f32 v15, v17, v17, v15
    ds_read_b64_tr_b16 v[64:65], v41 offset:8192
    ds_read_b64_tr_b16 v[66:67], v41 offset:9216
    s_waitcnt lgkmcnt(9)
    v_mfma_f32_32x32x16_bf16 v[160:175], v[72:75], v[96:99], v[160:175]
    s_add_u32 s36, s34, 1634304
    s_add_u32 s37, s35, 51200
    s_mov_b32 m0, s37
    s_mov_b64 exec, s[32:33]
    buffer_load_dwordx4 v3, s[8:11], s36 offen lds
    s_mov_b64 exec, -1
    ds_read_b64_tr_b16 v[68:69], v41 offset:24576
    ds_read_b64_tr_b16 v[70:71], v41 offset:25600
    s_waitcnt lgkmcnt(9)
    v_mfma_f32_32x32x16_bf16 v[176:191], v[76:79], v[96:99], v[176:191]
    s_add_u32 s36, s34, 1648640
    s_add_u32 s37, s35, 52224
    s_mov_b32 m0, s37
    s_mov_b64 exec, s[32:33]
    buffer_load_dwordx4 v3, s[8:11], s36 offen lds
    s_mov_b64 exec, -1
    ds_read_b128 v[104:107], v45
    ds_read_b64_tr_b16 v[72:73], v40 offset:12288
    ds_read_b64_tr_b16 v[74:75], v40 offset:13312
    s_waitcnt lgkmcnt(9)
    v_mfma_f32_32x32x16_bf16 v[128:143], v[80:83], v[100:103], v[128:143]
    v_lshlrev_b32 v16, 16, v100
    v_and_b32 v17, 0xffff0000, v100
    v_add_f32 v12, v12, v16
    v_add_f32 v13, v13, v17
    v_fma_f32 v14, v16, v16, v14
    v_fma_f32 v15, v17, v17, v15
    ds_read_b64_tr_b16 v[76:77], v40 offset:28672
    ds_read_b64_tr_b16 v[78:79], v40 offset:29696
    s_waitcnt lgkmcnt(9)
    v_mfma_f32_32x32x16_bf16 v[144:159], v[84:87], v[100:103], v[144:159]
    v_lshlrev_b32 v16, 16, v101
    v_and_b32 v17, 0xffff0000, v101
    v_add_f32 v12, v12, v16
    v_add_f32 v13, v13, v17
    v_fma_f32 v14, v16, v16, v14
    v_fma_f32 v15, v17, v17, v15
    ds_read_b64_tr_b16 v[80:81], v41 offset:12288
    ds_read_b64_tr_b16 v[82:83], v41 offset:13312
    s_waitcnt lgkmcnt(9)
    v_mfma_f32_32x32x16_bf16 v[160:175], v[64:67], v[100:103], v[160:175]
    ds_read_b64_tr_b16 v[84:85], v41 offset:28672
    ds_read_b64_tr_b16 v[86:87], v41 offset:29696
    s_waitcnt lgkmcnt(9)
    v_mfma_f32_32x32x16_bf16 v[176:191], v[68:71], v[100:103], v[176:191]
    s_waitcnt vmcnt(6)
    s_waitcnt lgkmcnt(0)
    s_barrier
    ds_read_b128 v[96:99], v30
    ds_read_b64_tr_b16 v[64:65], v28 offset:0
    ds_read_b64_tr_b16 v[66:67], v28 offset:1024
    v_mfma_f32_32x32x16_bf16 v[128:143], v[72:75], v[104:107], v[128:143]
    v_lshlrev_b32 v16, 16, v104
    v_and_b32 v17, 0xffff0000, v104
    v_add_f32 v12, v12, v16
    v_add_f32 v13, v13, v17
    v_fma_f32 v14, v16, v16, v14
    v_fma_f32 v15, v17, v17, v15
    ds_read_b64_tr_b16 v[68:69], v28 offset:16384
    ds_read_b64_tr_b16 v[70:71], v28 offset:17408
    v_mfma_f32_32x32x16_bf16 v[144:159], v[76:79], v[104:107], v[144:159]
    v_lshlrev_b32 v16, 16, v105
    v_and_b32 v17, 0xffff0000, v105
    v_add_f32 v12, v12, v16
    v_add_f32 v13, v13, v17
    v_fma_f32 v14, v16, v16, v14
    v_fma_f32 v15, v17, v17, v15
    ds_read_b64_tr_b16 v[72:73], v29 offset:0
    ds_read_b64_tr_b16 v[74:75], v29 offset:1024
    v_mfma_f32_32x32x16_bf16 v[160:175], v[80:83], v[104:107], v[160:175]
    ds_read_b64_tr_b16 v[76:77], v29 offset:16384
    ds_read_b64_tr_b16 v[78:79], v29 offset:17408
    v_mfma_f32_32x32x16_bf16 v[176:191], v[84:87], v[104:107], v[176:191]
    ds_read_b128 v[100:103], v31
    ds_read_b64_tr_b16 v[80:81], v28 offset:4096
    ds_read_b64_tr_b16 v[82:83], v28 offset:5120
    s_waitcnt lgkmcnt(9)
    v_mfma_f32_32x32x16_bf16 v[128:143], v[64:67], v[96:99], v[128:143]
    v_lshlrev_b32 v16, 16, v96
    v_and_b32 v17, 0xffff0000, v96
    v_add_f32 v12, v12, v16
    v_add_f32 v13, v13, v17
    v_fma_f32 v14, v16, v16, v14
    v_fma_f32 v15, v17, v17, v15
    ds_read_b64_tr_b16 v[84:85], v28 offset:20480
    ds_read_b64_tr_b16 v[86:87], v28 offset:21504
    s_waitcnt lgkmcnt(9)
    v_mfma_f32_32x32x16_bf16 v[144:159], v[68:71], v[96:99], v[144:159]
    v_lshlrev_b32 v16, 16, v97
    v_and_b32 v17, 0xffff0000, v97
    v_add_f32 v12, v12, v16
    v_add_f32 v13, v13, v17
    v_fma_f32 v14, v16, v16, v14
    v_fma_f32 v15, v17, v17, v15
    ds_read_b64_tr_b16 v[64:65], v29 offset:4096
    ds_read_b64_tr_b16 v[66:67], v29 offset:5120
    s_waitcnt lgkmcnt(9)
    v_mfma_f32_32x32x16_bf16 v[160:175], v[72:75], v[96:99], v[160:175]
    ds_read_b64_tr_b16 v[68:69], v29 offset:20480
    ds_read_b64_tr_b16 v[70:71], v29 offset:21504
    s_waitcnt lgkmcnt(9)
    v_mfma_f32_32x32x16_bf16 v[176:191], v[76:79], v[96:99], v[176:191]
    ds_read_b128 v[104:107], v32
    ds_read_b64_tr_b16 v[72:73], v28 offset:8192
    ds_read_b64_tr_b16 v[74:75], v28 offset:9216
    s_waitcnt lgkmcnt(9)
    v_mfma_f32_32x32x16_bf16 v[128:143], v[80:83], v[100:103], v[128:143]
    v_lshlrev_b32 v16, 16, v100
    v_and_b32 v17, 0xffff0000, v100
    v_add_f32 v12, v12, v16
    v_add_f32 v13, v13, v17
    v_fma_f32 v14, v16, v16, v14
    v_fma_f32 v15, v17, v17, v15
    ds_read_b64_tr_b16 v[76:77], v28 offset:24576
    ds_read_b64_tr_b16 v[78:79], v28 offset:25600
    s_waitcnt lgkmcnt(9)
    v_mfma_f32_32x32x16_bf16 v[144:159], v[84:87], v[100:103], v[144:159]
    v_lshlrev_b32 v16, 16, v101
    v_and_b32 v17, 0xffff0000, v101
    v_add_f32 v12, v12, v16
    v_add_f32 v13, v13, v17
    v_fma_f32 v14, v16, v16, v14
    v_fma_f32 v15, v17, v17, v15
    ds_read_b64_tr_b16 v[80:81], v29 offset:8192
    ds_read_b64_tr_b16 v[82:83], v29 offset:9216
    s_waitcnt lgkmcnt(9)
    v_mfma_f32_32x32x16_bf16 v[160:175], v[64:67], v[100:103], v[160:175]
    ds_read_b64_tr_b16 v[84:85], v29 offset:24576
    ds_read_b64_tr_b16 v[86:87], v29 offset:25600
    s_waitcnt lgkmcnt(9)
    v_mfma_f32_32x32x16_bf16 v[176:191], v[68:71], v[100:103], v[176:191]
    ds_read_b128 v[96:99], v33
    ds_read_b64_tr_b16 v[64:65], v28 offset:12288
    ds_read_b64_tr_b16 v[66:67], v28 offset:13312
    s_waitcnt lgkmcnt(9)
    v_mfma_f32_32x32x16_bf16 v[128:143], v[72:75], v[104:107], v[128:143]
    v_lshlrev_b32 v16, 16, v104
    v_and_b32 v17, 0xffff0000, v104
    v_add_f32 v12, v12, v16
    v_add_f32 v13, v13, v17
    v_fma_f32 v14, v16, v16, v14
    v_fma_f32 v15, v17, v17, v15
    ds_read_b64_tr_b16 v[68:69], v28 offset:28672
    ds_read_b64_tr_b16 v[70:71], v28 offset:29696
    s_waitcnt lgkmcnt(9)
    v_mfma_f32_32x32x16_bf16 v[144:159], v[76:79], v[104:107], v[144:159]
    v_lshlrev_b32 v16, 16, v105
    v_and_b32 v17, 0xffff0000, v105
    v_add_f32 v12, v12, v16
    v_add_f32 v13, v13, v17
    v_fma_f32 v14, v16, v16, v14
    v_fma_f32 v15, v17, v17, v15
    ds_read_b64_tr_b16 v[72:73], v29 offset:12288
    ds_read_b64_tr_b16 v[74:75], v29 offset:13312
    s_waitcnt lgkmcnt(9)
    v_mfma_f32_32x32x16_bf16 v[160:175], v[80:83], v[104:107], v[160:175]
    ds_read_b64_tr_b16 v[76:77], v29 offset:28672
    ds_read_b64_tr_b16 v[78:79], v29 offset:29696
    s_waitcnt lgkmcnt(9)
    v_mfma_f32_32x32x16_bf16 v[176:191], v[84:87], v[104:107], v[176:191]
    s_waitcnt vmcnt(0)
    s_waitcnt lgkmcnt(0)
    s_barrier
    ds_read_b128 v[100:103], v36
    ds_read_b64_tr_b16 v[80:81], v34 offset:0
    ds_read_b64_tr_b16 v[82:83], v34 offset:1024
    v_mfma_f32_32x32x16_bf16 v[128:143], v[64:67], v[96:99], v[128:143]
    v_lshlrev_b32 v16, 16, v96
    v_and_b32 v17, 0xffff0000, v96
    v_add_f32 v12, v12, v16
    v_add_f32 v13, v13, v17
    v_fma_f32 v14, v16, v16, v14
    v_fma_f32 v15, v17, v17, v15
    ds_read_b64_tr_b16 v[84:85], v34 offset:16384
    ds_read_b64_tr_b16 v[86:87], v34 offset:17408
    v_mfma_f32_32x32x16_bf16 v[144:159], v[68:71], v[96:99], v[144:159]
    v_lshlrev_b32 v16, 16, v97
    v_and_b32 v17, 0xffff0000, v97
    v_add_f32 v12, v12, v16
    v_add_f32 v13, v13, v17
    v_fma_f32 v14, v16, v16, v14
    v_fma_f32 v15, v17, v17, v15
    ds_read_b64_tr_b16 v[64:65], v35 offset:0
    ds_read_b64_tr_b16 v[66:67], v35 offset:1024
    v_mfma_f32_32x32x16_bf16 v[160:175], v[72:75], v[96:99], v[160:175]
    ds_read_b64_tr_b16 v[68:69], v35 offset:16384
    ds_read_b64_tr_b16 v[70:71], v35 offset:17408
    v_mfma_f32_32x32x16_bf16 v[176:191], v[76:79], v[96:99], v[176:191]
    ds_read_b128 v[104:107], v37
    ds_read_b64_tr_b16 v[72:73], v34 offset:4096
    ds_read_b64_tr_b16 v[74:75], v34 offset:5120
    s_waitcnt lgkmcnt(9)
    v_mfma_f32_32x32x16_bf16 v[128:143], v[80:83], v[100:103], v[128:143]
    v_lshlrev_b32 v16, 16, v100
    v_and_b32 v17, 0xffff0000, v100
    v_add_f32 v12, v12, v16
    v_add_f32 v13, v13, v17
    v_fma_f32 v14, v16, v16, v14
    v_fma_f32 v15, v17, v17, v15
    ds_read_b64_tr_b16 v[76:77], v34 offset:20480
    ds_read_b64_tr_b16 v[78:79], v34 offset:21504
    s_waitcnt lgkmcnt(9)
    v_mfma_f32_32x32x16_bf16 v[144:159], v[84:87], v[100:103], v[144:159]
    v_lshlrev_b32 v16, 16, v101
    v_and_b32 v17, 0xffff0000, v101
    v_add_f32 v12, v12, v16
    v_add_f32 v13, v13, v17
    v_fma_f32 v14, v16, v16, v14
    v_fma_f32 v15, v17, v17, v15
    ds_read_b64_tr_b16 v[80:81], v35 offset:4096
    ds_read_b64_tr_b16 v[82:83], v35 offset:5120
    s_waitcnt lgkmcnt(9)
    v_mfma_f32_32x32x16_bf16 v[160:175], v[64:67], v[100:103], v[160:175]
    ds_read_b64_tr_b16 v[84:85], v35 offset:20480
    ds_read_b64_tr_b16 v[86:87], v35 offset:21504
    s_waitcnt lgkmcnt(9)
    v_mfma_f32_32x32x16_bf16 v[176:191], v[68:71], v[100:103], v[176:191]
    ds_read_b128 v[96:99], v38
    ds_read_b64_tr_b16 v[64:65], v34 offset:8192
    ds_read_b64_tr_b16 v[66:67], v34 offset:9216
    s_waitcnt lgkmcnt(9)
    v_mfma_f32_32x32x16_bf16 v[128:143], v[72:75], v[104:107], v[128:143]
    v_lshlrev_b32 v16, 16, v104
    v_and_b32 v17, 0xffff0000, v104
    v_add_f32 v12, v12, v16
    v_add_f32 v13, v13, v17
    v_fma_f32 v14, v16, v16, v14
    v_fma_f32 v15, v17, v17, v15
    ds_read_b64_tr_b16 v[68:69], v34 offset:24576
    ds_read_b64_tr_b16 v[70:71], v34 offset:25600
    s_waitcnt lgkmcnt(9)
    v_mfma_f32_32x32x16_bf16 v[144:159], v[76:79], v[104:107], v[144:159]
    v_lshlrev_b32 v16, 16, v105
    v_and_b32 v17, 0xffff0000, v105
    v_add_f32 v12, v12, v16
    v_add_f32 v13, v13, v17
    v_fma_f32 v14, v16, v16, v14
    v_fma_f32 v15, v17, v17, v15
    ds_read_b64_tr_b16 v[72:73], v35 offset:8192
    ds_read_b64_tr_b16 v[74:75], v35 offset:9216
    s_waitcnt lgkmcnt(9)
    v_mfma_f32_32x32x16_bf16 v[160:175], v[80:83], v[104:107], v[160:175]
    ds_read_b64_tr_b16 v[76:77], v35 offset:24576
    ds_read_b64_tr_b16 v[78:79], v35 offset:25600
    s_waitcnt lgkmcnt(9)
    v_mfma_f32_32x32x16_bf16 v[176:191], v[84:87], v[104:107], v[176:191]
    ds_read_b128 v[100:103], v39
    ds_read_b64_tr_b16 v[80:81], v34 offset:12288
    ds_read_b64_tr_b16 v[82:83], v34 offset:13312
    s_waitcnt lgkmcnt(9)
    v_mfma_f32_32x32x16_bf16 v[128:143], v[64:67], v[96:99], v[128:143]
    v_lshlrev_b32 v16, 16, v96
    v_and_b32 v17, 0xffff0000, v96
    v_add_f32 v12, v12, v16
    v_add_f32 v13, v13, v17
    v_fma_f32 v14, v16, v16, v14
    v_fma_f32 v15, v17, v17, v15
    ds_read_b64_tr_b16 v[84:85], v34 offset:28672
    ds_read_b64_tr_b16 v[86:87], v34 offset:29696
    s_waitcnt lgkmcnt(9)
    v_mfma_f32_32x32x16_bf16 v[144:159], v[68:71], v[96:99], v[144:159]
    v_lshlrev_b32 v16, 16, v97
    v_and_b32 v17, 0xffff0000, v97
    v_add_f32 v12, v12, v16
    v_add_f32 v13, v13, v17
    v_fma_f32 v14, v16, v16, v14
    v_fma_f32 v15, v17, v17, v15
    ds_read_b64_tr_b16 v[64:65], v35 offset:12288
    ds_read_b64_tr_b16 v[66:67], v35 offset:13312
    s_waitcnt lgkmcnt(9)
    v_mfma_f32_32x32x16_bf16 v[160:175], v[72:75], v[96:99], v[160:175]
    ds_read_b64_tr_b16 v[68:69], v35 offset:28672
    ds_read_b64_tr_b16 v[70:71], v35 offset:29696
    s_waitcnt lgkmcnt(9)
    v_mfma_f32_32x32x16_bf16 v[176:191], v[76:79], v[96:99], v[176:191]
    s_waitcnt lgkmcnt(6)
    v_mfma_f32_32x32x16_bf16 v[128:143], v[80:83], v[100:103], v[128:143]
    v_lshlrev_b32 v16, 16, v100
    v_and_b32 v17, 0xffff0000, v100
    v_add_f32 v12, v12, v16
    v_add_f32 v13, v13, v17
    v_fma_f32 v14, v16, v16, v14
    v_fma_f32 v15, v17, v17, v15
    s_waitcnt lgkmcnt(4)
    v_mfma_f32_32x32x16_bf16 v[144:159], v[84:87], v[100:103], v[144:159]
    v_lshlrev_b32 v16, 16, v101
    v_and_b32 v17, 0xffff0000, v101
    v_add_f32 v12, v12, v16
    v_add_f32 v13, v13, v17
    v_fma_f32 v14, v16, v16, v14
    v_fma_f32 v15, v17, v17, v15
    s_waitcnt lgkmcnt(2)
    v_mfma_f32_32x32x16_bf16 v[160:175], v[64:67], v[100:103], v[160:175]
    s_waitcnt lgkmcnt(0)
    v_mfma_f32_32x32x16_bf16 v[176:191], v[68:71], v[100:103], v[176:191]
    v_add_f32 v12, v12, v13
    v_add_f32 v13, v14, v15
    s_lshl_b32 s30, s39, 10
    v_lshlrev_b32 v16, 3, v1
    v_add_u32 v16, s30, v16
    v_add_u32 v17, 148480, v16
    v_add_u32 v16, 148992, v16
    ds_write_b64 v17, v[12:13]
    s_waitcnt lgkmcnt(0)
    s_barrier
    ds_read_b64 v[14:15], v16
    s_waitcnt lgkmcnt(0)
    v_add_f32 v12, v12, v14
    v_add_f32 v13, v13, v15
    v_mov_b32 v16, v12
    s_nop 1
    v_permlane32_swap_b32 v12, v16
    v_add_f32 v12, v12, v16
    v_mov_b32 v16, v13
    s_nop 1
    v_permlane32_swap_b32 v13, v16
    v_add_f32 v13, v13, v16
    v_mul_f32 v14, 0x3b000000, v12
    v_mul_f32 v16, 0x3b000000, v13
    v_fma_f32 v16, -v14, v14, v16
    v_max_f32 v16, 0, v16
    v_cvt_pk_bf16_f32 v17, v14, v14
    v_lshlrev_b32 v14, 16, v17
    v_cvt_pk_bf16_f32 v17, v16, v16
    v_lshlrev_b32 v16, 16, v17
    v_add_f32 v16, 0x3727c5ac, v16
    v_cvt_pk_bf16_f32 v17, v16, v16
    v_lshlrev_b32 v16, 16, v17
    v_sqrt_f32 v16, v16
    s_nop 0
    v_cvt_pk_bf16_f32 v17, v16, v16
    v_lshlrev_b32 v16, 16, v17
    v_rcp_f32 v15, v16
    v_lshrrev_b32 v16, 5, v1
    v_lshlrev_b32 v16, 4, v16
    v_add_u32 v16, 147456, v16
    ds_read_b128 v[60:63], v16 offset:0
    ds_read_b128 v[76:79], v16 offset:128
    ds_read_b128 v[64:67], v16 offset:32
    ds_read_b128 v[80:83], v16 offset:160
    ds_read_b128 v[68:71], v16 offset:64
    ds_read_b128 v[84:87], v16 offset:192
    ds_read_b128 v[72:75], v16 offset:96
    ds_read_b128 v[88:91], v16 offset:224
    s_waitcnt lgkmcnt(0)
    v_fma_f32 v28, -v14, v60, v128
    v_fma_f32 v44, -v14, v76, v144
    v_fma_f32 v29, -v14, v61, v129
    v_fma_f32 v45, -v14, v77, v145
    v_fma_f32 v30, -v14, v62, v130
    v_fma_f32 v46, -v14, v78, v146
    v_fma_f32 v31, -v14, v63, v131
    v_fma_f32 v47, -v14, v79, v147
    v_fma_f32 v32, -v14, v64, v132
    v_fma_f32 v48, -v14, v80, v148
    v_fma_f32 v33, -v14, v65, v133
    v_fma_f32 v49, -v14, v81, v149
    v_fma_f32 v34, -v14, v66, v134
    v_fma_f32 v50, -v14, v82, v150
    v_fma_f32 v35, -v14, v67, v135
    v_fma_f32 v51, -v14, v83, v151
    v_fma_f32 v36, -v14, v68, v136
    v_fma_f32 v52, -v14, v84, v152
    v_fma_f32 v37, -v14, v69, v137
    v_fma_f32 v53, -v14, v85, v153
    v_fma_f32 v38, -v14, v70, v138
    v_fma_f32 v54, -v14, v86, v154
    v_fma_f32 v39, -v14, v71, v139
    v_fma_f32 v55, -v14, v87, v155
    v_fma_f32 v40, -v14, v72, v140
    v_fma_f32 v56, -v14, v88, v156
    v_fma_f32 v41, -v14, v73, v141
    v_fma_f32 v57, -v14, v89, v157
    v_fma_f32 v42, -v14, v74, v142
    v_fma_f32 v58, -v14, v90, v158
    v_fma_f32 v43, -v14, v75, v143
    v_fma_f32 v59, -v14, v91, v159
    v_mul_f32 v28, v15, v28
    v_mul_f32 v44, v15, v44
    v_mul_f32 v29, v15, v29
    v_mul_f32 v45, v15, v45
    v_mul_f32 v30, v15, v30
    v_mul_f32 v46, v15, v46
    v_mul_f32 v31, v15, v31
    v_mul_f32 v47, v15, v47
    v_mul_f32 v32, v15, v32
    v_mul_f32 v48, v15, v48
    v_mul_f32 v33, v15, v33
    v_mul_f32 v49, v15, v49
    v_mul_f32 v34, v15, v34
    v_mul_f32 v50, v15, v50
    v_mul_f32 v35, v15, v35
    v_mul_f32 v51, v15, v51
    v_mul_f32 v36, v15, v36
    v_mul_f32 v52, v15, v52
    v_mul_f32 v37, v15, v37
    v_mul_f32 v53, v15, v53
    v_mul_f32 v38, v15, v38
    v_mul_f32 v54, v15, v54
    v_mul_f32 v39, v15, v39
    v_mul_f32 v55, v15, v55
    v_mul_f32 v40, v15, v40
    v_mul_f32 v56, v15, v56
    v_mul_f32 v41, v15, v41
    v_mul_f32 v57, v15, v57
    v_mul_f32 v42, v15, v42
    v_mul_f32 v58, v15, v58
    v_mul_f32 v43, v15, v43
    v_mul_f32 v59, v15, v59
    v_cvt_pk_bf16_f32 v108, v28, v29
    v_cvt_pk_bf16_f32 v116, v44, v45
    v_cvt_pk_bf16_f32 v109, v30, v31
    v_cvt_pk_bf16_f32 v117, v46, v47
    v_cvt_pk_bf16_f32 v110, v32, v33
    v_cvt_pk_bf16_f32 v118, v48, v49
    v_cvt_pk_bf16_f32 v111, v34, v35
    v_cvt_pk_bf16_f32 v119, v50, v51
    v_cvt_pk_bf16_f32 v112, v36, v37
    v_cvt_pk_bf16_f32 v120, v52, v53
    v_cvt_pk_bf16_f32 v113, v38, v39
    v_cvt_pk_bf16_f32 v121, v54, v55
    v_cvt_pk_bf16_f32 v114, v40, v41
    v_cvt_pk_bf16_f32 v122, v56, v57
    v_cvt_pk_bf16_f32 v115, v42, v43
    v_cvt_pk_bf16_f32 v123, v58, v59
    v_lshlrev_b32 v28, 16, v108
    v_and_b32 v29, 0xffff0000, v108
    v_lshlrev_b32 v44, 16, v116
    v_and_b32 v45, 0xffff0000, v116
    v_lshlrev_b32 v30, 16, v109
    v_and_b32 v31, 0xffff0000, v109
    v_lshlrev_b32 v46, 16, v117
    v_and_b32 v47, 0xffff0000, v117
    v_lshlrev_b32 v32, 16, v110
    v_and_b32 v33, 0xffff0000, v110
    v_lshlrev_b32 v48, 16, v118
    v_and_b32 v49, 0xffff0000, v118
    v_lshlrev_b32 v34, 16, v111
    v_and_b32 v35, 0xffff0000, v111
    v_lshlrev_b32 v50, 16, v119
    v_and_b32 v51, 0xffff0000, v119
    v_lshlrev_b32 v36, 16, v112
    v_and_b32 v37, 0xffff0000, v112
    v_lshlrev_b32 v52, 16, v120
    v_and_b32 v53, 0xffff0000, v120
    v_lshlrev_b32 v38, 16, v113
    v_and_b32 v39, 0xffff0000, v113
    v_lshlrev_b32 v54, 16, v121
    v_and_b32 v55, 0xffff0000, v121
    v_lshlrev_b32 v40, 16, v114
    v_and_b32 v41, 0xffff0000, v114
    v_lshlrev_b32 v56, 16, v122
    v_and_b32 v57, 0xffff0000, v122
    v_lshlrev_b32 v42, 16, v115
    v_and_b32 v43, 0xffff0000, v115
    v_lshlrev_b32 v58, 16, v123
    v_and_b32 v59, 0xffff0000, v123
    v_mul_f32 v92, 0xbfb8aa3b, v28
    v_mul_f32 v93, 0xbfb8aa3b, v29
    v_mul_f32 v94, 0xbfb8aa3b, v30
    v_mul_f32 v95, 0xbfb8aa3b, v31
    v_mul_f32 v96, 0xbfb8aa3b, v32
    v_mul_f32 v97, 0xbfb8aa3b, v33
    v_mul_f32 v98, 0xbfb8aa3b, v34
    v_mul_f32 v99, 0xbfb8aa3b, v35
    v_mul_f32 v100, 0xbfb8aa3b, v36
    v_mul_f32 v101, 0xbfb8aa3b, v37
    v_mul_f32 v102, 0xbfb8aa3b, v38
    v_mul_f32 v103, 0xbfb8aa3b, v39
    v_mul_f32 v104, 0xbfb8aa3b, v40
    v_mul_f32 v105, 0xbfb8aa3b, v41
    v_mul_f32 v106, 0xbfb8aa3b, v42
    v_mul_f32 v107, 0xbfb8aa3b, v43
    v_exp_f32 v92, v92
    v_exp_f32 v93, v93
    v_exp_f32 v94, v94
    v_exp_f32 v95, v95
    v_exp_f32 v96, v96
    v_exp_f32 v97, v97
    v_exp_f32 v98, v98
    v_exp_f32 v99, v99
    v_exp_f32 v100, v100
    v_exp_f32 v101, v101
    v_exp_f32 v102, v102
    v_exp_f32 v103, v103
    v_exp_f32 v104, v104
    v_exp_f32 v105, v105
    v_exp_f32 v106, v106
    v_exp_f32 v107, v107
    v_add_f32 v92, 1.0, v92
    v_add_f32 v93, 1.0, v93
    v_add_f32 v94, 1.0, v94
    v_add_f32 v95, 1.0, v95
    v_add_f32 v96, 1.0, v96
    v_add_f32 v97, 1.0, v97
    v_add_f32 v98, 1.0, v98
    v_add_f32 v99, 1.0, v99
    v_add_f32 v100, 1.0, v100
    v_add_f32 v101, 1.0, v101
    v_add_f32 v102, 1.0, v102
    v_add_f32 v103, 1.0, v103
    v_add_f32 v104, 1.0, v104
    v_add_f32 v105, 1.0, v105
    v_add_f32 v106, 1.0, v106
    v_add_f32 v107, 1.0, v107
    v_rcp_f32 v92, v92
    v_rcp_f32 v93, v93
    v_rcp_f32 v94, v94
    v_rcp_f32 v95, v95
    v_rcp_f32 v96, v96
    v_rcp_f32 v97, v97
    v_rcp_f32 v98, v98
    v_rcp_f32 v99, v99
    v_rcp_f32 v100, v100
    v_rcp_f32 v101, v101
    v_rcp_f32 v102, v102
    v_rcp_f32 v103, v103
    v_rcp_f32 v104, v104
    v_rcp_f32 v105, v105
    v_rcp_f32 v106, v106
    v_rcp_f32 v107, v107
    v_mul_f32 v28, v28, v92
    v_mul_f32 v29, v29, v93
    v_mul_f32 v30, v30, v94
    v_mul_f32 v31, v31, v95
    v_mul_f32 v32, v32, v96
    v_mul_f32 v33, v33, v97
    v_mul_f32 v34, v34, v98
    v_mul_f32 v35, v35, v99
    v_mul_f32 v36, v36, v100
    v_mul_f32 v37, v37, v101
    v_mul_f32 v38, v38, v102
    v_mul_f32 v39, v39, v103
    v_mul_f32 v40, v40, v104
    v_mul_f32 v41, v41, v105
    v_mul_f32 v42, v42, v106
    v_mul_f32 v43, v43, v107
    v_cvt_pk_bf16_f32 v108, v28, v29
    v_cvt_pk_bf16_f32 v109, v30, v31
    v_cvt_pk_bf16_f32 v110, v32, v33
    v_cvt_pk_bf16_f32 v111, v34, v35
    v_cvt_pk_bf16_f32 v112, v36, v37
    v_cvt_pk_bf16_f32 v113, v38, v39
    v_cvt_pk_bf16_f32 v114, v40, v41
    v_cvt_pk_bf16_f32 v115, v42, v43
    v_lshlrev_b32 v28, 16, v108
    v_and_b32 v29, 0xffff0000, v108
    v_lshlrev_b32 v30, 16, v109
    v_and_b32 v31, 0xffff0000, v109
    v_lshlrev_b32 v32, 16, v110
    v_and_b32 v33, 0xffff0000, v110
    v_lshlrev_b32 v34, 16, v111
    v_and_b32 v35, 0xffff0000, v111
    v_lshlrev_b32 v36, 16, v112
    v_and_b32 v37, 0xffff0000, v112
    v_lshlrev_b32 v38, 16, v113
    v_and_b32 v39, 0xffff0000, v113
    v_lshlrev_b32 v40, 16, v114
    v_and_b32 v41, 0xffff0000, v114
    v_lshlrev_b32 v42, 16, v115
    v_and_b32 v43, 0xffff0000, v115
    v_mul_f32 v28, v28, v44
    v_mul_f32 v29, v29, v45
    v_mul_f32 v30, v30, v46
    v_mul_f32 v31, v31, v47
    v_mul_f32 v32, v32, v48
    v_mul_f32 v33, v33, v49
    v_mul_f32 v34, v34, v50
    v_mul_f32 v35, v35, v51
    v_mul_f32 v36, v36, v52
    v_mul_f32 v37, v37, v53
    v_mul_f32 v38, v38, v54
    v_mul_f32 v39, v39, v55
    v_mul_f32 v40, v40, v56
    v_mul_f32 v41, v41, v57
    v_mul_f32 v42, v42, v58
    v_mul_f32 v43, v43, v59
    v_cvt_pk_bf16_f32 v108, v28, v29
    v_cvt_pk_bf16_f32 v109, v30, v31
    v_cvt_pk_bf16_f32 v110, v32, v33
    v_cvt_pk_bf16_f32 v111, v34, v35
    v_cvt_pk_bf16_f32 v112, v36, v37
    v_cvt_pk_bf16_f32 v113, v38, v39
    v_cvt_pk_bf16_f32 v114, v40, v41
    v_cvt_pk_bf16_f32 v115, v42, v43
    buffer_store_dwordx2 v[108:109], v22, s[12:15], 0 offen offset:0
    buffer_store_dwordx2 v[110:111], v22, s[12:15], 0 offen offset:16
    buffer_store_dwordx2 v[112:113], v22, s[12:15], 0 offen offset:32
    buffer_store_dwordx2 v[114:115], v22, s[12:15], 0 offen offset:48
    ds_read_b128 v[60:63], v16 offset:256
    ds_read_b128 v[76:79], v16 offset:384
    ds_read_b128 v[64:67], v16 offset:288
    ds_read_b128 v[80:83], v16 offset:416
    ds_read_b128 v[68:71], v16 offset:320
    ds_read_b128 v[84:87], v16 offset:448
    ds_read_b128 v[72:75], v16 offset:352
    ds_read_b128 v[88:91], v16 offset:480
    s_waitcnt lgkmcnt(0)
    v_fma_f32 v28, -v14, v60, v160
    v_fma_f32 v44, -v14, v76, v176
    v_fma_f32 v29, -v14, v61, v161
    v_fma_f32 v45, -v14, v77, v177
    v_fma_f32 v30, -v14, v62, v162
    v_fma_f32 v46, -v14, v78, v178
    v_fma_f32 v31, -v14, v63, v163
    v_fma_f32 v47, -v14, v79, v179
    v_fma_f32 v32, -v14, v64, v164
    v_fma_f32 v48, -v14, v80, v180
    v_fma_f32 v33, -v14, v65, v165
    v_fma_f32 v49, -v14, v81, v181
    v_fma_f32 v34, -v14, v66, v166
    v_fma_f32 v50, -v14, v82, v182
    v_fma_f32 v35, -v14, v67, v167
    v_fma_f32 v51, -v14, v83, v183
    v_fma_f32 v36, -v14, v68, v168
    v_fma_f32 v52, -v14, v84, v184
    v_fma_f32 v37, -v14, v69, v169
    v_fma_f32 v53, -v14, v85, v185
    v_fma_f32 v38, -v14, v70, v170
    v_fma_f32 v54, -v14, v86, v186
    v_fma_f32 v39, -v14, v71, v171
    v_fma_f32 v55, -v14, v87, v187
    v_fma_f32 v40, -v14, v72, v172
    v_fma_f32 v56, -v14, v88, v188
    v_fma_f32 v41, -v14, v73, v173
    v_fma_f32 v57, -v14, v89, v189
    v_fma_f32 v42, -v14, v74, v174
    v_fma_f32 v58, -v14, v90, v190
    v_fma_f32 v43, -v14, v75, v175
    v_fma_f32 v59, -v14, v91, v191
    v_mul_f32 v28, v15, v28
    v_mul_f32 v44, v15, v44
    v_mul_f32 v29, v15, v29
    v_mul_f32 v45, v15, v45
    v_mul_f32 v30, v15, v30
    v_mul_f32 v46, v15, v46
    v_mul_f32 v31, v15, v31
    v_mul_f32 v47, v15, v47
    v_mul_f32 v32, v15, v32
    v_mul_f32 v48, v15, v48
    v_mul_f32 v33, v15, v33
    v_mul_f32 v49, v15, v49
    v_mul_f32 v34, v15, v34
    v_mul_f32 v50, v15, v50
    v_mul_f32 v35, v15, v35
    v_mul_f32 v51, v15, v51
    v_mul_f32 v36, v15, v36
    v_mul_f32 v52, v15, v52
    v_mul_f32 v37, v15, v37
    v_mul_f32 v53, v15, v53
    v_mul_f32 v38, v15, v38
    v_mul_f32 v54, v15, v54
    v_mul_f32 v39, v15, v39
    v_mul_f32 v55, v15, v55
    v_mul_f32 v40, v15, v40
    v_mul_f32 v56, v15, v56
    v_mul_f32 v41, v15, v41
    v_mul_f32 v57, v15, v57
    v_mul_f32 v42, v15, v42
    v_mul_f32 v58, v15, v58
    v_mul_f32 v43, v15, v43
    v_mul_f32 v59, v15, v59
    v_cvt_pk_bf16_f32 v108, v28, v29
    v_cvt_pk_bf16_f32 v116, v44, v45
    v_cvt_pk_bf16_f32 v109, v30, v31
    v_cvt_pk_bf16_f32 v117, v46, v47
    v_cvt_pk_bf16_f32 v110, v32, v33
    v_cvt_pk_bf16_f32 v118, v48, v49
    v_cvt_pk_bf16_f32 v111, v34, v35
    v_cvt_pk_bf16_f32 v119, v50, v51
    v_cvt_pk_bf16_f32 v112, v36, v37
    v_cvt_pk_bf16_f32 v120, v52, v53
    v_cvt_pk_bf16_f32 v113, v38, v39
    v_cvt_pk_bf16_f32 v121, v54, v55
    v_cvt_pk_bf16_f32 v114, v40, v41
    v_cvt_pk_bf16_f32 v122, v56, v57
    v_cvt_pk_bf16_f32 v115, v42, v43
    v_cvt_pk_bf16_f32 v123, v58, v59
    v_lshlrev_b32 v28, 16, v108
    v_and_b32 v29, 0xffff0000, v108
    v_lshlrev_b32 v44, 16, v116
    v_and_b32 v45, 0xffff0000, v116
    v_lshlrev_b32 v30, 16, v109
    v_and_b32 v31, 0xffff0000, v109
    v_lshlrev_b32 v46, 16, v117
    v_and_b32 v47, 0xffff0000, v117
    v_lshlrev_b32 v32, 16, v110
    v_and_b32 v33, 0xffff0000, v110
    v_lshlrev_b32 v48, 16, v118
    v_and_b32 v49, 0xffff0000, v118
    v_lshlrev_b32 v34, 16, v111
    v_and_b32 v35, 0xffff0000, v111
    v_lshlrev_b32 v50, 16, v119
    v_and_b32 v51, 0xffff0000, v119
    v_lshlrev_b32 v36, 16, v112
    v_and_b32 v37, 0xffff0000, v112
    v_lshlrev_b32 v52, 16, v120
    v_and_b32 v53, 0xffff0000, v120
    v_lshlrev_b32 v38, 16, v113
    v_and_b32 v39, 0xffff0000, v113
    v_lshlrev_b32 v54, 16, v121
    v_and_b32 v55, 0xffff0000, v121
    v_lshlrev_b32 v40, 16, v114
    v_and_b32 v41, 0xffff0000, v114
    v_lshlrev_b32 v56, 16, v122
    v_and_b32 v57, 0xffff0000, v122
    v_lshlrev_b32 v42, 16, v115
    v_and_b32 v43, 0xffff0000, v115
    v_lshlrev_b32 v58, 16, v123
    v_and_b32 v59, 0xffff0000, v123
    v_mul_f32 v92, 0xbfb8aa3b, v28
    v_mul_f32 v93, 0xbfb8aa3b, v29
    v_mul_f32 v94, 0xbfb8aa3b, v30
    v_mul_f32 v95, 0xbfb8aa3b, v31
    v_mul_f32 v96, 0xbfb8aa3b, v32
    v_mul_f32 v97, 0xbfb8aa3b, v33
    v_mul_f32 v98, 0xbfb8aa3b, v34
    v_mul_f32 v99, 0xbfb8aa3b, v35
    v_mul_f32 v100, 0xbfb8aa3b, v36
    v_mul_f32 v101, 0xbfb8aa3b, v37
    v_mul_f32 v102, 0xbfb8aa3b, v38
    v_mul_f32 v103, 0xbfb8aa3b, v39
    v_mul_f32 v104, 0xbfb8aa3b, v40
    v_mul_f32 v105, 0xbfb8aa3b, v41
    v_mul_f32 v106, 0xbfb8aa3b, v42
    v_mul_f32 v107, 0xbfb8aa3b, v43
    v_exp_f32 v92, v92
    v_exp_f32 v93, v93
    v_exp_f32 v94, v94
    v_exp_f32 v95, v95
    v_exp_f32 v96, v96
    v_exp_f32 v97, v97
    v_exp_f32 v98, v98
    v_exp_f32 v99, v99
    v_exp_f32 v100, v100
    v_exp_f32 v101, v101
    v_exp_f32 v102, v102
    v_exp_f32 v103, v103
    v_exp_f32 v104, v104
    v_exp_f32 v105, v105
    v_exp_f32 v106, v106
    v_exp_f32 v107, v107
    v_add_f32 v92, 1.0, v92
    v_add_f32 v93, 1.0, v93
    v_add_f32 v94, 1.0, v94
    v_add_f32 v95, 1.0, v95
    v_add_f32 v96, 1.0, v96
    v_add_f32 v97, 1.0, v97
    v_add_f32 v98, 1.0, v98
    v_add_f32 v99, 1.0, v99
    v_add_f32 v100, 1.0, v100
    v_add_f32 v101, 1.0, v101
    v_add_f32 v102, 1.0, v102
    v_add_f32 v103, 1.0, v103
    v_add_f32 v104, 1.0, v104
    v_add_f32 v105, 1.0, v105
    v_add_f32 v106, 1.0, v106
    v_add_f32 v107, 1.0, v107
    v_rcp_f32 v92, v92
    v_rcp_f32 v93, v93
    v_rcp_f32 v94, v94
    v_rcp_f32 v95, v95
    v_rcp_f32 v96, v96
    v_rcp_f32 v97, v97
    v_rcp_f32 v98, v98
    v_rcp_f32 v99, v99
    v_rcp_f32 v100, v100
    v_rcp_f32 v101, v101
    v_rcp_f32 v102, v102
    v_rcp_f32 v103, v103
    v_rcp_f32 v104, v104
    v_rcp_f32 v105, v105
    v_rcp_f32 v106, v106
    v_rcp_f32 v107, v107
    v_mul_f32 v28, v28, v92
    v_mul_f32 v29, v29, v93
    v_mul_f32 v30, v30, v94
    v_mul_f32 v31, v31, v95
    v_mul_f32 v32, v32, v96
    v_mul_f32 v33, v33, v97
    v_mul_f32 v34, v34, v98
    v_mul_f32 v35, v35, v99
    v_mul_f32 v36, v36, v100
    v_mul_f32 v37, v37, v101
    v_mul_f32 v38, v38, v102
    v_mul_f32 v39, v39, v103
    v_mul_f32 v40, v40, v104
    v_mul_f32 v41, v41, v105
    v_mul_f32 v42, v42, v106
    v_mul_f32 v43, v43, v107
    v_cvt_pk_bf16_f32 v108, v28, v29
    v_cvt_pk_bf16_f32 v109, v30, v31
    v_cvt_pk_bf16_f32 v110, v32, v33
    v_cvt_pk_bf16_f32 v111, v34, v35
    v_cvt_pk_bf16_f32 v112, v36, v37
    v_cvt_pk_bf16_f32 v113, v38, v39
    v_cvt_pk_bf16_f32 v114, v40, v41
    v_cvt_pk_bf16_f32 v115, v42, v43
    v_lshlrev_b32 v28, 16, v108
    v_and_b32 v29, 0xffff0000, v108
    v_lshlrev_b32 v30, 16, v109
    v_and_b32 v31, 0xffff0000, v109
    v_lshlrev_b32 v32, 16, v110
    v_and_b32 v33, 0xffff0000, v110
    v_lshlrev_b32 v34, 16, v111
    v_and_b32 v35, 0xffff0000, v111
    v_lshlrev_b32 v36, 16, v112
    v_and_b32 v37, 0xffff0000, v112
    v_lshlrev_b32 v38, 16, v113
    v_and_b32 v39, 0xffff0000, v113
    v_lshlrev_b32 v40, 16, v114
    v_and_b32 v41, 0xffff0000, v114
    v_lshlrev_b32 v42, 16, v115
    v_and_b32 v43, 0xffff0000, v115
    v_mul_f32 v28, v28, v44
    v_mul_f32 v29, v29, v45
    v_mul_f32 v30, v30, v46
    v_mul_f32 v31, v31, v47
    v_mul_f32 v32, v32, v48
    v_mul_f32 v33, v33, v49
    v_mul_f32 v34, v34, v50
    v_mul_f32 v35, v35, v51
    v_mul_f32 v36, v36, v52
    v_mul_f32 v37, v37, v53
    v_mul_f32 v38, v38, v54
    v_mul_f32 v39, v39, v55
    v_mul_f32 v40, v40, v56
    v_mul_f32 v41, v41, v57
    v_mul_f32 v42, v42, v58
    v_mul_f32 v43, v43, v59
    v_cvt_pk_bf16_f32 v108, v28, v29
    v_cvt_pk_bf16_f32 v109, v30, v31
    v_cvt_pk_bf16_f32 v110, v32, v33
    v_cvt_pk_bf16_f32 v111, v34, v35
    v_cvt_pk_bf16_f32 v112, v36, v37
    v_cvt_pk_bf16_f32 v113, v38, v39
    v_cvt_pk_bf16_f32 v114, v40, v41
    v_cvt_pk_bf16_f32 v115, v42, v43
    buffer_store_dwordx2 v[108:109], v22, s[12:15], 0 offen offset:64
    buffer_store_dwordx2 v[110:111], v22, s[12:15], 0 offen offset:80
    buffer_store_dwordx2 v[112:113], v22, s[12:15], 0 offen offset:96
    buffer_store_dwordx2 v[114:115], v22, s[12:15], 0 offen offset:112
    s_endpgm
L_k3_tg1:
    v_add_u32 v28, 0, v6
    v_add_u32 v29, 0, v7
    v_add_u32 v34, 49152, v6
    v_add_u32 v35, 49152, v7
    v_add_u32 v36, 49152, v30
    v_add_u32 v37, 49152, v31
    v_add_u32 v38, 49152, v32
    v_add_u32 v39, 49152, v33
    v_add_u32 v40, 98304, v6
    v_add_u32 v41, 98304, v7
    v_add_u32 v42, 98304, v30
    v_add_u32 v43, 98304, v31
    v_add_u32 v44, 98304, v32
    v_add_u32 v45, 98304, v33
    s_waitcnt vmcnt(7)
    s_barrier
    ds_read_b128 v[96:99], v30
    ds_read_b64_tr_b16 v[64:65], v28 offset:0
    ds_read_b64_tr_b16 v[66:67], v28 offset:1024
    ds_read_b64_tr_b16 v[68:69], v28 offset:16384
    ds_read_b64_tr_b16 v[70:71], v28 offset:17408
    ds_read_b64_tr_b16 v[72:73], v29 offset:0
    ds_read_b64_tr_b16 v[74:75], v29 offset:1024
    ds_read_b128 v[100:103], v31
    ds_read_b64_tr_b16 v[76:77], v28 offset:4096
    ds_read_b64_tr_b16 v[78:79], v28 offset:5120
    ds_read_b64_tr_b16 v[80:81], v28 offset:20480
    ds_read_b64_tr_b16 v[82:83], v28 offset:21504
    s_waitcnt lgkmcnt(9)
    v_mfma_f32_32x32x16_bf16 v[128:143], v[64:67], v[96:99], v[128:143]
    v_lshlrev_b32 v16, 16, v98
    v_and_b32 v17, 0xffff0000, v98
    v_add_f32 v12, v12, v16
    v_add_f32 v13, v13, v17
    v_fma_f32 v14, v16, v16, v14
    v_fma_f32 v15, v17, v17, v15
    s_add_u32 s37, s38, 98304
    s_mov_b32 m0, s37
    s_movk_i32 s36, 256
    buffer_load_dwordx4 v2, s[4:7], s36 offen lds
    ds_read_b64_tr_b16 v[84:85], v29 offset:4096
    ds_read_b64_tr_b16 v[86:87], v29 offset:5120
    s_waitcnt lgkmcnt(9)
    v_mfma_f32_32x32x16_bf16 v[144:159], v[68:71], v[96:99], v[144:159]
    v_lshlrev_b32 v16, 16, v99
    v_and_b32 v17, 0xffff0000, v99
    v_add_f32 v12, v12, v16
    v_add_f32 v13, v13, v17
    v_fma_f32 v14, v16, v16, v14
    v_fma_f32 v15, v17, v17, v15
    s_add_u32 s37, s38, 99328
    s_mov_b32 m0, s37
    s_movk_i32 s36, 256
    buffer_load_dwordx4 v10, s[4:7], s36 offen lds
    ds_read_b128 v[104:107], v32
    ds_read_b64_tr_b16 v[64:65], v28 offset:8192
    ds_read_b64_tr_b16 v[66:67], v28 offset:9216
    s_waitcnt lgkmcnt(10)
    v_mfma_f32_32x32x16_bf16 v[160:175], v[72:75], v[96:99], v[160:175]
    s_add_u32 s36, s34, 458752
    s_add_u32 s37, s35, 98304
    s_mov_b32 m0, s37
    s_mov_b64 exec, s[32:33]
    buffer_load_dwordx4 v3, s[8:11], s36 offen lds
    s_mov_b64 exec, -1
    ds_read_b64_tr_b16 v[68:69], v28 offset:24576
    ds_read_b64_tr_b16 v[70:71], v28 offset:25600
    s_waitcnt lgkmcnt(9)
    v_mfma_f32_32x32x16_bf16 v[128:143], v[76:79], v[100:103], v[128:143]
    v_lshlrev_b32 v16, 16, v102
    v_and_b32 v17, 0xffff0000, v102
    v_add_f32 v12, v12, v16
    v_add_f32 v13, v13, v17
    v_fma_f32 v14, v16, v16, v14
    v_fma_f32 v15, v17, v17, v15
    s_add_u32 s36, s34, 473088
    s_add_u32 s37, s35, 99328
    s_mov_b32 m0, s37
    s_mov_b64 exec, s[32:33]
    buffer_load_dwordx4 v3, s[8:11], s36 offen lds
    s_mov_b64 exec, -1
    ds_read_b64_tr_b16 v[72:73], v29 offset:8192
    ds_read_b64_tr_b16 v[74:75], v29 offset:9216
    s_waitcnt lgkmcnt(9)
    v_mfma_f32_32x32x16_bf16 v[144:159], v[80:83], v[100:103], v[144:159]
    v_lshlrev_b32 v16, 16, v103
    v_and_b32 v17, 0xffff0000, v103
    v_add_f32 v12, v12, v16
    v_add_f32 v13, v13, v17
    v_fma_f32 v14, v16, v16, v14
    v_fma_f32 v15, v17, v17, v15
    s_add_u32 s36, s34, 487424
    s_add_u32 s37, s35, 100352
    s_mov_b32 m0, s37
    s_mov_b64 exec, s[32:33]
    buffer_load_dwordx4 v3, s[8:11], s36 offen lds
    s_mov_b64 exec, -1
    ds_read_b128 v[96:99], v33
    ds_read_b64_tr_b16 v[76:77], v28 offset:12288
    ds_read_b64_tr_b16 v[78:79], v28 offset:13312
    s_waitcnt lgkmcnt(10)
    v_mfma_f32_32x32x16_bf16 v[160:175], v[84:87], v[100:103], v[160:175]
    s_add_u32 s36, s34, 501760
    s_add_u32 s37, s35, 101376
    s_mov_b32 m0, s37
    s_mov_b64 exec, s[32:33]
    buffer_load_dwordx4 v3, s[8:11], s36 offen lds
    s_mov_b64 exec, -1
    ds_read_b64_tr_b16 v[80:81], v28 offset:28672
    ds_read_b64_tr_b16 v[82:83], v28 offset:29696
    s_waitcnt lgkmcnt(9)
    v_mfma_f32_32x32x16_bf16 v[128:143], v[64:67], v[104:107], v[128:143]
    v_lshlrev_b32 v16, 16, v106
    v_and_b32 v17, 0xffff0000, v106
    v_add_f32 v12, v12, v16
    v_add_f32 v13, v13, v17
    v_fma_f32 v14, v16, v16, v14
    v_fma_f32 v15, v17, v17, v15
    ds_read_b64_tr_b16 v[84:85], v29 offset:12288
    ds_read_b64_tr_b16 v[86:87], v29 offset:13312
    s_waitcnt lgkmcnt(9)
    v_mfma_f32_32x32x16_bf16 v[144:159], v[68:71], v[104:107], v[144:159]
    v_lshlrev_b32 v16, 16, v107
    v_and_b32 v17, 0xffff0000, v107
    v_add_f32 v12, v12, v16
    v_add_f32 v13, v13, v17
    v_fma_f32 v14, v16, v16, v14
    v_fma_f32 v15, v17, v17, v15
    s_waitcnt vmcnt(6)
    s_waitcnt lgkmcnt(0)
    s_barrier
    ds_read_b128 v[100:103], v36
    ds_read_b64_tr_b16 v[64:65], v34 offset:0
    ds_read_b64_tr_b16 v[66:67], v34 offset:1024
    v_mfma_f32_32x32x16_bf16 v[160:175], v[72:75], v[104:107], v[160:175]
    s_add_u32 s37, s38, 0
    s_mov_b32 m0, s37
    s_movk_i32 s36, 384
    buffer_load_dwordx4 v2, s[4:7], s36 offen lds
    ds_read_b64_tr_b16 v[68:69], v34 offset:16384
    ds_read_b64_tr_b16 v[70:71], v34 offset:17408
    v_mfma_f32_32x32x16_bf16 v[128:143], v[76:79], v[96:99], v[128:143]
    v_lshlrev_b32 v16, 16, v98
    v_and_b32 v17, 0xffff0000, v98
    v_add_f32 v12, v12, v16
    v_add_f32 v13, v13, v17
    v_fma_f32 v14, v16, v16, v14
    v_fma_f32 v15, v17, v17, v15
    s_add_u32 s37, s38, 1024
    s_mov_b32 m0, s37
    s_movk_i32 s36, 384
    buffer_load_dwordx4 v10, s[4:7], s36 offen lds
    ds_read_b64_tr_b16 v[72:73], v35 offset:0
    ds_read_b64_tr_b16 v[74:75], v35 offset:1024
    v_mfma_f32_32x32x16_bf16 v[144:159], v[80:83], v[96:99], v[144:159]
    v_lshlrev_b32 v16, 16, v99
    v_and_b32 v17, 0xffff0000, v99
    v_add_f32 v12, v12, v16
    v_add_f32 v13, v13, v17
    v_fma_f32 v14, v16, v16, v14
    v_fma_f32 v15, v17, v17, v15
    s_add_u32 s36, s34, 688128
    s_add_u32 s37, s35, 0
    s_mov_b32 m0, s37
    s_mov_b64 exec, s[32:33]
    buffer_load_dwordx4 v3, s[8:11], s36 offen lds
    s_mov_b64 exec, -1
    ds_read_b128 v[104:107], v37
    ds_read_b64_tr_b16 v[76:77], v34 offset:4096
    ds_read_b64_tr_b16 v[78:79], v34 offset:5120
    v_mfma_f32_32x32x16_bf16 v[160:175], v[84:87], v[96:99], v[160:175]
    s_add_u32 s36, s34, 702464
    s_add_u32 s37, s35, 1024
    s_mov_b32 m0, s37
    s_mov_b64 exec, s[32:33]
    buffer_load_dwordx4 v3, s[8:11], s36 offen lds
    s_mov_b64 exec, -1
    ds_read_b64_tr_b16 v[80:81], v34 offset:20480
    ds_read_b64_tr_b16 v[82:83], v34 offset:21504
    s_waitcnt lgkmcnt(9)
    v_mfma_f32_32x32x16_bf16 v[128:143], v[64:67], v[100:103], v[128:143]
    v_lshlrev_b32 v16, 16, v102
    v_and_b32 v17, 0xffff0000, v102
    v_add_f32 v12, v12, v16
    v_add_f32 v13, v13, v17
    v_fma_f32 v14, v16, v16, v14
    v_fma_f32 v15, v17, v17, v15
    s_add_u32 s36, s34, 716800
    s_add_u32 s37, s35, 2048
    s_mov_b32 m0, s37
    s_mov_b64 exec, s[32:33]
    buffer_load_dwordx4 v3, s[8:11], s36 offen lds
    s_mov_b64 exec, -1
    ds_read_b64_tr_b16 v[84:85], v35 offset:4096
    ds_read_b64_tr_b16 v[86:87], v35 offset:5120
    s_waitcnt lgkmcnt(9)
    v_mfma_f32_32x32x16_bf16 v[144:159], v[68:71], v[100:103], v[144:159]
    v_lshlrev_b32 v16, 16, v103
    v_and_b32 v17, 0xffff0000, v103
    v_add_f32 v12, v12, v16
    v_add_f32 v13, v13, v17
    v_fma_f32 v14, v16, v16, v14
    v_fma_f32 v15, v17, v17, v15
    s_add_u32 s36, s34, 731136
    s_add_u32 s37, s35, 3072
    s_mov_b32 m0, s37
    s_mov_b64 exec, s[32:33]
    buffer_load_dwordx4 v3, s[8:11], s36 offen lds
    s_mov_b64 exec, -1
    ds_read_b128 v[96:99], v38
    ds_read_b64_tr_b16 v[64:65], v34 offset:8192
    ds_read_b64_tr_b16 v[66:67], v34 offset:9216
    s_waitcnt lgkmcnt(10)
    v_mfma_f32_32x32x16_bf16 v[160:175], v[72:75], v[100:103], v[160:175]
    ds_read_b64_tr_b16 v[68:69], v34 offset:24576
    ds_read_b64_tr_b16 v[70:71], v34 offset:25600
    s_waitcnt lgkmcnt(9)
    v_mfma_f32_32x32x16_bf16 v[128:143], v[76:79], v[104:107], v[128:143]
    v_lshlrev_b32 v16, 16, v106
    v_and_b32 v17, 0xffff0000, v106
    v_add_f32 v12, v12, v16
    v_add_f32 v13, v13, v17
    v_fma_f32 v14, v16, v16, v14
    v_fma_f32 v15, v17, v17, v15
    ds_read_b64_tr_b16 v[72:73], v35 offset:8192
    ds_read_b64_tr_b16 v[74:75], v35 offset:9216
    s_waitcnt lgkmcnt(9)
    v_mfma_f32_32x32x16_bf16 v[144:159], v[80:83], v[104:107], v[144:159]
    v_lshlrev_b32 v16, 16, v107
    v_and_b32 v17, 0xffff0000, v107
    v_add_f32 v12, v12, v16
    v_add_f32 v13, v13, v17
    v_fma_f32 v14, v16, v16, v14
    v_fma_f32 v15, v17, v17, v15
    ds_read_b128 v[100:103], v39
    ds_read_b64_tr_b16 v[76:77], v34 offset:12288
    ds_read_b64_tr_b16 v[78:79], v34 offset:13312
    s_waitcnt lgkmcnt(10)
    v_mfma_f32_32x32x16_bf16 v[160:175], v[84:87], v[104:107], v[160:175]
    ds_read_b64_tr_b16 v[80:81], v34 offset:28672
    ds_read_b64_tr_b16 v[82:83], v34 offset:29696
    s_waitcnt lgkmcnt(9)
    v_mfma_f32_32x32x16_bf16 v[128:143], v[64:67], v[96:99], v[128:143]
    v_lshlrev_b32 v16, 16, v98
    v_and_b32 v17, 0xffff0000, v98
    v_add_f32 v12, v12, v16
    v_add_f32 v13, v13, v17
    v_fma_f32 v14, v16, v16, v14
    v_fma_f32 v15, v17, v17, v15
    ds_read_b64_tr_b16 v[84:85], v35 offset:12288
    ds_read_b64_tr_b16 v[86:87], v35 offset:13312
    s_waitcnt lgkmcnt(9)
    v_mfma_f32_32x32x16_bf16 v[144:159], v[68:71], v[96:99], v[144:159]
    v_lshlrev_b32 v16, 16, v99
    v_and_b32 v17, 0xffff0000, v99
    v_add_f32 v12, v12, v16
    v_add_f32 v13, v13, v17
    v_fma_f32 v14, v16, v16, v14
    v_fma_f32 v15, v17, v17, v15
    s_waitcnt vmcnt(6)
    s_waitcnt lgkmcnt(0)
    s_barrier
    ds_read_b128 v[104:107], v42
    ds_read_b64_tr_b16 v[64:65], v40 offset:0
    ds_read_b64_tr_b16 v[66:67], v40 offset:1024
    v_mfma_f32_32x32x16_bf16 v[160:175], v[72:75], v[96:99], v[160:175]
    s_add_u32 s37, s38, 49152
    s_mov_b32 m0, s37
    s_movk_i32 s36, 512
    buffer_load_dwordx4 v2, s[4:7], s36 offen lds
    v_lshlrev_b32 v18, 2, v0
    v_add_u32 v18, 147456, v18
    v_min_u32 v18, 148476, v18
    ds_write_b32 v18, v20
    ds_read_b64_tr_b16 v[68:69], v40 offset:16384
    ds_read_b64_tr_b16 v[70:71], v40 offset:17408
    v_mfma_f32_32x32x16_bf16 v[128:143], v[76:79], v[100:103], v[128:143]
    v_lshlrev_b32 v16, 16, v102
    v_and_b32 v17, 0xffff0000, v102
    v_add_f32 v12, v12, v16
    v_add_f32 v13, v13, v17
    v_fma_f32 v14, v16, v16, v14
    v_fma_f32 v15, v17, v17, v15
    s_add_u32 s37, s38, 50176
    s_mov_b32 m0, s37
    s_movk_i32 s36, 512
    buffer_load_dwordx4 v10, s[4:7], s36 offen lds
    ds_read_b64_tr_b16 v[72:73], v41 offset:0
    ds_read_b64_tr_b16 v[74:75], v41 offset:1024
    v_mfma_f32_32x32x16_bf16 v[144:159], v[80:83], v[100:103], v[144:159]
    v_lshlrev_b32 v16, 16, v103
    v_and_b32 v17, 0xffff0000, v103
    v_add_f32 v12, v12, v16
    v_add_f32 v13, v13, v17
    v_fma_f32 v14, v16, v16, v14
    v_fma_f32 v15, v17, v17, v15
    s_add_u32 s36, s34, 917504
    s_add_u32 s37, s35, 49152
    s_mov_b32 m0, s37
    s_mov_b64 exec, s[32:33]
    buffer_load_dwordx4 v3, s[8:11], s36 offen lds
    s_mov_b64 exec, -1
    ds_read_b128 v[96:99], v43
    ds_read_b64_tr_b16 v[76:77], v40 offset:4096
    ds_read_b64_tr_b16 v[78:79], v40 offset:5120
    v_mfma_f32_32x32x16_bf16 v[160:175], v[84:87], v[100:103], v[160:175]
    s_add_u32 s36, s34, 931840
    s_add_u32 s37, s35, 50176
    s_mov_b32 m0, s37
    s_mov_b64 exec, s[32:33]
    buffer_load_dwordx4 v3, s[8:11], s36 offen lds
    s_mov_b64 exec, -1
    ds_read_b64_tr_b16 v[80:81], v40 offset:20480
    ds_read_b64_tr_b16 v[82:83], v40 offset:21504
    s_waitcnt lgkmcnt(10)
    v_mfma_f32_32x32x16_bf16 v[128:143], v[64:67], v[104:107], v[128:143]
    v_lshlrev_b32 v16, 16, v106
    v_and_b32 v17, 0xffff0000, v106
    v_add_f32 v12, v12, v16
    v_add_f32 v13, v13, v17
    v_fma_f32 v14, v16, v16, v14
    v_fma_f32 v15, v17, v17, v15
    s_add_u32 s36, s34, 946176
    s_add_u32 s37, s35, 51200
    s_mov_b32 m0, s37
    s_mov_b64 exec, s[32:33]
    buffer_load_dwordx4 v3, s[8:11], s36 offen lds
    s_mov_b64 exec, -1
    ds_read_b64_tr_b16 v[84:85], v41 offset:4096
    ds_read_b64_tr_b16 v[86:87], v41 offset:5120
    s_waitcnt lgkmcnt(9)
    v_mfma_f32_32x32x16_bf16 v[144:159], v[68:71], v[104:107], v[144:159]
    v_lshlrev_b32 v16, 16, v107
    v_and_b32 v17, 0xffff0000, v107
    v_add_f32 v12, v12, v16
    v_add_f32 v13, v13, v17
    v_fma_f32 v14, v16, v16, v14
    v_fma_f32 v15, v17, v17, v15
    s_add_u32 s36, s34, 960512
    s_add_u32 s37, s35, 52224
    s_mov_b32 m0, s37
    s_mov_b64 exec, s[32:33]
    buffer_load_dwordx4 v3, s[8:11], s36 offen lds
    s_mov_b64 exec, -1
    ds_read_b128 v[100:103], v44
    ds_read_b64_tr_b16 v[64:65], v40 offset:8192
    ds_read_b64_tr_b16 v[66:67], v40 offset:9216
    s_waitcnt lgkmcnt(10)
    v_mfma_f32_32x32x16_bf16 v[160:175], v[72:75], v[104:107], v[160:175]
    ds_read_b64_tr_b16 v[68:69], v40 offset:24576
    ds_read_b64_tr_b16 v[70:71], v40 offset:25600
    s_waitcnt lgkmcnt(9)
    v_mfma_f32_32x32x16_bf16 v[128:143], v[76:79], v[96:99], v[128:143]
    v_lshlrev_b32 v16, 16, v98
    v_and_b32 v17, 0xffff0000, v98
    v_add_f32 v12, v12, v16
    v_add_f32 v13, v13, v17
    v_fma_f32 v14, v16, v16, v14
    v_fma_f32 v15, v17, v17, v15
    ds_read_b64_tr_b16 v[72:73], v41 offset:8192
    ds_read_b64_tr_b16 v[74:75], v41 offset:9216
    s_waitcnt lgkmcnt(9)
    v_mfma_f32_32x32x16_bf16 v[144:159], v[80:83], v[96:99], v[144:159]
    v_lshlrev_b32 v16, 16, v99
    v_and_b32 v17, 0xffff0000, v99
    v_add_f32 v12, v12, v16
    v_add_f32 v13, v13, v17
    v_fma_f32 v14, v16, v16, v14
    v_fma_f32 v15, v17, v17, v15
    ds_read_b128 v[104:107], v45
    ds_read_b64_tr_b16 v[76:77], v40 offset:12288
    ds_read_b64_tr_b16 v[78:79], v40 offset:13312
    s_waitcnt lgkmcnt(10)
    v_mfma_f32_32x32x16_bf16 v[160:175], v[84:87], v[96:99], v[160:175]
    ds_read_b64_tr_b16 v[80:81], v40 offset:28672
    ds_read_b64_tr_b16 v[82:83], v40 offset:29696
    s_waitcnt lgkmcnt(9)
    v_mfma_f32_32x32x16_bf16 v[128:143], v[64:67], v[100:103], v[128:143]
    v_lshlrev_b32 v16, 16, v102
    v_and_b32 v17, 0xffff0000, v102
    v_add_f32 v12, v12, v16
    v_add_f32 v13, v13, v17
    v_fma_f32 v14, v16, v16, v14
    v_fma_f32 v15, v17, v17, v15
    ds_read_b64_tr_b16 v[84:85], v41 offset:12288
    ds_read_b64_tr_b16 v[86:87], v41 offset:13312
    s_waitcnt lgkmcnt(9)
    v_mfma_f32_32x32x16_bf16 v[144:159], v[68:71], v[100:103], v[144:159]
    v_lshlrev_b32 v16, 16, v103
    v_and_b32 v17, 0xffff0000, v103
    v_add_f32 v12, v12, v16
    v_add_f32 v13, v13, v17
    v_fma_f32 v14, v16, v16, v14
    v_fma_f32 v15, v17, v17, v15
    s_waitcnt vmcnt(6)
    s_waitcnt lgkmcnt(0)
    s_barrier
    ds_read_b128 v[96:99], v30
    ds_read_b64_tr_b16 v[64:65], v28 offset:0
    ds_read_b64_tr_b16 v[66:67], v28 offset:1024
    v_mfma_f32_32x32x16_bf16 v[160:175], v[72:75], v[100:103], v[160:175]
    s_add_u32 s37, s38, 98304
    s_mov_b32 m0, s37
    s_movk_i32 s36, 640
    buffer_load_dwordx4 v2, s[4:7], s36 offen lds
    ds_read_b64_tr_b16 v[68:69], v28 offset:16384
    ds_read_b64_tr_b16 v[70:71], v28 offset:17408
    v_mfma_f32_32x32x16_bf16 v[128:143], v[76:79], v[104:107], v[128:143]
    v_lshlrev_b32 v16, 16, v106
    v_and_b32 v17, 0xffff0000, v106
    v_add_f32 v12, v12, v16
    v_add_f32 v13, v13, v17
    v_fma_f32 v14, v16, v16, v14
    v_fma_f32 v15, v17, v17, v15
    s_add_u32 s37, s38, 99328
    s_mov_b32 m0, s37
    s_movk_i32 s36, 640
    buffer_load_dwordx4 v10, s[4:7], s36 offen lds
    ds_read_b64_tr_b16 v[72:73], v29 offset:0
    ds_read_b64_tr_b16 v[74:75], v29 offset:1024
    v_mfma_f32_32x32x16_bf16 v[144:159], v[80:83], v[104:107], v[144:159]
    v_lshlrev_b32 v16, 16, v107
    v_and_b32 v17, 0xffff0000, v107
    v_add_f32 v12, v12, v16
    v_add_f32 v13, v13, v17
    v_fma_f32 v14, v16, v16, v14
    v_fma_f32 v15, v17, v17, v15
    s_add_u32 s36, s34, 1146880
    s_add_u32 s37, s35, 98304
    s_mov_b32 m0, s37
    s_mov_b64 exec, s[32:33]
    buffer_load_dwordx4 v3, s[8:11], s36 offen lds
    s_mov_b64 exec, -1
    ds_read_b128 v[100:103], v31
    ds_read_b64_tr_b16 v[76:77], v28 offset:4096
    ds_read_b64_tr_b16 v[78:79], v28 offset:5120
    v_mfma_f32_32x32x16_bf16 v[160:175], v[84:87], v[104:107], v[160:175]
    s_add_u32 s36, s34, 1161216
    s_add_u32 s37, s35, 99328
    s_mov_b32 m0, s37
    s_mov_b64 exec, s[32:33]
    buffer_load_dwordx4 v3, s[8:11], s36 offen lds
    s_mov_b64 exec, -1
    ds_read_b64_tr_b16 v[80:81], v28 offset:20480
    ds_read_b64_tr_b16 v[82:83], v28 offset:21504
    s_waitcnt lgkmcnt(9)
    v_mfma_f32_32x32x16_bf16 v[128:143], v[64:67], v[96:99], v[128:143]
    v_lshlrev_b32 v16, 16, v98
    v_and_b32 v17, 0xffff0000, v98
    v_add_f32 v12, v12, v16
    v_add_f32 v13, v13, v17
    v_fma_f32 v14, v16, v16, v14
    v_fma_f32 v15, v17, v17, v15
    s_add_u32 s36, s34, 1175552
    s_add_u32 s37, s35, 100352
    s_mov_b32 m0, s37
    s_mov_b64 exec, s[32:33]
    buffer_load_dwordx4 v3, s[8:11], s36 offen lds
    s_mov_b64 exec, -1
    ds_read_b64_tr_b16 v[84:85], v29 offset:4096
    ds_read_b64_tr_b16 v[86:87], v29 offset:5120
    s_waitcnt lgkmcnt(9)
    v_mfma_f32_32x32x16_bf16 v[144:159], v[68:71], v[96:99], v[144:159]
    v_lshlrev_b32 v16, 16, v99
    v_and_b32 v17, 0xffff0000, v99
    v_add_f32 v12, v12, v16
    v_add_f32 v13, v13, v17
    v_fma_f32 v14, v16, v16, v14
    v_fma_f32 v15, v17, v17, v15
    s_add_u32 s36, s34, 1189888
    s_add_u32 s37, s35, 101376
    s_mov_b32 m0, s37
    s_mov_b64 exec, s[32:33]
    buffer_load_dwordx4 v3, s[8:11], s36 offen lds
    s_mov_b64 exec, -1
    ds_read_b128 v[104:107], v32
    ds_read_b64_tr_b16 v[64:65], v28 offset:8192
    ds_read_b64_tr_b16 v[66:67], v28 offset:9216
    s_waitcnt lgkmcnt(10)
    v_mfma_f32_32x32x16_bf16 v[160:175], v[72:75], v[96:99], v[160:175]
    ds_read_b64_tr_b16 v[68:69], v28 offset:24576
    ds_read_b64_tr_b16 v[70:71], v28 offset:25600
    s_waitcnt lgkmcnt(9)
    v_mfma_f32_32x32x16_bf16 v[128:143], v[76:79], v[100:103], v[128:143]
    v_lshlrev_b32 v16, 16, v102
    v_and_b32 v17, 0xffff0000, v102
    v_add_f32 v12, v12, v16
    v_add_f32 v13, v13, v17
    v_fma_f32 v14, v16, v16, v14
    v_fma_f32 v15, v17, v17, v15
    ds_read_b64_tr_b16 v[72:73], v29 offset:8192
    ds_read_b64_tr_b16 v[74:75], v29 offset:9216
    s_waitcnt lgkmcnt(9)
    v_mfma_f32_32x32x16_bf16 v[144:159], v[80:83], v[100:103], v[144:159]
    v_lshlrev_b32 v16, 16, v103
    v_and_b32 v17, 0xffff0000, v103
    v_add_f32 v12, v12, v16
    v_add_f32 v13, v13, v17
    v_fma_f32 v14, v16, v16, v14
    v_fma_f32 v15, v17, v17, v15
    ds_read_b128 v[96:99], v33
    ds_read_b64_tr_b16 v[76:77], v28 offset:12288
    ds_read_b64_tr_b16 v[78:79], v28 offset:13312
    s_waitcnt lgkmcnt(10)
    v_mfma_f32_32x32x16_bf16 v[160:175], v[84:87], v[100:103], v[160:175]
    ds_read_b64_tr_b16 v[80:81], v28 offset:28672
    ds_read_b64_tr_b16 v[82:83], v28 offset:29696
    s_waitcnt lgkmcnt(9)
    v_mfma_f32_32x32x16_bf16 v[128:143], v[64:67], v[104:107], v[128:143]
    v_lshlrev_b32 v16, 16, v106
    v_and_b32 v17, 0xffff0000, v106
    v_add_f32 v12, v12, v16
    v_add_f32 v13, v13, v17
    v_fma_f32 v14, v16, v16, v14
    v_fma_f32 v15, v17, v17, v15
    ds_read_b64_tr_b16 v[84:85], v29 offset:12288
    ds_read_b64_tr_b16 v[86:87], v29 offset:13312
    s_waitcnt lgkmcnt(9)
    v_mfma_f32_32x32x16_bf16 v[144:159], v[68:71], v[104:107], v[144:159]
    v_lshlrev_b32 v16, 16, v107
    v_and_b32 v17, 0xffff0000, v107
    v_add_f32 v12, v12, v16
    v_add_f32 v13, v13, v17
    v_fma_f32 v14, v16, v16, v14
    v_fma_f32 v15, v17, v17, v15
    s_waitcnt vmcnt(6)
    s_waitcnt lgkmcnt(0)
    s_barrier
    ds_read_b128 v[100:103], v36
    ds_read_b64_tr_b16 v[64:65], v34 offset:0
    ds_read_b64_tr_b16 v[66:67], v34 offset:1024
    v_mfma_f32_32x32x16_bf16 v[160:175], v[72:75], v[104:107], v[160:175]
    s_add_u32 s37, s38, 0
    s_mov_b32 m0, s37
    s_movk_i32 s36, 768
    buffer_load_dwordx4 v2, s[4:7], s36 offen lds
    ds_read_b64_tr_b16 v[68:69], v34 offset:16384
    ds_read_b64_tr_b16 v[70:71], v34 offset:17408
    v_mfma_f32_32x32x16_bf16 v[128:143], v[76:79], v[96:99], v[128:143]
    v_lshlrev_b32 v16, 16, v98
    v_and_b32 v17, 0xffff0000, v98
    v_add_f32 v12, v12, v16
    v_add_f32 v13, v13, v17
    v_fma_f32 v14, v16, v16, v14
    v_fma_f32 v15, v17, v17, v15
    s_add_u32 s37, s38, 1024
    s_mov_b32 m0, s37
    s_movk_i32 s36, 768
    buffer_load_dwordx4 v10, s[4:7], s36 offen lds
    ds_read_b64_tr_b16 v[72:73], v35 offset:0
    ds_read_b64_tr_b16 v[74:75], v35 offset:1024
    v_mfma_f32_32x32x16_bf16 v[144:159], v[80:83], v[96:99], v[144:159]
    v_lshlrev_b32 v16, 16, v99
    v_and_b32 v17, 0xffff0000, v99
    v_add_f32 v12, v12, v16
    v_add_f32 v13, v13, v17
    v_fma_f32 v14, v16, v16, v14
    v_fma_f32 v15, v17, v17, v15
    s_add_u32 s36, s34, 1376256
    s_add_u32 s37, s35, 0
    s_mov_b32 m0, s37
    s_mov_b64 exec, s[32:33]
    buffer_load_dwordx4 v3, s[8:11], s36 offen lds
    s_mov_b64 exec, -1
    ds_read_b128 v[104:107], v37
    ds_read_b64_tr_b16 v[76:77], v34 offset:4096
    ds_read_b64_tr_b16 v[78:79], v34 offset:5120
    v_mfma_f32_32x32x16_bf16 v[160:175], v[84:87], v[96:99], v[160:175]
    s_add_u32 s36, s34, 1390592
    s_add_u32 s37, s35, 1024
    s_mov_b32 m0, s37
    s_mov_b64 exec, s[32:33]
    buffer_load_dwordx4 v3, s[8:11], s36 offen lds
    s_mov_b64 exec, -1
    ds_read_b64_tr_b16 v[80:81], v34 offset:20480
    ds_read_b64_tr_b16 v[82:83], v34 offset:21504
    s_waitcnt lgkmcnt(9)
    v_mfma_f32_32x32x16_bf16 v[128:143], v[64:67], v[100:103], v[128:143]
    v_lshlrev_b32 v16, 16, v102
    v_and_b32 v17, 0xffff0000, v102
    v_add_f32 v12, v12, v16
    v_add_f32 v13, v13, v17
    v_fma_f32 v14, v16, v16, v14
    v_fma_f32 v15, v17, v17, v15
    s_add_u32 s36, s34, 1404928
    s_add_u32 s37, s35, 2048
    s_mov_b32 m0, s37
    s_mov_b64 exec, s[32:33]
    buffer_load_dwordx4 v3, s[8:11], s36 offen lds
    s_mov_b64 exec, -1
    ds_read_b64_tr_b16 v[84:85], v35 offset:4096
    ds_read_b64_tr_b16 v[86:87], v35 offset:5120
    s_waitcnt lgkmcnt(9)
    v_mfma_f32_32x32x16_bf16 v[144:159], v[68:71], v[100:103], v[144:159]
    v_lshlrev_b32 v16, 16, v103
    v_and_b32 v17, 0xffff0000, v103
    v_add_f32 v12, v12, v16
    v_add_f32 v13, v13, v17
    v_fma_f32 v14, v16, v16, v14
    v_fma_f32 v15, v17, v17, v15
    s_add_u32 s36, s34, 1419264
    s_add_u32 s37, s35, 3072
    s_mov_b32 m0, s37
    s_mov_b64 exec, s[32:33]
    buffer_load_dwordx4 v3, s[8:11], s36 offen lds
    s_mov_b64 exec, -1
    ds_read_b128 v[96:99], v38
    ds_read_b64_tr_b16 v[64:65], v34 offset:8192
    ds_read_b64_tr_b16 v[66:67], v34 offset:9216
    s_waitcnt lgkmcnt(10)
    v_mfma_f32_32x32x16_bf16 v[160:175], v[72:75], v[100:103], v[160:175]
    ds_read_b64_tr_b16 v[68:69], v34 offset:24576
    ds_read_b64_tr_b16 v[70:71], v34 offset:25600
    s_waitcnt lgkmcnt(9)
    v_mfma_f32_32x32x16_bf16 v[128:143], v[76:79], v[104:107], v[128:143]
    v_lshlrev_b32 v16, 16, v106
    v_and_b32 v17, 0xffff0000, v106
    v_add_f32 v12, v12, v16
    v_add_f32 v13, v13, v17
    v_fma_f32 v14, v16, v16, v14
    v_fma_f32 v15, v17, v17, v15
    ds_read_b64_tr_b16 v[72:73], v35 offset:8192
    ds_read_b64_tr_b16 v[74:75], v35 offset:9216
    s_waitcnt lgkmcnt(9)
    v_mfma_f32_32x32x16_bf16 v[144:159], v[80:83], v[104:107], v[144:159]
    v_lshlrev_b32 v16, 16, v107
    v_and_b32 v17, 0xffff0000, v107
    v_add_f32 v12, v12, v16
    v_add_f32 v13, v13, v17
    v_fma_f32 v14, v16, v16, v14
    v_fma_f32 v15, v17, v17, v15
    ds_read_b128 v[100:103], v39
    ds_read_b64_tr_b16 v[76:77], v34 offset:12288
    ds_read_b64_tr_b16 v[78:79], v34 offset:13312
    s_waitcnt lgkmcnt(10)
    v_mfma_f32_32x32x16_bf16 v[160:175], v[84:87], v[104:107], v[160:175]
    ds_read_b64_tr_b16 v[80:81], v34 offset:28672
    ds_read_b64_tr_b16 v[82:83], v34 offset:29696
    s_waitcnt lgkmcnt(9)
    v_mfma_f32_32x32x16_bf16 v[128:143], v[64:67], v[96:99], v[128:143]
    v_lshlrev_b32 v16, 16, v98
    v_and_b32 v17, 0xffff0000, v98
    v_add_f32 v12, v12, v16
    v_add_f32 v13, v13, v17
    v_fma_f32 v14, v16, v16, v14
    v_fma_f32 v15, v17, v17, v15
    ds_read_b64_tr_b16 v[84:85], v35 offset:12288
    ds_read_b64_tr_b16 v[86:87], v35 offset:13312
    s_waitcnt lgkmcnt(9)
    v_mfma_f32_32x32x16_bf16 v[144:159], v[68:71], v[96:99], v[144:159]
    v_lshlrev_b32 v16, 16, v99
    v_and_b32 v17, 0xffff0000, v99
    v_add_f32 v12, v12, v16
    v_add_f32 v13, v13, v17
    v_fma_f32 v14, v16, v16, v14
    v_fma_f32 v15, v17, v17, v15
    s_waitcnt vmcnt(6)
    s_waitcnt lgkmcnt(0)
    s_barrier
    ds_read_b128 v[104:107], v42
    ds_read_b64_tr_b16 v[64:65], v40 offset:0
    ds_read_b64_tr_b16 v[66:67], v40 offset:1024
    v_mfma_f32_32x32x16_bf16 v[160:175], v[72:75], v[96:99], v[160:175]
    s_add_u32 s37, s38, 49152
    s_mov_b32 m0, s37
    s_movk_i32 s36, 896
    buffer_load_dwordx4 v2, s[4:7], s36 offen lds
    ds_read_b64_tr_b16 v[68:69], v40 offset:16384
    ds_read_b64_tr_b16 v[70:71], v40 offset:17408
    v_mfma_f32_32x32x16_bf16 v[128:143], v[76:79], v[100:103], v[128:143]
    v_lshlrev_b32 v16, 16, v102
    v_and_b32 v17, 0xffff0000, v102
    v_add_f32 v12, v12, v16
    v_add_f32 v13, v13, v17
    v_fma_f32 v14, v16, v16, v14
    v_fma_f32 v15, v17, v17, v15
    s_add_u32 s37, s38, 50176
    s_mov_b32 m0, s37
    s_movk_i32 s36, 896
    buffer_load_dwordx4 v10, s[4:7], s36 offen lds
    ds_read_b64_tr_b16 v[72:73], v41 offset:0
    ds_read_b64_tr_b16 v[74:75], v41 offset:1024
    v_mfma_f32_32x32x16_bf16 v[144:159], v[80:83], v[100:103], v[144:159]
    v_lshlrev_b32 v16, 16, v103
    v_and_b32 v17, 0xffff0000, v103
    v_add_f32 v12, v12, v16
    v_add_f32 v13, v13, v17
    v_fma_f32 v14, v16, v16, v14
    v_fma_f32 v15, v17, v17, v15
    s_add_u32 s36, s34, 1605632
    s_add_u32 s37, s35, 49152
    s_mov_b32 m0, s37
    s_mov_b64 exec, s[32:33]
    buffer_load_dwordx4 v3, s[8:11], s36 offen lds
    s_mov_b64 exec, -1
    ds_read_b128 v[96:99], v43
    ds_read_b64_tr_b16 v[76:77], v40 offset:4096
    ds_read_b64_tr_b16 v[78:79], v40 offset:5120
    v_mfma_f32_32x32x16_bf16 v[160:175], v[84:87], v[100:103], v[160:175]
    s_add_u32 s36, s34, 1619968
    s_add_u32 s37, s35, 50176
    s_mov_b32 m0, s37
    s_mov_b64 exec, s[32:33]
    buffer_load_dwordx4 v3, s[8:11], s36 offen lds
    s_mov_b64 exec, -1
    ds_read_b64_tr_b16 v[80:81], v40 offset:20480
    ds_read_b64_tr_b16 v[82:83], v40 offset:21504
    s_waitcnt lgkmcnt(9)
    v_mfma_f32_32x32x16_bf16 v[128:143], v[64:67], v[104:107], v[128:143]
    v_lshlrev_b32 v16, 16, v106
    v_and_b32 v17, 0xffff0000, v106
    v_add_f32 v12, v12, v16
    v_add_f32 v13, v13, v17
    v_fma_f32 v14, v16, v16, v14
    v_fma_f32 v15, v17, v17, v15
    s_add_u32 s36, s34, 1634304
    s_add_u32 s37, s35, 51200
    s_mov_b32 m0, s37
    s_mov_b64 exec, s[32:33]
    buffer_load_dwordx4 v3, s[8:11], s36 offen lds
    s_mov_b64 exec, -1
    ds_read_b64_tr_b16 v[84:85], v41 offset:4096
    ds_read_b64_tr_b16 v[86:87], v41 offset:5120
    s_waitcnt lgkmcnt(9)
    v_mfma_f32_32x32x16_bf16 v[144:159], v[68:71], v[104:107], v[144:159]
    v_lshlrev_b32 v16, 16, v107
    v_and_b32 v17, 0xffff0000, v107
    v_add_f32 v12, v12, v16
    v_add_f32 v13, v13, v17
    v_fma_f32 v14, v16, v16, v14
    v_fma_f32 v15, v17, v17, v15
    s_add_u32 s36, s34, 1648640
    s_add_u32 s37, s35, 52224
    s_mov_b32 m0, s37
    s_mov_b64 exec, s[32:33]
    buffer_load_dwordx4 v3, s[8:11], s36 offen lds
    s_mov_b64 exec, -1
    ds_read_b128 v[100:103], v44
    ds_read_b64_tr_b16 v[64:65], v40 offset:8192
    ds_read_b64_tr_b16 v[66:67], v40 offset:9216
    s_waitcnt lgkmcnt(10)
    v_mfma_f32_32x32x16_bf16 v[160:175], v[72:75], v[104:107], v[160:175]
    ds_read_b64_tr_b16 v[68:69], v40 offset:24576
    ds_read_b64_tr_b16 v[70:71], v40 offset:25600
    s_waitcnt lgkmcnt(9)
    v_mfma_f32_32x32x16_bf16 v[128:143], v[76:79], v[96:99], v[128:143]
    v_lshlrev_b32 v16, 16, v98
    v_and_b32 v17, 0xffff0000, v98
    v_add_f32 v12, v12, v16
    v_add_f32 v13, v13, v17
    v_fma_f32 v14, v16, v16, v14
    v_fma_f32 v15, v17, v17, v15
    ds_read_b64_tr_b16 v[72:73], v41 offset:8192
    ds_read_b64_tr_b16 v[74:75], v41 offset:9216
    s_waitcnt lgkmcnt(9)
    v_mfma_f32_32x32x16_bf16 v[144:159], v[80:83], v[96:99], v[144:159]
    v_lshlrev_b32 v16, 16, v99
    v_and_b32 v17, 0xffff0000, v99
    v_add_f32 v12, v12, v16
    v_add_f32 v13, v13, v17
    v_fma_f32 v14, v16, v16, v14
    v_fma_f32 v15, v17, v17, v15
    ds_read_b128 v[104:107], v45
    ds_read_b64_tr_b16 v[76:77], v40 offset:12288
    ds_read_b64_tr_b16 v[78:79], v40 offset:13312
    s_waitcnt lgkmcnt(10)
    v_mfma_f32_32x32x16_bf16 v[160:175], v[84:87], v[96:99], v[160:175]
    ds_read_b64_tr_b16 v[80:81], v40 offset:28672
    ds_read_b64_tr_b16 v[82:83], v40 offset:29696
    s_waitcnt lgkmcnt(9)
    v_mfma_f32_32x32x16_bf16 v[128:143], v[64:67], v[100:103], v[128:143]
    v_lshlrev_b32 v16, 16, v102
    v_and_b32 v17, 0xffff0000, v102
    v_add_f32 v12, v12, v16
    v_add_f32 v13, v13, v17
    v_fma_f32 v14, v16, v16, v14
    v_fma_f32 v15, v17, v17, v15
    ds_read_b64_tr_b16 v[84:85], v41 offset:12288
    ds_read_b64_tr_b16 v[86:87], v41 offset:13312
    s_waitcnt lgkmcnt(9)
    v_mfma_f32_32x32x16_bf16 v[144:159], v[68:71], v[100:103], v[144:159]
    v_lshlrev_b32 v16, 16, v103
    v_and_b32 v17, 0xffff0000, v103
    v_add_f32 v12, v12, v16
    v_add_f32 v13, v13, v17
    v_fma_f32 v14, v16, v16, v14
    v_fma_f32 v15, v17, v17, v15
    s_waitcnt vmcnt(6)
    s_waitcnt lgkmcnt(0)
    s_barrier
    ds_read_b128 v[96:99], v30
    ds_read_b64_tr_b16 v[64:65], v28 offset:0
    ds_read_b64_tr_b16 v[66:67], v28 offset:1024
    v_mfma_f32_32x32x16_bf16 v[160:175], v[72:75], v[100:103], v[160:175]
    ds_read_b64_tr_b16 v[68:69], v28 offset:16384
    ds_read_b64_tr_b16 v[70:71], v28 offset:17408
    v_mfma_f32_32x32x16_bf16 v[128:143], v[76:79], v[104:107], v[128:143]
    v_lshlrev_b32 v16, 16, v106
    v_and_b32 v17, 0xffff0000, v106
    v_add_f32 v12, v12, v16
    v_add_f32 v13, v13, v17
    v_fma_f32 v14, v16, v16, v14
    v_fma_f32 v15, v17, v17, v15
    ds_read_b64_tr_b16 v[72:73], v29 offset:0
    ds_read_b64_tr_b16 v[74:75], v29 offset:1024
    v_mfma_f32_32x32x16_bf16 v[144:159], v[80:83], v[104:107], v[144:159]
    v_lshlrev_b32 v16, 16, v107
    v_and_b32 v17, 0xffff0000, v107
    v_add_f32 v12, v12, v16
    v_add_f32 v13, v13, v17
    v_fma_f32 v14, v16, v16, v14
    v_fma_f32 v15, v17, v17, v15
    ds_read_b128 v[100:103], v31
    ds_read_b64_tr_b16 v[76:77], v28 offset:4096
    ds_read_b64_tr_b16 v[78:79], v28 offset:5120
    v_mfma_f32_32x32x16_bf16 v[160:175], v[84:87], v[104:107], v[160:175]
    ds_read_b64_tr_b16 v[80:81], v28 offset:20480
    ds_read_b64_tr_b16 v[82:83], v28 offset:21504
    s_waitcnt lgkmcnt(9)
    v_mfma_f32_32x32x16_bf16 v[128:143], v[64:67], v[96:99], v[128:143]
    v_lshlrev_b32 v16, 16, v98
    v_and_b32 v17, 0xffff0000, v98
    v_add_f32 v12, v12, v16
    v_add_f32 v13, v13, v17
    v_fma_f32 v14, v16, v16, v14
    v_fma_f32 v15, v17, v17, v15
    ds_read_b64_tr_b16 v[84:85], v29 offset:4096
    ds_read_b64_tr_b16 v[86:87], v29 offset:5120
    s_waitcnt lgkmcnt(9)
    v_mfma_f32_32x32x16_bf16 v[144:159], v[68:71], v[96:99], v[144:159]
    v_lshlrev_b32 v16, 16, v99
    v_and_b32 v17, 0xffff0000, v99
    v_add_f32 v12, v12, v16
    v_add_f32 v13, v13, v17
    v_fma_f32 v14, v16, v16, v14
    v_fma_f32 v15, v17, v17, v15
    ds_read_b128 v[104:107], v32
    ds_read_b64_tr_b16 v[64:65], v28 offset:8192
    ds_read_b64_tr_b16 v[66:67], v28 offset:9216
    s_waitcnt lgkmcnt(10)
    v_mfma_f32_32x32x16_bf16 v[160:175], v[72:75], v[96:99], v[160:175]
    ds_read_b64_tr_b16 v[68:69], v28 offset:24576
    ds_read_b64_tr_b16 v[70:71], v28 offset:25600
    s_waitcnt lgkmcnt(9)
    v_mfma_f32_32x32x16_bf16 v[128:143], v[76:79], v[100:103], v[128:143]
    v_lshlrev_b32 v16, 16, v102
    v_and_b32 v17, 0xffff0000, v102
    v_add_f32 v12, v12, v16
    v_add_f32 v13, v13, v17
    v_fma_f32 v14, v16, v16, v14
    v_fma_f32 v15, v17, v17, v15
    ds_read_b64_tr_b16 v[72:73], v29 offset:8192
    ds_read_b64_tr_b16 v[74:75], v29 offset:9216
    s_waitcnt lgkmcnt(9)
    v_mfma_f32_32x32x16_bf16 v[144:159], v[80:83], v[100:103], v[144:159]
    v_lshlrev_b32 v16, 16, v103
    v_and_b32 v17, 0xffff0000, v103
    v_add_f32 v12, v12, v16
    v_add_f32 v13, v13, v17
    v_fma_f32 v14, v16, v16, v14
    v_fma_f32 v15, v17, v17, v15
    ds_read_b128 v[96:99], v33
    ds_read_b64_tr_b16 v[76:77], v28 offset:12288
    ds_read_b64_tr_b16 v[78:79], v28 offset:13312
    s_waitcnt lgkmcnt(10)
    v_mfma_f32_32x32x16_bf16 v[160:175], v[84:87], v[100:103], v[160:175]
    ds_read_b64_tr_b16 v[80:81], v28 offset:28672
    ds_read_b64_tr_b16 v[82:83], v28 offset:29696
    s_waitcnt lgkmcnt(9)
    v_mfma_f32_32x32x16_bf16 v[128:143], v[64:67], v[104:107], v[128:143]
    v_lshlrev_b32 v16, 16, v106
    v_and_b32 v17, 0xffff0000, v106
    v_add_f32 v12, v12, v16
    v_add_f32 v13, v13, v17
    v_fma_f32 v14, v16, v16, v14
    v_fma_f32 v15, v17, v17, v15
    ds_read_b64_tr_b16 v[84:85], v29 offset:12288
    ds_read_b64_tr_b16 v[86:87], v29 offset:13312
    s_waitcnt lgkmcnt(9)
    v_mfma_f32_32x32x16_bf16 v[144:159], v[68:71], v[104:107], v[144:159]
    v_lshlrev_b32 v16, 16, v107
    v_and_b32 v17, 0xffff0000, v107
    v_add_f32 v12, v12, v16
    v_add_f32 v13, v13, v17
    v_fma_f32 v14, v16, v16, v14
    v_fma_f32 v15, v17, v17, v15
    s_waitcnt vmcnt(0)
    s_waitcnt lgkmcnt(0)
    s_barrier
    ds_read_b128 v[100:103], v36
    ds_read_b64_tr_b16 v[64:65], v34 offset:0
    ds_read_b64_tr_b16 v[66:67], v34 offset:1024
    v_mfma_f32_32x32x16_bf16 v[160:175], v[72:75], v[104:107], v[160:175]
    ds_read_b64_tr_b16 v[68:69], v34 offset:16384
    ds_read_b64_tr_b16 v[70:71], v34 offset:17408
    v_mfma_f32_32x32x16_bf16 v[128:143], v[76:79], v[96:99], v[128:143]
    v_lshlrev_b32 v16, 16, v98
    v_and_b32 v17, 0xffff0000, v98
    v_add_f32 v12, v12, v16
    v_add_f32 v13, v13, v17
    v_fma_f32 v14, v16, v16, v14
    v_fma_f32 v15, v17, v17, v15
    ds_read_b64_tr_b16 v[72:73], v35 offset:0
    ds_read_b64_tr_b16 v[74:75], v35 offset:1024
    v_mfma_f32_32x32x16_bf16 v[144:159], v[80:83], v[96:99], v[144:159]
    v_lshlrev_b32 v16, 16, v99
    v_and_b32 v17, 0xffff0000, v99
    v_add_f32 v12, v12, v16
    v_add_f32 v13, v13, v17
    v_fma_f32 v14, v16, v16, v14
    v_fma_f32 v15, v17, v17, v15
    ds_read_b128 v[104:107], v37
    ds_read_b64_tr_b16 v[76:77], v34 offset:4096
    ds_read_b64_tr_b16 v[78:79], v34 offset:5120
    v_mfma_f32_32x32x16_bf16 v[160:175], v[84:87], v[96:99], v[160:175]
    ds_read_b64_tr_b16 v[80:81], v34 offset:20480
    ds_read_b64_tr_b16 v[82:83], v34 offset:21504
    s_waitcnt lgkmcnt(9)
    v_mfma_f32_32x32x16_bf16 v[128:143], v[64:67], v[100:103], v[128:143]
    v_lshlrev_b32 v16, 16, v102
    v_and_b32 v17, 0xffff0000, v102
    v_add_f32 v12, v12, v16
    v_add_f32 v13, v13, v17
    v_fma_f32 v14, v16, v16, v14
    v_fma_f32 v15, v17, v17, v15
    ds_read_b64_tr_b16 v[84:85], v35 offset:4096
    ds_read_b64_tr_b16 v[86:87], v35 offset:5120
    s_waitcnt lgkmcnt(9)
    v_mfma_f32_32x32x16_bf16 v[144:159], v[68:71], v[100:103], v[144:159]
    v_lshlrev_b32 v16, 16, v103
    v_and_b32 v17, 0xffff0000, v103
    v_add_f32 v12, v12, v16
    v_add_f32 v13, v13, v17
    v_fma_f32 v14, v16, v16, v14
    v_fma_f32 v15, v17, v17, v15
    ds_read_b128 v[96:99], v38
    ds_read_b64_tr_b16 v[64:65], v34 offset:8192
    ds_read_b64_tr_b16 v[66:67], v34 offset:9216
    s_waitcnt lgkmcnt(10)
    v_mfma_f32_32x32x16_bf16 v[160:175], v[72:75], v[100:103], v[160:175]
    ds_read_b64_tr_b16 v[68:69], v34 offset:24576
    ds_read_b64_tr_b16 v[70:71], v34 offset:25600
    s_waitcnt lgkmcnt(9)
    v_mfma_f32_32x32x16_bf16 v[128:143], v[76:79], v[104:107], v[128:143]
    v_lshlrev_b32 v16, 16, v106
    v_and_b32 v17, 0xffff0000, v106
    v_add_f32 v12, v12, v16
    v_add_f32 v13, v13, v17
    v_fma_f32 v14, v16, v16, v14
    v_fma_f32 v15, v17, v17, v15
    ds_read_b64_tr_b16 v[72:73], v35 offset:8192
    ds_read_b64_tr_b16 v[74:75], v35 offset:9216
    s_waitcnt lgkmcnt(9)
    v_mfma_f32_32x32x16_bf16 v[144:159], v[80:83], v[104:107], v[144:159]
    v_lshlrev_b32 v16, 16, v107
    v_and_b32 v17, 0xffff0000, v107
    v_add_f32 v12, v12, v16
    v_add_f32 v13, v13, v17
    v_fma_f32 v14, v16, v16, v14
    v_fma_f32 v15, v17, v17, v15
    ds_read_b128 v[100:103], v39
    ds_read_b64_tr_b16 v[76:77], v34 offset:12288
    ds_read_b64_tr_b16 v[78:79], v34 offset:13312
    s_waitcnt lgkmcnt(10)
    v_mfma_f32_32x32x16_bf16 v[160:175], v[84:87], v[104:107], v[160:175]
    ds_read_b64_tr_b16 v[80:81], v34 offset:28672
    ds_read_b64_tr_b16 v[82:83], v34 offset:29696
    s_waitcnt lgkmcnt(9)
    v_mfma_f32_32x32x16_bf16 v[128:143], v[64:67], v[96:99], v[128:143]
    v_lshlrev_b32 v16, 16, v98
    v_and_b32 v17, 0xffff0000, v98
    v_add_f32 v12, v12, v16
    v_add_f32 v13, v13, v17
    v_fma_f32 v14, v16, v16, v14
    v_fma_f32 v15, v17, v17, v15
    ds_read_b64_tr_b16 v[84:85], v35 offset:12288
    ds_read_b64_tr_b16 v[86:87], v35 offset:13312
    s_waitcnt lgkmcnt(9)
    v_mfma_f32_32x32x16_bf16 v[144:159], v[68:71], v[96:99], v[144:159]
    v_lshlrev_b32 v16, 16, v99
    v_and_b32 v17, 0xffff0000, v99
    v_add_f32 v12, v12, v16
    v_add_f32 v13, v13, v17
    v_fma_f32 v14, v16, v16, v14
    v_fma_f32 v15, v17, v17, v15
    s_waitcnt lgkmcnt(7)
    v_mfma_f32_32x32x16_bf16 v[160:175], v[72:75], v[96:99], v[160:175]
    s_waitcnt lgkmcnt(4)
    v_mfma_f32_32x32x16_bf16 v[128:143], v[76:79], v[100:103], v[128:143]
    v_lshlrev_b32 v16, 16, v102
    v_and_b32 v17, 0xffff0000, v102
    v_add_f32 v12, v12, v16
    v_add_f32 v13, v13, v17
    v_fma_f32 v14, v16, v16, v14
    v_fma_f32 v15, v17, v17, v15
    s_waitcnt lgkmcnt(2)
    v_mfma_f32_32x32x16_bf16 v[144:159], v[80:83], v[100:103], v[144:159]
    v_lshlrev_b32 v16, 16, v103
    v_and_b32 v17, 0xffff0000, v103
    v_add_f32 v12, v12, v16
    v_add_f32 v13, v13, v17
    v_fma_f32 v14, v16, v16, v14
    v_fma_f32 v15, v17, v17, v15
    s_waitcnt lgkmcnt(0)
    v_mfma_f32_32x32x16_bf16 v[160:175], v[84:87], v[100:103], v[160:175]
    v_add_f32 v12, v12, v13
    v_add_f32 v13, v14, v15
    s_lshl_b32 s30, s39, 10
    v_lshlrev_b32 v16, 3, v1
    v_add_u32 v16, s30, v16
    v_add_u32 v17, 148992, v16
    v_add_u32 v16, 148480, v16
    ds_write_b64 v17, v[12:13]
    s_waitcnt lgkmcnt(0)
    s_barrier
    ds_read_b64 v[14:15], v16
    s_waitcnt lgkmcnt(0)
    v_add_f32 v12, v12, v14
    v_add_f32 v13, v13, v15
    v_mov_b32 v16, v12
    s_nop 1
    v_permlane32_swap_b32 v12, v16
    v_add_f32 v12, v12, v16
    v_mov_b32 v16, v13
    s_nop 1
    v_permlane32_swap_b32 v13, v16
    v_add_f32 v13, v13, v16
    v_mul_f32 v14, 0x3b000000, v12
    v_mul_f32 v16, 0x3b000000, v13
    v_fma_f32 v16, -v14, v14, v16
    v_max_f32 v16, 0, v16
    v_cvt_pk_bf16_f32 v17, v14, v14
    v_lshlrev_b32 v14, 16, v17
    v_cvt_pk_bf16_f32 v17, v16, v16
    v_lshlrev_b32 v16, 16, v17
    v_add_f32 v16, 0x3727c5ac, v16
    v_cvt_pk_bf16_f32 v17, v16, v16
    v_lshlrev_b32 v16, 16, v17
    v_sqrt_f32 v16, v16
    s_nop 0
    v_cvt_pk_bf16_f32 v17, v16, v16
    v_lshlrev_b32 v16, 16, v17
    v_rcp_f32 v15, v16
    v_lshrrev_b32 v16, 5, v1
    v_lshlrev_b32 v16, 4, v16
    v_add_u32 v16, 147456, v16
    ds_read_b128 v[60:63], v16 offset:512
    ds_read_b128 v[76:79], v16 offset:640
    ds_read_b128 v[64:67], v16 offset:544
    ds_read_b128 v[80:83], v16 offset:672
    ds_read_b128 v[68:71], v16 offset:576
    ds_read_b128 v[84:87], v16 offset:704
    ds_read_b128 v[72:75], v16 offset:608
    ds_read_b128 v[88:91], v16 offset:736
    s_waitcnt lgkmcnt(0)
    v_fma_f32 v28, -v14, v60, v128
    v_fma_f32 v44, -v14, v76, v144
    v_fma_f32 v29, -v14, v61, v129
    v_fma_f32 v45, -v14, v77, v145
    v_fma_f32 v30, -v14, v62, v130
    v_fma_f32 v46, -v14, v78, v146
    v_fma_f32 v31, -v14, v63, v131
    v_fma_f32 v47, -v14, v79, v147
    v_fma_f32 v32, -v14, v64, v132
    v_fma_f32 v48, -v14, v80, v148
    v_fma_f32 v33, -v14, v65, v133
    v_fma_f32 v49, -v14, v81, v149
    v_fma_f32 v34, -v14, v66, v134
    v_fma_f32 v50, -v14, v82, v150
    v_fma_f32 v35, -v14, v67, v135
    v_fma_f32 v51, -v14, v83, v151
    v_fma_f32 v36, -v14, v68, v136
    v_fma_f32 v52, -v14, v84, v152
    v_fma_f32 v37, -v14, v69, v137
    v_fma_f32 v53, -v14, v85, v153
    v_fma_f32 v38, -v14, v70, v138
    v_fma_f32 v54, -v14, v86, v154
    v_fma_f32 v39, -v14, v71, v139
    v_fma_f32 v55, -v14, v87, v155
    v_fma_f32 v40, -v14, v72, v140
    v_fma_f32 v56, -v14, v88, v156
    v_fma_f32 v41, -v14, v73, v141
    v_fma_f32 v57, -v14, v89, v157
    v_fma_f32 v42, -v14, v74, v142
    v_fma_f32 v58, -v14, v90, v158
    v_fma_f32 v43, -v14, v75, v143
    v_fma_f32 v59, -v14, v91, v159
    v_mul_f32 v28, v15, v28
    v_mul_f32 v44, v15, v44
    v_mul_f32 v29, v15, v29
    v_mul_f32 v45, v15, v45
    v_mul_f32 v30, v15, v30
    v_mul_f32 v46, v15, v46
    v_mul_f32 v31, v15, v31
    v_mul_f32 v47, v15, v47
    v_mul_f32 v32, v15, v32
    v_mul_f32 v48, v15, v48
    v_mul_f32 v33, v15, v33
    v_mul_f32 v49, v15, v49
    v_mul_f32 v34, v15, v34
    v_mul_f32 v50, v15, v50
    v_mul_f32 v35, v15, v35
    v_mul_f32 v51, v15, v51
    v_mul_f32 v36, v15, v36
    v_mul_f32 v52, v15, v52
    v_mul_f32 v37, v15, v37
    v_mul_f32 v53, v15, v53
    v_mul_f32 v38, v15, v38
    v_mul_f32 v54, v15, v54
    v_mul_f32 v39, v15, v39
    v_mul_f32 v55, v15, v55
    v_mul_f32 v40, v15, v40
    v_mul_f32 v56, v15, v56
    v_mul_f32 v41, v15, v41
    v_mul_f32 v57, v15, v57
    v_mul_f32 v42, v15, v42
    v_mul_f32 v58, v15, v58
    v_mul_f32 v43, v15, v43
    v_mul_f32 v59, v15, v59
    v_cvt_pk_bf16_f32 v108, v28, v29
    v_cvt_pk_bf16_f32 v116, v44, v45
    v_cvt_pk_bf16_f32 v109, v30, v31
    v_cvt_pk_bf16_f32 v117, v46, v47
    v_cvt_pk_bf16_f32 v110, v32, v33
    v_cvt_pk_bf16_f32 v118, v48, v49
    v_cvt_pk_bf16_f32 v111, v34, v35
    v_cvt_pk_bf16_f32 v119, v50, v51
    v_cvt_pk_bf16_f32 v112, v36, v37
    v_cvt_pk_bf16_f32 v120, v52, v53
    v_cvt_pk_bf16_f32 v113, v38, v39
    v_cvt_pk_bf16_f32 v121, v54, v55
    v_cvt_pk_bf16_f32 v114, v40, v41
    v_cvt_pk_bf16_f32 v122, v56, v57
    v_cvt_pk_bf16_f32 v115, v42, v43
    v_cvt_pk_bf16_f32 v123, v58, v59
    v_lshlrev_b32 v28, 16, v108
    v_and_b32 v29, 0xffff0000, v108
    v_lshlrev_b32 v44, 16, v116
    v_and_b32 v45, 0xffff0000, v116
    v_lshlrev_b32 v30, 16, v109
    v_and_b32 v31, 0xffff0000, v109
    v_lshlrev_b32 v46, 16, v117
    v_and_b32 v47, 0xffff0000, v117
    v_lshlrev_b32 v32, 16, v110
    v_and_b32 v33, 0xffff0000, v110
    v_lshlrev_b32 v48, 16, v118
    v_and_b32 v49, 0xffff0000, v118
    v_lshlrev_b32 v34, 16, v111
    v_and_b32 v35, 0xffff0000, v111
    v_lshlrev_b32 v50, 16, v119
    v_and_b32 v51, 0xffff0000, v119
    v_lshlrev_b32 v36, 16, v112
    v_and_b32 v37, 0xffff0000, v112
    v_lshlrev_b32 v52, 16, v120
    v_and_b32 v53, 0xffff0000, v120
    v_lshlrev_b32 v38, 16, v113
    v_and_b32 v39, 0xffff0000, v113
    v_lshlrev_b32 v54, 16, v121
    v_and_b32 v55, 0xffff0000, v121
    v_lshlrev_b32 v40, 16, v114
    v_and_b32 v41, 0xffff0000, v114
    v_lshlrev_b32 v56, 16, v122
    v_and_b32 v57, 0xffff0000, v122
    v_lshlrev_b32 v42, 16, v115
    v_and_b32 v43, 0xffff0000, v115
    v_lshlrev_b32 v58, 16, v123
    v_and_b32 v59, 0xffff0000, v123
    v_mul_f32 v92, 0xbfb8aa3b, v28
    v_mul_f32 v93, 0xbfb8aa3b, v29
    v_mul_f32 v94, 0xbfb8aa3b, v30
    v_mul_f32 v95, 0xbfb8aa3b, v31
    v_mul_f32 v96, 0xbfb8aa3b, v32
    v_mul_f32 v97, 0xbfb8aa3b, v33
    v_mul_f32 v98, 0xbfb8aa3b, v34
    v_mul_f32 v99, 0xbfb8aa3b, v35
    v_mul_f32 v100, 0xbfb8aa3b, v36
    v_mul_f32 v101, 0xbfb8aa3b, v37
    v_mul_f32 v102, 0xbfb8aa3b, v38
    v_mul_f32 v103, 0xbfb8aa3b, v39
    v_mul_f32 v104, 0xbfb8aa3b, v40
    v_mul_f32 v105, 0xbfb8aa3b, v41
    v_mul_f32 v106, 0xbfb8aa3b, v42
    v_mul_f32 v107, 0xbfb8aa3b, v43
    v_exp_f32 v92, v92
    v_exp_f32 v93, v93
    v_exp_f32 v94, v94
    v_exp_f32 v95, v95
    v_exp_f32 v96, v96
    v_exp_f32 v97, v97
    v_exp_f32 v98, v98
    v_exp_f32 v99, v99
    v_exp_f32 v100, v100
    v_exp_f32 v101, v101
    v_exp_f32 v102, v102
    v_exp_f32 v103, v103
    v_exp_f32 v104, v104
    v_exp_f32 v105, v105
    v_exp_f32 v106, v106
    v_exp_f32 v107, v107
    v_add_f32 v92, 1.0, v92
    v_add_f32 v93, 1.0, v93
    v_add_f32 v94, 1.0, v94
    v_add_f32 v95, 1.0, v95
    v_add_f32 v96, 1.0, v96
    v_add_f32 v97, 1.0, v97
    v_add_f32 v98, 1.0, v98
    v_add_f32 v99, 1.0, v99
    v_add_f32 v100, 1.0, v100
    v_add_f32 v101, 1.0, v101
    v_add_f32 v102, 1.0, v102
    v_add_f32 v103, 1.0, v103
    v_add_f32 v104, 1.0, v104
    v_add_f32 v105, 1.0, v105
    v_add_f32 v106, 1.0, v106
    v_add_f32 v107, 1.0, v107
    v_rcp_f32 v92, v92
    v_rcp_f32 v93, v93
    v_rcp_f32 v94, v94
    v_rcp_f32 v95, v95
    v_rcp_f32 v96, v96
    v_rcp_f32 v97, v97
    v_rcp_f32 v98, v98
    v_rcp_f32 v99, v99
    v_rcp_f32 v100, v100
    v_rcp_f32 v101, v101
    v_rcp_f32 v102, v102
    v_rcp_f32 v103, v103
    v_rcp_f32 v104, v104
    v_rcp_f32 v105, v105
    v_rcp_f32 v106, v106
    v_rcp_f32 v107, v107
    v_mul_f32 v28, v28, v92
    v_mul_f32 v29, v29, v93
    v_mul_f32 v30, v30, v94
    v_mul_f32 v31, v31, v95
    v_mul_f32 v32, v32, v96
    v_mul_f32 v33, v33, v97
    v_mul_f32 v34, v34, v98
    v_mul_f32 v35, v35, v99
    v_mul_f32 v36, v36, v100
    v_mul_f32 v37, v37, v101
    v_mul_f32 v38, v38, v102
    v_mul_f32 v39, v39, v103
    v_mul_f32 v40, v40, v104
    v_mul_f32 v41, v41, v105
    v_mul_f32 v42, v42, v106
    v_mul_f32 v43, v43, v107
    v_cvt_pk_bf16_f32 v108, v28, v29
    v_cvt_pk_bf16_f32 v109, v30, v31
    v_cvt_pk_bf16_f32 v110, v32, v33
    v_cvt_pk_bf16_f32 v111, v34, v35
    v_cvt_pk_bf16_f32 v112, v36, v37
    v_cvt_pk_bf16_f32 v113, v38, v39
    v_cvt_pk_bf16_f32 v114, v40, v41
    v_cvt_pk_bf16_f32 v115, v42, v43
    v_lshlrev_b32 v28, 16, v108
    v_and_b32 v29, 0xffff0000, v108
    v_lshlrev_b32 v30, 16, v109
    v_and_b32 v31, 0xffff0000, v109
    v_lshlrev_b32 v32, 16, v110
    v_and_b32 v33, 0xffff0000, v110
    v_lshlrev_b32 v34, 16, v111
    v_and_b32 v35, 0xffff0000, v111
    v_lshlrev_b32 v36, 16, v112
    v_and_b32 v37, 0xffff0000, v112
    v_lshlrev_b32 v38, 16, v113
    v_and_b32 v39, 0xffff0000, v113
    v_lshlrev_b32 v40, 16, v114
    v_and_b32 v41, 0xffff0000, v114
    v_lshlrev_b32 v42, 16, v115
    v_and_b32 v43, 0xffff0000, v115
    v_mul_f32 v28, v28, v44
    v_mul_f32 v29, v29, v45
    v_mul_f32 v30, v30, v46
    v_mul_f32 v31, v31, v47
    v_mul_f32 v32, v32, v48
    v_mul_f32 v33, v33, v49
    v_mul_f32 v34, v34, v50
    v_mul_f32 v35, v35, v51
    v_mul_f32 v36, v36, v52
    v_mul_f32 v37, v37, v53
    v_mul_f32 v38, v38, v54
    v_mul_f32 v39, v39, v55
    v_mul_f32 v40, v40, v56
    v_mul_f32 v41, v41, v57
    v_mul_f32 v42, v42, v58
    v_mul_f32 v43, v43, v59
    v_cvt_pk_bf16_f32 v108, v28, v29
    v_cvt_pk_bf16_f32 v109, v30, v31
    v_cvt_pk_bf16_f32 v110, v32, v33
    v_cvt_pk_bf16_f32 v111, v34, v35
    v_cvt_pk_bf16_f32 v112, v36, v37
    v_cvt_pk_bf16_f32 v113, v38, v39
    v_cvt_pk_bf16_f32 v114, v40, v41
    v_cvt_pk_bf16_f32 v115, v42, v43
    buffer_store_dwordx2 v[108:109], v22, s[12:15], 0 offen offset:128
    buffer_store_dwordx2 v[110:111], v22, s[12:15], 0 offen offset:144
    buffer_store_dwordx2 v[112:113], v22, s[12:15], 0 offen offset:160
    buffer_store_dwordx2 v[114:115], v22, s[12:15], 0 offen offset:176
    ds_read_b128 v[60:63], v16 offset:768
    ds_read_b128 v[76:79], v16 offset:832
    ds_read_b128 v[64:67], v16 offset:800
    ds_read_b128 v[80:83], v16 offset:864
    s_waitcnt lgkmcnt(0)
    v_fma_f32 v28, -v14, v60, v160
    v_fma_f32 v44, -v14, v76, v168
    v_fma_f32 v29, -v14, v61, v161
    v_fma_f32 v45, -v14, v77, v169
    v_fma_f32 v30, -v14, v62, v162
    v_fma_f32 v46, -v14, v78, v170
    v_fma_f32 v31, -v14, v63, v163
    v_fma_f32 v47, -v14, v79, v171
    v_fma_f32 v32, -v14, v64, v164
    v_fma_f32 v48, -v14, v80, v172
    v_fma_f32 v33, -v14, v65, v165
    v_fma_f32 v49, -v14, v81, v173
    v_fma_f32 v34, -v14, v66, v166
    v_fma_f32 v50, -v14, v82, v174
    v_fma_f32 v35, -v14, v67, v167
    v_fma_f32 v51, -v14, v83, v175
    v_mul_f32 v28, v15, v28
    v_mul_f32 v44, v15, v44
    v_mul_f32 v29, v15, v29
    v_mul_f32 v45, v15, v45
    v_mul_f32 v30, v15, v30
    v_mul_f32 v46, v15, v46
    v_mul_f32 v31, v15, v31
    v_mul_f32 v47, v15, v47
    v_mul_f32 v32, v15, v32
    v_mul_f32 v48, v15, v48
    v_mul_f32 v33, v15, v33
    v_mul_f32 v49, v15, v49
    v_mul_f32 v34, v15, v34
    v_mul_f32 v50, v15, v50
    v_mul_f32 v35, v15, v35
    v_mul_f32 v51, v15, v51
    v_cvt_pk_bf16_f32 v108, v28, v29
    v_cvt_pk_bf16_f32 v116, v44, v45
    v_cvt_pk_bf16_f32 v109, v30, v31
    v_cvt_pk_bf16_f32 v117, v46, v47
    v_cvt_pk_bf16_f32 v110, v32, v33
    v_cvt_pk_bf16_f32 v118, v48, v49
    v_cvt_pk_bf16_f32 v111, v34, v35
    v_cvt_pk_bf16_f32 v119, v50, v51
    v_lshlrev_b32 v28, 16, v108
    v_and_b32 v29, 0xffff0000, v108
    v_lshlrev_b32 v44, 16, v116
    v_and_b32 v45, 0xffff0000, v116
    v_lshlrev_b32 v30, 16, v109
    v_and_b32 v31, 0xffff0000, v109
    v_lshlrev_b32 v46, 16, v117
    v_and_b32 v47, 0xffff0000, v117
    v_lshlrev_b32 v32, 16, v110
    v_and_b32 v33, 0xffff0000, v110
    v_lshlrev_b32 v48, 16, v118
    v_and_b32 v49, 0xffff0000, v118
    v_lshlrev_b32 v34, 16, v111
    v_and_b32 v35, 0xffff0000, v111
    v_lshlrev_b32 v50, 16, v119
    v_and_b32 v51, 0xffff0000, v119
    v_mul_f32 v92, 0xbfb8aa3b, v28
    v_mul_f32 v93, 0xbfb8aa3b, v29
    v_mul_f32 v94, 0xbfb8aa3b, v30
    v_mul_f32 v95, 0xbfb8aa3b, v31
    v_mul_f32 v96, 0xbfb8aa3b, v32
    v_mul_f32 v97, 0xbfb8aa3b, v33
    v_mul_f32 v98, 0xbfb8aa3b, v34
    v_mul_f32 v99, 0xbfb8aa3b, v35
    v_exp_f32 v92, v92
    v_exp_f32 v93, v93
    v_exp_f32 v94, v94
    v_exp_f32 v95, v95
    v_exp_f32 v96, v96
    v_exp_f32 v97, v97
    v_exp_f32 v98, v98
    v_exp_f32 v99, v99
    v_add_f32 v92, 1.0, v92
    v_add_f32 v93, 1.0, v93
    v_add_f32 v94, 1.0, v94
    v_add_f32 v95, 1.0, v95
    v_add_f32 v96, 1.0, v96
    v_add_f32 v97, 1.0, v97
    v_add_f32 v98, 1.0, v98
    v_add_f32 v99, 1.0, v99
    v_rcp_f32 v92, v92
    v_rcp_f32 v93, v93
    v_rcp_f32 v94, v94
    v_rcp_f32 v95, v95
    v_rcp_f32 v96, v96
    v_rcp_f32 v97, v97
    v_rcp_f32 v98, v98
    v_rcp_f32 v99, v99
    v_mul_f32 v28, v28, v92
    v_mul_f32 v29, v29, v93
    v_mul_f32 v30, v30, v94
    v_mul_f32 v31, v31, v95
    v_mul_f32 v32, v32, v96
    v_mul_f32 v33, v33, v97
    v_mul_f32 v34, v34, v98
    v_mul_f32 v35, v35, v99
    v_cvt_pk_bf16_f32 v108, v28, v29
    v_cvt_pk_bf16_f32 v109, v30, v31
    v_cvt_pk_bf16_f32 v110, v32, v33
    v_cvt_pk_bf16_f32 v111, v34, v35
    v_lshlrev_b32 v28, 16, v108
    v_and_b32 v29, 0xffff0000, v108
    v_lshlrev_b32 v30, 16, v109
    v_and_b32 v31, 0xffff0000, v109
    v_lshlrev_b32 v32, 16, v110
    v_and_b32 v33, 0xffff0000, v110
    v_lshlrev_b32 v34, 16, v111
    v_and_b32 v35, 0xffff0000, v111
    v_mul_f32 v28, v28, v44
    v_mul_f32 v29, v29, v45
    v_mul_f32 v30, v30, v46
    v_mul_f32 v31, v31, v47
    v_mul_f32 v32, v32, v48
    v_mul_f32 v33, v33, v49
    v_mul_f32 v34, v34, v50
    v_mul_f32 v35, v35, v51
    v_cvt_pk_bf16_f32 v108, v28, v29
    v_cvt_pk_bf16_f32 v109, v30, v31
    v_cvt_pk_bf16_f32 v110, v32, v33
    v_cvt_pk_bf16_f32 v111, v34, v35
    buffer_store_dwordx2 v[108:109], v22, s[12:15], 0 offen offset:192
    buffer_store_dwordx2 v[110:111], v22, s[12:15], 0 offen offset:208
    s_endpgm
L_k3_done:
    s_endpgm
.text
.globl k4_ffn_down_kernel
.p2align 8
.type k4_ffn_down_kernel,@function
k4_ffn_down_kernel:

    s_cmp_ge_u32 s2, 256
    s_cbranch_scc1 L_k4_done
    s_load_dwordx2 s[20:21], s[0:1], 80
    s_load_dwordx2 s[22:23], s[0:1], 56
    s_load_dwordx2 s[24:25], s[0:1], 64
    v_lshrrev_b32 v16, 6, v0
    v_and_b32 v1, 63, v0
    v_readfirstlane_b32 s26, v16
    s_and_b32 s27, s2, 7
    s_lshl_b32 s27, s27, 2
    s_bfe_u32 s28, s2, 0x20003
    s_add_u32 s27, s27, s28
    s_lshr_b32 s28, s2, 5
    v_lshrrev_b32 v17, 3, v1
    v_and_b32 v18, 7, v1
    v_lshrrev_b32 v19, 1, v17
    s_and_b32 s30, s26, 1
    s_lshl_b32 s30, s30, 2
    v_add_u32 v19, s30, v19
    v_xor_b32 v18, v18, v19
    s_lshl_b32 s30, s27, 6
    s_lshl_b32 s36, s26, 3
    s_add_u32 s30, s30, s36
    v_add_u32 v17, s30, v17
    s_movk_i32 s30, 3584
    v_mul_lo_u32 v2, v17, s30
    v_lshl_add_u32 v2, v18, 4, v2
    s_lshl_b32 s38, s26, 10
    v_lshrrev_b32 v17, 3, v1
    v_and_b32 v18, 7, v1
    v_bfe_u32 v19, v17, 1, 1
    v_lshlrev_b32 v19, 2, v19
    v_xor_b32 v18, v18, v19
    v_lshlrev_b32 v3, 10, v17
    v_lshl_add_u32 v3, v18, 4, v3
    s_lshl_b32 s30, s28, 7
    v_add_u32 v3, s30, v3
    s_lshl_b32 s34, s26, 14
    s_lshl_b32 s35, s26, 11
    s_add_u32 s35, s35, 16384
    s_waitcnt lgkmcnt(0)
    s_add_u32 s4, s20, 12582912
    s_addc_u32 s5, s21, 0
    s_mov_b32 s6, 7340032
    s_mov_b32 s7, 0x00020000
    s_mov_b32 s8, s22
    s_mov_b32 s9, s23
    s_mov_b32 s10, 1835008
    s_mov_b32 s11, 0x00020000
    s_add_u32 s37, s38, 0
    s_mov_b32 m0, s37
    s_movk_i32 s36, 0
    buffer_load_dwordx4 v2, s[4:7], s36 offen lds
    s_add_u32 s37, s38, 8192
    s_mov_b32 m0, s37
    s_movk_i32 s36, 128
    buffer_load_dwordx4 v2, s[4:7], s36 offen lds
    s_add_u32 s36, s34, 0
    s_add_u32 s37, s35, 0
    s_mov_b32 m0, s37
    s_nop 0
    buffer_load_dwordx4 v3, s[8:11], s36 offen lds
    s_add_u32 s36, s34, 8192
    s_add_u32 s37, s35, 1024
    s_mov_b32 m0, s37
    s_nop 0
    buffer_load_dwordx4 v3, s[8:11], s36 offen lds
    s_mov_b32 s12, s24
    s_mov_b32 s13, s25
    s_mov_b32 s14, 2097152
    s_mov_b32 s15, 0x00020000
    s_add_u32 s16, s20, 8388608
    s_addc_u32 s17, s21, 0
    s_mov_b32 s18, 2097152
    s_mov_b32 s19, 0x00020000
    s_and_b32 s39, s26, 1
    s_bfe_u32 s40, s26, 0x10001
    s_lshr_b32 s41, s26, 2
    v_and_b32 v16, 31, v1
    v_lshrrev_b32 v17, 5, v1
    v_bfe_u32 v18, v1, 2, 2
    v_and_b32 v19, 3, v1
    v_bfe_u32 v20, v1, 4, 1
    s_lshl_b32 s29, s27, 6
    s_lshl_b32 s30, s39, 5
    s_add_u32 s29, s29, s30
    v_add_u32 v21, s29, v16
    v_lshlrev_b32 v22, 10, v21
    s_lshl_b32 s30, s28, 7
    s_lshl_b32 s36, s40, 6
    s_add_u32 s30, s30, s36
    v_add_u32 v22, s30, v22
    v_lshl_add_u32 v22, v17, 3, v22
    buffer_load_dwordx2 v[48:49], v22, s[16:19], 0 offen offset:0
    buffer_load_dwordx2 v[50:51], v22, s[16:19], 0 offen offset:16
    buffer_load_dwordx2 v[52:53], v22, s[16:19], 0 offen offset:32
    buffer_load_dwordx2 v[54:55], v22, s[16:19], 0 offen offset:48
    s_lshl_b32 s30, s39, 5
    v_add_u32 v21, s30, v16
    v_lshrrev_b32 v23, 3, v21
    v_lshlrev_b32 v24, 10, v23
    v_and_b32 v23, 7, v21
    v_lshl_add_u32 v24, v23, 7, v24
    v_bfe_u32 v23, v21, 1, 3
    s_lshl_b32 s30, s41, 1
    s_add_u32 s30, s30, 0
    v_add_u32 v25, s30, v17
    v_xor_b32 v25, v25, v23
    v_lshl_add_u32 v28, v25, 4, v24
    s_lshl_b32 s30, s41, 1
    s_add_u32 s30, s30, 4
    v_add_u32 v25, s30, v17
    v_xor_b32 v25, v25, v23
    v_lshl_add_u32 v29, v25, 4, v24
    s_lshl_b32 s30, s41, 1
    s_add_u32 s30, s30, 0
    v_add_u32 v25, s30, v17
    v_xor_b32 v25, v25, v23
    v_lshl_add_u32 v30, v25, 4, v24
    v_add_u32 v30, 8192, v30
    s_lshl_b32 s30, s41, 1
    s_add_u32 s30, s30, 4
    v_add_u32 v25, s30, v17
    v_xor_b32 v25, v25, v23
    v_lshl_add_u32 v31, v25, 4, v24
    v_add_u32 v31, 8192, v31
    v_lshl_add_u32 v21, v17, 3, v18
    v_lshlrev_b32 v21, 7, v21
    v_and_b32 v23, 1, v19
    v_lshl_add_u32 v21, v23, 3, v21
    v_lshrrev_b32 v23, 1, v19
    v_lshl_add_u32 v23, v20, 1, v23
    s_lshl_b32 s30, s40, 2
    v_add_u32 v23, s30, v23
    v_bfe_u32 v24, v18, 1, 1
    v_lshlrev_b32 v24, 2, v24
    v_xor_b32 v23, v23, v24
    v_lshl_add_u32 v21, v23, 4, v21
    s_lshl_b32 s30, s41, 11
    v_add_u32 v21, s30, v21
    v_add_u32 v32, 16384, v21
    s_add_u32 s37, s38, 32768
    s_mov_b32 m0, s37
    s_movk_i32 s36, 256
    buffer_load_dwordx4 v2, s[4:7], s36 offen lds
    s_add_u32 s37, s38, 40960
    s_mov_b32 m0, s37
    s_movk_i32 s36, 384
    buffer_load_dwordx4 v2, s[4:7], s36 offen lds
    s_add_u32 s36, s34, 131072
    s_add_u32 s37, s35, 32768
    s_mov_b32 m0, s37
    s_nop 0
    buffer_load_dwordx4 v3, s[8:11], s36 offen lds
    s_add_u32 s36, s34, 139264
    s_add_u32 s37, s35, 33792
    s_mov_b32 m0, s37
    s_nop 0
    buffer_load_dwordx4 v3, s[8:11], s36 offen lds
    v_mov_b32 v64, 0
    v_mov_b32 v65, 0
    v_mov_b32 v66, 0
    v_mov_b32 v67, 0
    v_mov_b32 v68, 0
    v_mov_b32 v69, 0
    v_mov_b32 v70, 0
    v_mov_b32 v71, 0
    v_mov_b32 v72, 0
    v_mov_b32 v73, 0
    v_mov_b32 v74, 0
    v_mov_b32 v75, 0
    v_mov_b32 v76, 0
    v_mov_b32 v77, 0
    v_mov_b32 v78, 0
    v_mov_b32 v79, 0
    v_add_u32 v152, 0, v28
    v_add_u32 v153, 0, v29
    v_add_u32 v154, 0, v30
    v_add_u32 v155, 0, v31
    v_add_u32 v156, 0, v32
    v_add_u32 v160, 32768, v28
    v_add_u32 v161, 32768, v29
    v_add_u32 v162, 32768, v30
    v_add_u32 v163, 32768, v31
    v_add_u32 v164, 32768, v32
    v_add_u32 v168, 65536, v28
    v_add_u32 v169, 65536, v29
    v_add_u32 v170, 65536, v30
    v_add_u32 v171, 65536, v31
    v_add_u32 v172, 65536, v32
    v_add_u32 v176, 98304, v28
    v_add_u32 v177, 98304, v29
    v_add_u32 v178, 98304, v30
    v_add_u32 v179, 98304, v31
    v_add_u32 v180, 98304, v32
    s_waitcnt vmcnt(8)
    s_barrier
    ds_read_b128 v[128:131], v152
    ds_read_b64_tr_b16 v[80:81], v156 offset:0
    ds_read_b64_tr_b16 v[82:83], v156 offset:512
    ds_read_b128 v[132:135], v153
    ds_read_b64_tr_b16 v[84:85], v156 offset:4096
    ds_read_b64_tr_b16 v[86:87], v156 offset:4608
    ds_read_b128 v[136:139], v154
    ds_read_b64_tr_b16 v[88:89], v156 offset:8192
    ds_read_b64_tr_b16 v[90:91], v156 offset:8704
    ds_read_b128 v[140:143], v155
    ds_read_b64_tr_b16 v[92:93], v156 offset:12288
    ds_read_b64_tr_b16 v[94:95], v156 offset:12800
    s_waitcnt lgkmcnt(9)
    v_mfma_f32_32x32x16_bf16 v[64:79], v[80:83], v[128:131], v[64:79]
    s_add_u32 s37, s38, 65536
    s_mov_b32 m0, s37
    s_movk_i32 s36, 512
    buffer_load_dwordx4 v2, s[4:7], s36 offen lds
    s_add_u32 s37, s38, 73728
    s_mov_b32 m0, s37
    s_movk_i32 s36, 640
    buffer_load_dwordx4 v2, s[4:7], s36 offen lds
    s_add_u32 s36, s34, 262144
    s_add_u32 s37, s35, 65536
    s_mov_b32 m0, s37
    s_nop 0
    buffer_load_dwordx4 v3, s[8:11], s36 offen lds
    s_add_u32 s36, s34, 270336
    s_add_u32 s37, s35, 66560
    s_mov_b32 m0, s37
    s_nop 0
    buffer_load_dwordx4 v3, s[8:11], s36 offen lds
    s_add_u32 s37, s38, 98304
    s_mov_b32 m0, s37
    s_movk_i32 s36, 768
    buffer_load_dwordx4 v2, s[4:7], s36 offen lds
    s_add_u32 s37, s38, 106496
    s_mov_b32 m0, s37
    s_movk_i32 s36, 896
    buffer_load_dwordx4 v2, s[4:7], s36 offen lds
    s_add_u32 s36, s34, 393216
    s_add_u32 s37, s35, 98304
    s_mov_b32 m0, s37
    s_nop 0
    buffer_load_dwordx4 v3, s[8:11], s36 offen lds
    s_add_u32 s36, s34, 401408
    s_add_u32 s37, s35, 99328
    s_mov_b32 m0, s37
    s_nop 0
    buffer_load_dwordx4 v3, s[8:11], s36 offen lds
    s_waitcnt vmcnt(8)
    s_waitcnt lgkmcnt(0)
    s_barrier
    ds_read_b128 v[144:147], v160
    ds_read_b64_tr_b16 v[96:97], v164 offset:0
    ds_read_b64_tr_b16 v[98:99], v164 offset:512
    v_mfma_f32_32x32x16_bf16 v[64:79], v[84:87], v[132:135], v[64:79]
    s_add_u32 s37, s38, 0
    s_mov_b32 m0, s37
    s_movk_i32 s36, 1024
    buffer_load_dwordx4 v2, s[4:7], s36 offen lds
    s_add_u32 s37, s38, 8192
    s_mov_b32 m0, s37
    s_movk_i32 s36, 1152
    buffer_load_dwordx4 v2, s[4:7], s36 offen lds
    ds_read_b128 v[128:131], v161
    ds_read_b64_tr_b16 v[80:81], v164 offset:4096
    ds_read_b64_tr_b16 v[82:83], v164 offset:4608
    v_mfma_f32_32x32x16_bf16 v[64:79], v[88:91], v[136:139], v[64:79]
    s_add_u32 s36, s34, 524288
    s_add_u32 s37, s35, 0
    s_mov_b32 m0, s37
    s_nop 0
    buffer_load_dwordx4 v3, s[8:11], s36 offen lds
    s_add_u32 s36, s34, 532480
    s_add_u32 s37, s35, 1024
    s_mov_b32 m0, s37
    s_nop 0
    buffer_load_dwordx4 v3, s[8:11], s36 offen lds
    ds_read_b128 v[132:135], v162
    ds_read_b64_tr_b16 v[84:85], v164 offset:8192
    ds_read_b64_tr_b16 v[86:87], v164 offset:8704
    v_mfma_f32_32x32x16_bf16 v[64:79], v[92:95], v[140:143], v[64:79]
    ds_read_b128 v[136:139], v163
    ds_read_b64_tr_b16 v[88:89], v164 offset:12288
    ds_read_b64_tr_b16 v[90:91], v164 offset:12800
    s_waitcnt lgkmcnt(9)
    v_mfma_f32_32x32x16_bf16 v[64:79], v[96:99], v[144:147], v[64:79]
    s_waitcnt vmcnt(8)
    s_waitcnt lgkmcnt(0)
    s_barrier
    ds_read_b128 v[140:143], v168
    ds_read_b64_tr_b16 v[92:93], v172 offset:0
    ds_read_b64_tr_b16 v[94:95], v172 offset:512
    v_mfma_f32_32x32x16_bf16 v[64:79], v[80:83], v[128:131], v[64:79]
    s_add_u32 s37, s38, 32768
    s_mov_b32 m0, s37
    s_movk_i32 s36, 1280
    buffer_load_dwordx4 v2, s[4:7], s36 offen lds
    s_add_u32 s37, s38, 40960
    s_mov_b32 m0, s37
    s_movk_i32 s36, 1408
    buffer_load_dwordx4 v2, s[4:7], s36 offen lds
    ds_read_b128 v[144:147], v169
    ds_read_b64_tr_b16 v[96:97], v172 offset:4096
    ds_read_b64_tr_b16 v[98:99], v172 offset:4608
    v_mfma_f32_32x32x16_bf16 v[64:79], v[84:87], v[132:135], v[64:79]
    s_add_u32 s36, s34, 655360
    s_add_u32 s37, s35, 32768
    s_mov_b32 m0, s37
    s_nop 0
    buffer_load_dwordx4 v3, s[8:11], s36 offen lds
    s_add_u32 s36, s34, 663552
    s_add_u32 s37, s35, 33792
    s_mov_b32 m0, s37
    s_nop 0
    buffer_load_dwordx4 v3, s[8:11], s36 offen lds
    ds_read_b128 v[128:131], v170
    ds_read_b64_tr_b16 v[80:81], v172 offset:8192
    ds_read_b64_tr_b16 v[82:83], v172 offset:8704
    v_mfma_f32_32x32x16_bf16 v[64:79], v[88:91], v[136:139], v[64:79]
    ds_read_b128 v[132:135], v171
    ds_read_b64_tr_b16 v[84:85], v172 offset:12288
    ds_read_b64_tr_b16 v[86:87], v172 offset:12800
    s_waitcnt lgkmcnt(9)
    v_mfma_f32_32x32x16_bf16 v[64:79], v[92:95], v[140:143], v[64:79]
    s_waitcnt vmcnt(8)
    s_waitcnt lgkmcnt(0)
    s_barrier
    ds_read_b128 v[136:139], v176
    ds_read_b64_tr_b16 v[88:89], v180 offset:0
    ds_read_b64_tr_b16 v[90:91], v180 offset:512
    v_mfma_f32_32x32x16_bf16 v[64:79], v[96:99], v[144:147], v[64:79]
    s_add_u32 s37, s38, 65536
    s_mov_b32 m0, s37
    s_movk_i32 s36, 1536
    buffer_load_dwordx4 v2, s[4:7], s36 offen lds
    s_add_u32 s37, s38, 73728
    s_mov_b32 m0, s37
    s_movk_i32 s36, 1664
    buffer_load_dwordx4 v2, s[4:7], s36 offen lds
    ds_read_b128 v[140:143], v177
    ds_read_b64_tr_b16 v[92:93], v180 offset:4096
    ds_read_b64_tr_b16 v[94:95], v180 offset:4608
    v_mfma_f32_32x32x16_bf16 v[64:79], v[80:83], v[128:131], v[64:79]
    s_add_u32 s36, s34, 786432
    s_add_u32 s37, s35, 65536
    s_mov_b32 m0, s37
    s_nop 0
    buffer_load_dwordx4 v3, s[8:11], s36 offen lds
    s_add_u32 s36, s34, 794624
    s_add_u32 s37, s35, 66560
    s_mov_b32 m0, s37
    s_nop 0
    buffer_load_dwordx4 v3, s[8:11], s36 offen lds
    ds_read_b128 v[144:147], v178
    ds_read_b64_tr_b16 v[96:97], v180 offset:8192
    ds_read_b64_tr_b16 v[98:99], v180 offset:8704
    v_mfma_f32_32x32x16_bf16 v[64:79], v[84:87], v[132:135], v[64:79]
    ds_read_b128 v[128:131], v179
    ds_read_b64_tr_b16 v[80:81], v180 offset:12288
    ds_read_b64_tr_b16 v[82:83], v180 offset:12800
    s_waitcnt lgkmcnt(9)
    v_mfma_f32_32x32x16_bf16 v[64:79], v[88:91], v[136:139], v[64:79]
    s_waitcnt vmcnt(8)
    s_waitcnt lgkmcnt(0)
    s_barrier
    ds_read_b128 v[132:135], v152
    ds_read_b64_tr_b16 v[84:85], v156 offset:0
    ds_read_b64_tr_b16 v[86:87], v156 offset:512
    v_mfma_f32_32x32x16_bf16 v[64:79], v[92:95], v[140:143], v[64:79]
    s_add_u32 s37, s38, 98304
    s_mov_b32 m0, s37
    s_movk_i32 s36, 1792
    buffer_load_dwordx4 v2, s[4:7], s36 offen lds
    s_add_u32 s37, s38, 106496
    s_mov_b32 m0, s37
    s_movk_i32 s36, 1920
    buffer_load_dwordx4 v2, s[4:7], s36 offen lds
    ds_read_b128 v[136:139], v153
    ds_read_b64_tr_b16 v[88:89], v156 offset:4096
    ds_read_b64_tr_b16 v[90:91], v156 offset:4608
    v_mfma_f32_32x32x16_bf16 v[64:79], v[96:99], v[144:147], v[64:79]
    s_add_u32 s36, s34, 917504
    s_add_u32 s37, s35, 98304
    s_mov_b32 m0, s37
    s_nop 0
    buffer_load_dwordx4 v3, s[8:11], s36 offen lds
    s_add_u32 s36, s34, 925696
    s_add_u32 s37, s35, 99328
    s_mov_b32 m0, s37
    s_nop 0
    buffer_load_dwordx4 v3, s[8:11], s36 offen lds
    ds_read_b128 v[140:143], v154
    ds_read_b64_tr_b16 v[92:93], v156 offset:8192
    ds_read_b64_tr_b16 v[94:95], v156 offset:8704
    v_mfma_f32_32x32x16_bf16 v[64:79], v[80:83], v[128:131], v[64:79]
    ds_read_b128 v[144:147], v155
    ds_read_b64_tr_b16 v[96:97], v156 offset:12288
    ds_read_b64_tr_b16 v[98:99], v156 offset:12800
    s_waitcnt lgkmcnt(9)
    v_mfma_f32_32x32x16_bf16 v[64:79], v[84:87], v[132:135], v[64:79]
    s_waitcnt vmcnt(8)
    s_waitcnt lgkmcnt(0)
    s_barrier
    ds_read_b128 v[128:131], v160
    ds_read_b64_tr_b16 v[80:81], v164 offset:0
    ds_read_b64_tr_b16 v[82:83], v164 offset:512
    v_mfma_f32_32x32x16_bf16 v[64:79], v[88:91], v[136:139], v[64:79]
    s_add_u32 s37, s38, 0
    s_mov_b32 m0, s37
    s_movk_i32 s36, 2048
    buffer_load_dwordx4 v2, s[4:7], s36 offen lds
    s_add_u32 s37, s38, 8192
    s_mov_b32 m0, s37
    s_movk_i32 s36, 2176
    buffer_load_dwordx4 v2, s[4:7], s36 offen lds
    ds_read_b128 v[132:135], v161
    ds_read_b64_tr_b16 v[84:85], v164 offset:4096
    ds_read_b64_tr_b16 v[86:87], v164 offset:4608
    v_mfma_f32_32x32x16_bf16 v[64:79], v[92:95], v[140:143], v[64:79]
    s_add_u32 s36, s34, 1048576
    s_add_u32 s37, s35, 0
    s_mov_b32 m0, s37
    s_nop 0
    buffer_load_dwordx4 v3, s[8:11], s36 offen lds
    s_add_u32 s36, s34, 1056768
    s_add_u32 s37, s35, 1024
    s_mov_b32 m0, s37
    s_nop 0
    buffer_load_dwordx4 v3, s[8:11], s36 offen lds
    ds_read_b128 v[136:139], v162
    ds_read_b64_tr_b16 v[88:89], v164 offset:8192
    ds_read_b64_tr_b16 v[90:91], v164 offset:8704
    v_mfma_f32_32x32x16_bf16 v[64:79], v[96:99], v[144:147], v[64:79]
    ds_read_b128 v[140:143], v163
    ds_read_b64_tr_b16 v[92:93], v164 offset:12288
    ds_read_b64_tr_b16 v[94:95], v164 offset:12800
    s_waitcnt lgkmcnt(9)
    v_mfma_f32_32x32x16_bf16 v[64:79], v[80:83], v[128:131], v[64:79]
    s_waitcnt vmcnt(8)
    s_waitcnt lgkmcnt(0)
    s_barrier
    ds_read_b128 v[144:147], v168
    ds_read_b64_tr_b16 v[96:97], v172 offset:0
    ds_read_b64_tr_b16 v[98:99], v172 offset:512
    v_mfma_f32_32x32x16_bf16 v[64:79], v[84:87], v[132:135], v[64:79]
    s_add_u32 s37, s38, 32768
    s_mov_b32 m0, s37
    s_movk_i32 s36, 2304
    buffer_load_dwordx4 v2, s[4:7], s36 offen lds
    s_add_u32 s37, s38, 40960
    s_mov_b32 m0, s37
    s_movk_i32 s36, 2432
    buffer_load_dwordx4 v2, s[4:7], s36 offen lds
    ds_read_b128 v[128:131], v169
    ds_read_b64_tr_b16 v[80:81], v172 offset:4096
    ds_read_b64_tr_b16 v[82:83], v172 offset:4608
    v_mfma_f32_32x32x16_bf16 v[64:79], v[88:91], v[136:139], v[64:79]
    s_add_u32 s36, s34, 1179648
    s_add_u32 s37, s35, 32768
    s_mov_b32 m0, s37
    s_nop 0
    buffer_load_dwordx4 v3, s[8:11], s36 offen lds
    s_add_u32 s36, s34, 1187840
    s_add_u32 s37, s35, 33792
    s_mov_b32 m0, s37
    s_nop 0
    buffer_load_dwordx4 v3, s[8:11], s36 offen lds
    ds_read_b128 v[132:135], v170
    ds_read_b64_tr_b16 v[84:85], v172 offset:8192
    ds_read_b64_tr_b16 v[86:87], v172 offset:8704
    v_mfma_f32_32x32x16_bf16 v[64:79], v[92:95], v[140:143], v[64:79]
    ds_read_b128 v[136:139], v171
    ds_read_b64_tr_b16 v[88:89], v172 offset:12288
    ds_read_b64_tr_b16 v[90:91], v172 offset:12800
    s_waitcnt lgkmcnt(9)
    v_mfma_f32_32x32x16_bf16 v[64:79], v[96:99], v[144:147], v[64:79]
    s_waitcnt vmcnt(8)
    s_waitcnt lgkmcnt(0)
    s_barrier
    ds_read_b128 v[140:143], v176
    ds_read_b64_tr_b16 v[92:93], v180 offset:0
    ds_read_b64_tr_b16 v[94:95], v180 offset:512
    v_mfma_f32_32x32x16_bf16 v[64:79], v[80:83], v[128:131], v[64:79]
    s_add_u32 s37, s38, 65536
    s_mov_b32 m0, s37
    s_movk_i32 s36, 2560
    buffer_load_dwordx4 v2, s[4:7], s36 offen lds
    s_add_u32 s37, s38, 73728
    s_mov_b32 m0, s37
    s_movk_i32 s36, 2688
    buffer_load_dwordx4 v2, s[4:7], s36 offen lds
    ds_read_b128 v[144:147], v177
    ds_read_b64_tr_b16 v[96:97], v180 offset:4096
    ds_read_b64_tr_b16 v[98:99], v180 offset:4608
    v_mfma_f32_32x32x16_bf16 v[64:79], v[84:87], v[132:135], v[64:79]
    s_add_u32 s36, s34, 1310720
    s_add_u32 s37, s35, 65536
    s_mov_b32 m0, s37
    s_nop 0
    buffer_load_dwordx4 v3, s[8:11], s36 offen lds
    s_add_u32 s36, s34, 1318912
    s_add_u32 s37, s35, 66560
    s_mov_b32 m0, s37
    s_nop 0
    buffer_load_dwordx4 v3, s[8:11], s36 offen lds
    ds_read_b128 v[128:131], v178
    ds_read_b64_tr_b16 v[80:81], v180 offset:8192
    ds_read_b64_tr_b16 v[82:83], v180 offset:8704
    v_mfma_f32_32x32x16_bf16 v[64:79], v[88:91], v[136:139], v[64:79]
    ds_read_b128 v[132:135], v179
    ds_read_b64_tr_b16 v[84:85], v180 offset:12288
    ds_read_b64_tr_b16 v[86:87], v180 offset:12800
    s_waitcnt lgkmcnt(9)
    v_mfma_f32_32x32x16_bf16 v[64:79], v[92:95], v[140:143], v[64:79]
    s_waitcnt vmcnt(8)
    s_waitcnt lgkmcnt(0)
    s_barrier
    ds_read_b128 v[136:139], v152
    ds_read_b64_tr_b16 v[88:89], v156 offset:0
    ds_read_b64_tr_b16 v[90:91], v156 offset:512
    v_mfma_f32_32x32x16_bf16 v[64:79], v[96:99], v[144:147], v[64:79]
    s_add_u32 s37, s38, 98304
    s_mov_b32 m0, s37
    s_movk_i32 s36, 2816
    buffer_load_dwordx4 v2, s[4:7], s36 offen lds
    s_add_u32 s37, s38, 106496
    s_mov_b32 m0, s37
    s_movk_i32 s36, 2944
    buffer_load_dwordx4 v2, s[4:7], s36 offen lds
    ds_read_b128 v[140:143], v153
    ds_read_b64_tr_b16 v[92:93], v156 offset:4096
    ds_read_b64_tr_b16 v[94:95], v156 offset:4608
    v_mfma_f32_32x32x16_bf16 v[64:79], v[80:83], v[128:131], v[64:79]
    s_add_u32 s36, s34, 1441792
    s_add_u32 s37, s35, 98304
    s_mov_b32 m0, s37
    s_nop 0
    buffer_load_dwordx4 v3, s[8:11], s36 offen lds
    s_add_u32 s36, s34, 1449984
    s_add_u32 s37, s35, 99328
    s_mov_b32 m0, s37
    s_nop 0
    buffer_load_dwordx4 v3, s[8:11], s36 offen lds
    ds_read_b128 v[144:147], v154
    ds_read_b64_tr_b16 v[96:97], v156 offset:8192
    ds_read_b64_tr_b16 v[98:99], v156 offset:8704
    v_mfma_f32_32x32x16_bf16 v[64:79], v[84:87], v[132:135], v[64:79]
    ds_read_b128 v[128:131], v155
    ds_read_b64_tr_b16 v[80:81], v156 offset:12288
    ds_read_b64_tr_b16 v[82:83], v156 offset:12800
    s_waitcnt lgkmcnt(9)
    v_mfma_f32_32x32x16_bf16 v[64:79], v[88:91], v[136:139], v[64:79]
    s_waitcnt vmcnt(8)
    s_waitcnt lgkmcnt(0)
    s_barrier
    ds_read_b128 v[132:135], v160
    ds_read_b64_tr_b16 v[84:85], v164 offset:0
    ds_read_b64_tr_b16 v[86:87], v164 offset:512
    v_mfma_f32_32x32x16_bf16 v[64:79], v[92:95], v[140:143], v[64:79]
    s_add_u32 s37, s38, 0
    s_mov_b32 m0, s37
    s_movk_i32 s36, 3072
    buffer_load_dwordx4 v2, s[4:7], s36 offen lds
    s_add_u32 s37, s38, 8192
    s_mov_b32 m0, s37
    s_movk_i32 s36, 3200
    buffer_load_dwordx4 v2, s[4:7], s36 offen lds
    ds_read_b128 v[136:139], v161
    ds_read_b64_tr_b16 v[88:89], v164 offset:4096
    ds_read_b64_tr_b16 v[90:91], v164 offset:4608
    v_mfma_f32_32x32x16_bf16 v[64:79], v[96:99], v[144:147], v[64:79]
    s_add_u32 s36, s34, 1572864
    s_add_u32 s37, s35, 0
    s_mov_b32 m0, s37
    s_nop 0
    buffer_load_dwordx4 v3, s[8:11], s36 offen lds
    s_add_u32 s36, s34, 1581056
    s_add_u32 s37, s35, 1024
    s_mov_b32 m0, s37
    s_nop 0
    buffer_load_dwordx4 v3, s[8:11], s36 offen lds
    ds_read_b128 v[140:143], v162
    ds_read_b64_tr_b16 v[92:93], v164 offset:8192
    ds_read_b64_tr_b16 v[94:95], v164 offset:8704
    v_mfma_f32_32x32x16_bf16 v[64:79], v[80:83], v[128:131], v[64:79]
    ds_read_b128 v[144:147], v163
    ds_read_b64_tr_b16 v[96:97], v164 offset:12288
    ds_read_b64_tr_b16 v[98:99], v164 offset:12800
    s_waitcnt lgkmcnt(9)
    v_mfma_f32_32x32x16_bf16 v[64:79], v[84:87], v[132:135], v[64:79]
    s_waitcnt vmcnt(8)
    s_waitcnt lgkmcnt(0)
    s_barrier
    ds_read_b128 v[128:131], v168
    ds_read_b64_tr_b16 v[80:81], v172 offset:0
    ds_read_b64_tr_b16 v[82:83], v172 offset:512
    v_mfma_f32_32x32x16_bf16 v[64:79], v[88:91], v[136:139], v[64:79]
    s_add_u32 s37, s38, 32768
    s_mov_b32 m0, s37
    s_movk_i32 s36, 3328
    buffer_load_dwordx4 v2, s[4:7], s36 offen lds
    s_add_u32 s37, s38, 40960
    s_mov_b32 m0, s37
    s_movk_i32 s36, 3456
    buffer_load_dwordx4 v2, s[4:7], s36 offen lds
    ds_read_b128 v[132:135], v169
    ds_read_b64_tr_b16 v[84:85], v172 offset:4096
    ds_read_b64_tr_b16 v[86:87], v172 offset:4608
    v_mfma_f32_32x32x16_bf16 v[64:79], v[92:95], v[140:143], v[64:79]
    s_add_u32 s36, s34, 1703936
    s_add_u32 s37, s35, 32768
    s_mov_b32 m0, s37
    s_nop 0
    buffer_load_dwordx4 v3, s[8:11], s36 offen lds
    s_add_u32 s36, s34, 1712128
    s_add_u32 s37, s35, 33792
    s_mov_b32 m0, s37
    s_nop 0
    buffer_load_dwordx4 v3, s[8:11], s36 offen lds
    ds_read_b128 v[136:139], v170
    ds_read_b64_tr_b16 v[88:89], v172 offset:8192
    ds_read_b64_tr_b16 v[90:91], v172 offset:8704
    v_mfma_f32_32x32x16_bf16 v[64:79], v[96:99], v[144:147], v[64:79]
    ds_read_b128 v[140:143], v171
    ds_read_b64_tr_b16 v[92:93], v172 offset:12288
    ds_read_b64_tr_b16 v[94:95], v172 offset:12800
    s_waitcnt lgkmcnt(9)
    v_mfma_f32_32x32x16_bf16 v[64:79], v[80:83], v[128:131], v[64:79]
    s_waitcnt vmcnt(8)
    s_waitcnt lgkmcnt(0)
    s_barrier
    ds_read_b128 v[144:147], v176
    ds_read_b64_tr_b16 v[96:97], v180 offset:0
    ds_read_b64_tr_b16 v[98:99], v180 offset:512
    v_mfma_f32_32x32x16_bf16 v[64:79], v[84:87], v[132:135], v[64:79]
    ds_read_b128 v[128:131], v177
    ds_read_b64_tr_b16 v[80:81], v180 offset:4096
    ds_read_b64_tr_b16 v[82:83], v180 offset:4608
    v_mfma_f32_32x32x16_bf16 v[64:79], v[88:91], v[136:139], v[64:79]
    ds_read_b128 v[132:135], v178
    ds_read_b64_tr_b16 v[84:85], v180 offset:8192
    ds_read_b64_tr_b16 v[86:87], v180 offset:8704
    v_mfma_f32_32x32x16_bf16 v[64:79], v[92:95], v[140:143], v[64:79]
    ds_read_b128 v[136:139], v179
    ds_read_b64_tr_b16 v[88:89], v180 offset:12288
    ds_read_b64_tr_b16 v[90:91], v180 offset:12800
    s_waitcnt lgkmcnt(9)
    v_mfma_f32_32x32x16_bf16 v[64:79], v[96:99], v[144:147], v[64:79]
    s_waitcnt vmcnt(4)
    s_waitcnt lgkmcnt(0)
    s_barrier
    ds_read_b128 v[140:143], v152
    ds_read_b64_tr_b16 v[92:93], v156 offset:0
    ds_read_b64_tr_b16 v[94:95], v156 offset:512
    v_mfma_f32_32x32x16_bf16 v[64:79], v[80:83], v[128:131], v[64:79]
    ds_read_b128 v[144:147], v153
    ds_read_b64_tr_b16 v[96:97], v156 offset:4096
    ds_read_b64_tr_b16 v[98:99], v156 offset:4608
    v_mfma_f32_32x32x16_bf16 v[64:79], v[84:87], v[132:135], v[64:79]
    ds_read_b128 v[128:131], v154
    ds_read_b64_tr_b16 v[80:81], v156 offset:8192
    ds_read_b64_tr_b16 v[82:83], v156 offset:8704
    v_mfma_f32_32x32x16_bf16 v[64:79], v[88:91], v[136:139], v[64:79]
    ds_read_b128 v[132:135], v155
    ds_read_b64_tr_b16 v[84:85], v156 offset:12288
    ds_read_b64_tr_b16 v[86:87], v156 offset:12800
    s_waitcnt lgkmcnt(9)
    v_mfma_f32_32x32x16_bf16 v[64:79], v[92:95], v[140:143], v[64:79]
    s_waitcnt vmcnt(0)
    s_waitcnt lgkmcnt(0)
    s_barrier
    ds_read_b128 v[136:139], v160
    ds_read_b64_tr_b16 v[88:89], v164 offset:0
    ds_read_b64_tr_b16 v[90:91], v164 offset:512
    v_mfma_f32_32x32x16_bf16 v[64:79], v[96:99], v[144:147], v[64:79]
    ds_read_b128 v[140:143], v161
    ds_read_b64_tr_b16 v[92:93], v164 offset:4096
    ds_read_b64_tr_b16 v[94:95], v164 offset:4608
    v_mfma_f32_32x32x16_bf16 v[64:79], v[80:83], v[128:131], v[64:79]
    ds_read_b128 v[144:147], v162
    ds_read_b64_tr_b16 v[96:97], v164 offset:8192
    ds_read_b64_tr_b16 v[98:99], v164 offset:8704
    v_mfma_f32_32x32x16_bf16 v[64:79], v[84:87], v[132:135], v[64:79]
    ds_read_b128 v[128:131], v163
    ds_read_b64_tr_b16 v[80:81], v164 offset:12288
    ds_read_b64_tr_b16 v[82:83], v164 offset:12800
    s_waitcnt lgkmcnt(9)
    v_mfma_f32_32x32x16_bf16 v[64:79], v[88:91], v[136:139], v[64:79]
    s_waitcnt lgkmcnt(6)
    v_mfma_f32_32x32x16_bf16 v[64:79], v[92:95], v[140:143], v[64:79]
    s_waitcnt lgkmcnt(3)
    v_mfma_f32_32x32x16_bf16 v[64:79], v[96:99], v[144:147], v[64:79]
    s_waitcnt lgkmcnt(0)
    v_mfma_f32_32x32x16_bf16 v[64:79], v[80:83], v[128:131], v[64:79]
    s_barrier
    v_lshlrev_b32 v16, 4, v1
    s_and_b32 s30, s26, 3
    s_lshl_b32 s30, s30, 12
    v_add_u32 v16, s30, v16
    s_cmp_eq_u32 s41, 0
    s_cbranch_scc1 L_k4_red0
    s_nop 4
    ds_write_b128 v16, v[64:67] offset:0
    ds_write_b128 v16, v[68:71] offset:1024
    ds_write_b128 v16, v[72:75] offset:2048
    ds_write_b128 v16, v[76:79] offset:3072
    s_waitcnt lgkmcnt(0)
    s_barrier
    s_endpgm
L_k4_red0:
    s_nop 15
    s_barrier
    ds_read_b128 v[32:35], v16 offset:0
    ds_read_b128 v[36:39], v16 offset:1024
    ds_read_b128 v[40:43], v16 offset:2048
    ds_read_b128 v[44:47], v16 offset:3072
    s_waitcnt lgkmcnt(0)
    v_add_f32 v64, v64, v32
    v_add_f32 v65, v65, v33
    v_add_f32 v66, v66, v34
    v_add_f32 v67, v67, v35
    v_add_f32 v68, v68, v36
    v_add_f32 v69, v69, v37
    v_add_f32 v70, v70, v38
    v_add_f32 v71, v71, v39
    v_add_f32 v72, v72, v40
    v_add_f32 v73, v73, v41
    v_add_f32 v74, v74, v42
    v_add_f32 v75, v75, v43
    v_add_f32 v76, v76, v44
    v_add_f32 v77, v77, v45
    v_add_f32 v78, v78, v46
    v_add_f32 v79, v79, v47
    v_cvt_pk_bf16_f32 v32, v64, v65
    v_cvt_pk_bf16_f32 v33, v66, v67
    v_cvt_pk_bf16_f32 v34, v68, v69
    v_cvt_pk_bf16_f32 v35, v70, v71
    v_cvt_pk_bf16_f32 v36, v72, v73
    v_cvt_pk_bf16_f32 v37, v74, v75
    v_cvt_pk_bf16_f32 v38, v76, v77
    v_cvt_pk_bf16_f32 v39, v78, v79
    v_lshlrev_b32 v64, 16, v32
    v_and_b32 v65, 0xffff0000, v32
    v_lshlrev_b32 v66, 16, v33
    v_and_b32 v67, 0xffff0000, v33
    v_lshlrev_b32 v68, 16, v34
    v_and_b32 v69, 0xffff0000, v34
    v_lshlrev_b32 v70, 16, v35
    v_and_b32 v71, 0xffff0000, v35
    v_lshlrev_b32 v72, 16, v36
    v_and_b32 v73, 0xffff0000, v36
    v_lshlrev_b32 v74, 16, v37
    v_and_b32 v75, 0xffff0000, v37
    v_lshlrev_b32 v76, 16, v38
    v_and_b32 v77, 0xffff0000, v38
    v_lshlrev_b32 v78, 16, v39
    v_and_b32 v79, 0xffff0000, v39
    v_lshlrev_b32 v32, 16, v48
    v_and_b32 v33, 0xffff0000, v48
    v_add_f32 v64, v64, v32
    v_add_f32 v65, v65, v33
    v_lshlrev_b32 v34, 16, v49
    v_and_b32 v35, 0xffff0000, v49
    v_add_f32 v66, v66, v34
    v_add_f32 v67, v67, v35
    v_lshlrev_b32 v32, 16, v50
    v_and_b32 v33, 0xffff0000, v50
    v_add_f32 v68, v68, v32
    v_add_f32 v69, v69, v33
    v_lshlrev_b32 v34, 16, v51
    v_and_b32 v35, 0xffff0000, v51
    v_add_f32 v70, v70, v34
    v_add_f32 v71, v71, v35
    v_lshlrev_b32 v32, 16, v52
    v_and_b32 v33, 0xffff0000, v52
    v_add_f32 v72, v72, v32
    v_add_f32 v73, v73, v33
    v_lshlrev_b32 v34, 16, v53
    v_and_b32 v35, 0xffff0000, v53
    v_add_f32 v74, v74, v34
    v_add_f32 v75, v75, v35
    v_lshlrev_b32 v32, 16, v54
    v_and_b32 v33, 0xffff0000, v54
    v_add_f32 v76, v76, v32
    v_add_f32 v77, v77, v33
    v_lshlrev_b32 v34, 16, v55
    v_and_b32 v35, 0xffff0000, v55
    v_add_f32 v78, v78, v34
    v_add_f32 v79, v79, v35
    v_cvt_pk_bf16_f32 v40, v64, v65
    v_cvt_pk_bf16_f32 v41, v66, v67
    v_cvt_pk_bf16_f32 v42, v68, v69
    v_cvt_pk_bf16_f32 v43, v70, v71
    v_cvt_pk_bf16_f32 v44, v72, v73
    v_cvt_pk_bf16_f32 v45, v74, v75
    v_cvt_pk_bf16_f32 v46, v76, v77
    v_cvt_pk_bf16_f32 v47, v78, v79
    buffer_store_dwordx2 v[40:41], v22, s[12:15], 0 offen offset:0
    buffer_store_dwordx2 v[42:43], v22, s[12:15], 0 offen offset:16
    buffer_store_dwordx2 v[44:45], v22, s[12:15], 0 offen offset:32
    buffer_store_dwordx2 v[46:47], v22, s[12:15], 0 offen offset:48
L_k4_done:
    s_endpgm
.section .rodata,"a"
.p2align 6
.amdhsa_kernel k1_qkv_kernel
  .amdhsa_next_free_vgpr 256
  .amdhsa_next_free_sgpr 96
  .amdhsa_accum_offset 256
  .amdhsa_group_segment_fixed_size 0
  .amdhsa_kernarg_size 88
  .amdhsa_user_sgpr_count 2
  .amdhsa_user_sgpr_kernarg_segment_ptr 1
  .amdhsa_system_sgpr_workgroup_id_x 1
.end_amdhsa_kernel
.section .rodata,"a"
.p2align 6
.amdhsa_kernel kaux_reduce_kernel
  .amdhsa_next_free_vgpr 64
  .amdhsa_next_free_sgpr 48
  .amdhsa_accum_offset 64
  .amdhsa_group_segment_fixed_size 0
  .amdhsa_kernarg_size 88
  .amdhsa_user_sgpr_count 2
  .amdhsa_user_sgpr_kernarg_segment_ptr 1
  .amdhsa_system_sgpr_workgroup_id_x 1
.end_amdhsa_kernel
.section .rodata,"a"
.p2align 6
.amdhsa_kernel k2_attn_out_kernel
  .amdhsa_next_free_vgpr 224
  .amdhsa_next_free_sgpr 96
  .amdhsa_accum_offset 224
  .amdhsa_group_segment_fixed_size 0
  .amdhsa_kernarg_size 88
  .amdhsa_user_sgpr_count 2
  .amdhsa_user_sgpr_kernarg_segment_ptr 1
  .amdhsa_system_sgpr_workgroup_id_x 1
.end_amdhsa_kernel
.section .rodata,"a"
.p2align 6
.amdhsa_kernel k3_ffn_up_kernel
  .amdhsa_next_free_vgpr 256
  .amdhsa_next_free_sgpr 96
  .amdhsa_accum_offset 256
  .amdhsa_group_segment_fixed_size 0
  .amdhsa_kernarg_size 88
  .amdhsa_user_sgpr_count 2
  .amdhsa_user_sgpr_kernarg_segment_ptr 1
  .amdhsa_system_sgpr_workgroup_id_x 1
.end_amdhsa_kernel
.section .rodata,"a"
.p2align 6
.amdhsa_kernel k4_ffn_down_kernel
  .amdhsa_next_free_vgpr 184
  .amdhsa_next_free_sgpr 96
  .amdhsa_accum_offset 184
  .amdhsa_group_segment_fixed_size 0
  .amdhsa_kernarg_size 88
  .amdhsa_user_sgpr_count 2
  .amdhsa_user_sgpr_kernarg_segment_ptr 1
  .amdhsa_system_sgpr_workgroup_id_x 1
.end_amdhsa_kernel
```
